```python
import torch

def _softmax(x, axis=-1):
    return torch.softmax(x, dim=axis)
def _gelu(x):
    return torch.nn.functional.gelu(x, approximate="tanh")
def _silu(x):
    return torch.nn.functional.silu(x)
def _sigmoid(x):
    return torch.sigmoid(x)
def _layernorm(x, axis=-1, eps=1e-5):
    m = x.mean(dim=axis, keepdim=True)
    v = x.var(dim=axis, keepdim=True, unbiased=False)
    return (x - m) / torch.sqrt(v + eps)
def _scatter_add(tgt, idx, src, axis=0):
    return tgt.clone().index_add_(axis, idx, src)
def _segment_sum(src, seg, n):
    out = torch.zeros((n,) + src.shape[1:], dtype=src.dtype)
    return out.index_add_(0, seg, src)
def _pad(x, pw):
    flat = tuple(v for pair in reversed(pw) for v in pair)
    return torch.nn.functional.pad(x, flat)

kernel_name = 'recurrent_scan__compressed_kv_cla__dense_activation_mish__prompt'

def setup_inputs():

    _w = (lambda a: (lambda t: t.to(torch.bfloat16) if t.is_floating_point() else t)(torch.as_tensor(a)))
    def _A_setup():
        B, H, Sq, Sk, D, M = 1, 16, 2048, 2048, 256, 448
        Dc = 4 * D
        return {
            "x": _w((lambda *s: torch.randn(*s, dtype=torch.bfloat16) * 0.05)(B, Sq, M)),
            "c_kv": _w((lambda *s: torch.randn(*s, dtype=torch.bfloat16) * 0.8)(B, Sk, Dc)),
            "w_q": _w((lambda *s: torch.randn(*s, dtype=torch.bfloat16) * 1.6)(M, H, D) * (M ** -0.5)),
            "w_uk": _w((lambda *s: torch.randn(*s, dtype=torch.bfloat16) * 1.6)(Dc, H, D) * (Dc ** -0.5)),
            "w_uv": _w((lambda *s: torch.randn(*s, dtype=torch.bfloat16) * 0.8)(Dc, H, D) * (Dc ** -0.5)),
            "w_o": _w((lambda *s: torch.randn(*s, dtype=torch.bfloat16) * 0.8)(H, D, M) * ((H * D) ** -0.5)),
        }
    _A_in = _A_setup()

    def _B_setup():
        B, S, D, F = 1, 2048, 448, 1792
        return {
            "x": _w((lambda *s: torch.randn(*s, dtype=torch.bfloat16) * 0.05)(B, S, D)),
            "w1": _w((lambda *s: torch.randn(*s, dtype=torch.bfloat16) * 0.8)(D, F) * (D ** -0.5)),
            "b1": _w((lambda *s: torch.randn(*s, dtype=torch.bfloat16) * 0.8)(F)),
            "w2": _w((lambda *s: torch.randn(*s, dtype=torch.bfloat16) * 0.2)(F, D) * (F ** -0.5)),
        }
    _B_in = _B_setup()

    return {
        "A_x": _A_in["x"],
        "A_c_kv": _A_in["c_kv"],
        "A_w_q": _A_in["w_q"],
        "A_w_uk": _A_in["w_uk"],
        "A_w_uv": _A_in["w_uv"],
        "A_w_o": _A_in["w_o"],
        "B_x": _B_in["x"],
        "B_w1": _B_in["w1"],
        "B_b1": _B_in["b1"],
        "B_w2": _B_in["w2"],
    }

def reference(A_x, A_c_kv, A_w_q, A_w_uk, A_w_uv, A_w_o, B_x, B_w1, B_b1, B_w2):
    def _A_ref(x, c_kv, w_q, w_uk, w_uv, w_o):
        B, Sq, M = x.shape[0], x.shape[1], x.shape[2]
        Sk = c_kv.shape[1]
        H, D = w_q.shape[1], w_q.shape[2]
        q = torch.einsum("bqm,mhd->bhqd", x, w_q)
        k = torch.einsum("bkc,chd->bhkd", c_kv, w_uk)
        v = torch.einsum("bkc,chd->bhkd", c_kv, w_uv)
        scores = torch.einsum("bhqd,bhkd->bhqk", q, k) * (D ** -0.5)
        off = Sk - Sq
        qi = torch.arange(Sq)[:, None]
        kj = torch.arange(Sk)[None, :]
        cmask = kj <= (qi + off)
        scores = torch.where(cmask[None, None], scores, -1e9)
        p = _softmax(scores, axis=-1)
        ctx = torch.einsum("bhqk,bhkd->bhqd", p, v)
        return torch.einsum("bhqd,hdm->bqm", ctx, w_o)

    def _B_ref(x, w1, b1, w2):
        h = torch.einsum("bsd,df->bsf", x, w1) + b1
        sp = torch.log1p(torch.exp(-torch.abs(h))) + torch.where(h > 0, h, torch.zeros_like(h))
        act = h * torch.tanh(sp)
        return torch.einsum("bsf,fd->bsd", act, w2)

    x = A_x
    xn = _layernorm(x, axis=-1)
    s = _A_ref(xn, A_c_kv, A_w_q, A_w_uk, A_w_uv, A_w_o)
    g = _silu(_B_ref(xn, B_w1, B_b1, B_w2))
    return x + s * g
```

```asm
; @launch kernel=k1_kernel grid=(288,1,1) block=(512,1,1) lds=139264
; @launch kernel=k2_kernel grid=(184,1,1) block=(512,1,1) lds=139264
; @launch kernel=k3_kernel grid=(256,1,1) block=(256,1,1) lds=157696
; @launch kernel=k4_kernel grid=(224,1,1) block=(256,1,1) lds=131072
.amdgcn_target "amdgcn-amd-amdhsa--gfx950"
.text
.p2align 8
k1_kernel:
    s_load_dwordx2 s[4:5], s[0:1], 96
    v_lshrrev_b32 v1, 6, v0
    v_and_b32 v2, 63, v0
    s_nop 0
    v_readfirstlane_b32 s25, v1
    s_cmp_ge_u32 s2, 288
    s_cbranch_scc1 k1_end
    s_cmp_ge_u32 s2, 256
    s_cbranch_scc1 k1_ln
    s_load_dwordx2 s[6:7], s[0:1], 8
    s_load_dwordx4 s[32:35], s[0:1], 24
    s_and_b32 s30, s2, 7
    s_lshr_b32 s31, s2, 3
    s_lshl_b32 s30, s30, 2
    s_and_b32 s36, s31, 3
    s_add_u32 s36, s36, s30
    s_lshr_b32 s26, s31, 2
    s_lshl_b32 s26, s26, 8
    s_and_b32 s27, s36, 15
    s_lshl_b32 s27, s27, 8
    s_waitcnt lgkmcnt(0)
    s_mov_b32 s8, s6
    s_mov_b32 s9, s7
    s_mov_b32 s10, 4194304
    s_mov_b32 s11, 0x00020000
    s_cmp_ge_u32 s36, 16
    s_cselect_b32 s32, s34, s32
    s_cselect_b32 s33, s35, s33
    s_mov_b32 s12, s32
    s_mov_b32 s13, s33
    s_mov_b32 s14, 8388608
    s_mov_b32 s15, 0x00020000
    s_cbranch_scc1 k1_v
    s_add_u32 s16, s4, 20971520
    s_addc_u32 s17, s5, 0
    s_mov_b32 s18, 16777216
    s_mov_b32 s19, 0x00020000
    s_and_b32 s28, s25, 1
    s_lshr_b32 s29, s25, 1
    v_lshrrev_b32 v3, 3, v2
    s_lshl_b32 s30, s25, 5
    s_add_u32 s30, s30, s26
    v_add_u32 v3, s30, v3
    s_mov_b32 s31, 2048
    v_mul_lo_u32 v3, v3, s31
    v_and_b32 v14, 7, v2
    v_lshrrev_b32 v15, 4, v2
    v_xor_b32 v16, v14, v15
    v_lshl_add_u32 v4, v16, 4, v3
    v_add_u32 v15, 4, v15
    v_xor_b32 v16, v14, v15
    v_lshl_add_u32 v5, v16, 4, v3
    v_lshrrev_b32 v3, 5, v2
    s_lshl_b32 s30, s25, 3
    v_add_u32 v14, s30, v3
    s_mov_b32 s31, 8192
    v_mul_lo_u32 v14, v14, s31
    s_lshl_b32 s30, s27, 1
    v_add_u32 v14, s30, v14
    v_and_b32 v15, 3, v2
    v_lshl_add_u32 v14, v15, 4, v14
    v_bfe_u32 v15, v2, 2, 3
    v_xor_b32 v16, v15, v3
    v_lshl_add_u32 v6, v16, 6, v14
    v_add_u32 v3, 2, v3
    v_xor_b32 v16, v15, v3
    v_lshl_add_u32 v7, v16, 6, v14
    v_and_b32 v3, 31, v2
    v_lshrrev_b32 v14, 5, v2
    v_bfe_u32 v15, v2, 1, 3
    v_xor_b32 v14, v14, v15
    v_lshlrev_b32 v3, 7, v3
    v_lshl_add_u32 v3, v14, 4, v3
    s_lshl_b32 s30, s28, 14
    v_add_u32 v3, s30, v3
    v_xor_b32 v8, 0, v3
    v_xor_b32 v9, 32, v3
    v_xor_b32 v10, 64, v3
    v_xor_b32 v11, 96, v3
    v_lshrrev_b32 v3, 5, v2
    v_bfe_u32 v14, v2, 2, 2
    v_lshl_add_u32 v3, v3, 3, v14
    v_lshlrev_b32 v3, 9, v3
    v_bfe_u32 v15, v2, 4, 1
    v_lshl_add_u32 v3, v15, 5, v3
    v_and_b32 v15, 3, v2
    v_lshl_add_u32 v3, v15, 3, v3
    v_add_u32 v3, 0x8000, v3
    s_lshl_b32 s30, s29, 1
    s_add_u32 s30, s30, 0
    s_lshr_b32 s31, s30, 2
    s_lshl_b32 s31, s31, 8
    s_and_b32 s30, s30, 3
    v_xor_b32 v15, s30, v14
    v_lshl_add_u32 v15, v15, 6, v3
    v_add_u32 v12, s31, v15
    s_lshl_b32 s30, s29, 1
    s_add_u32 s30, s30, 1
    s_lshr_b32 s31, s30, 2
    s_lshl_b32 s31, s31, 8
    s_and_b32 s30, s30, 3
    v_xor_b32 v15, s30, v14
    v_lshl_add_u32 v15, v15, 6, v3
    v_add_u32 v13, s31, v15
    v_mov_b32 v64, 0
    v_mov_b32 v65, 0
    v_mov_b32 v66, 0
    v_mov_b32 v67, 0
    v_mov_b32 v68, 0
    v_mov_b32 v69, 0
    v_mov_b32 v70, 0
    v_mov_b32 v71, 0
    v_mov_b32 v72, 0
    v_mov_b32 v73, 0
    v_mov_b32 v74, 0
    v_mov_b32 v75, 0
    v_mov_b32 v76, 0
    v_mov_b32 v77, 0
    v_mov_b32 v78, 0
    v_mov_b32 v79, 0
    v_mov_b32 v80, 0
    v_mov_b32 v81, 0
    v_mov_b32 v82, 0
    v_mov_b32 v83, 0
    v_mov_b32 v84, 0
    v_mov_b32 v85, 0
    v_mov_b32 v86, 0
    v_mov_b32 v87, 0
    v_mov_b32 v88, 0
    v_mov_b32 v89, 0
    v_mov_b32 v90, 0
    v_mov_b32 v91, 0
    v_mov_b32 v92, 0
    v_mov_b32 v93, 0
    v_mov_b32 v94, 0
    v_mov_b32 v95, 0
    v_mov_b32 v96, 0
    v_mov_b32 v97, 0
    v_mov_b32 v98, 0
    v_mov_b32 v99, 0
    v_mov_b32 v100, 0
    v_mov_b32 v101, 0
    v_mov_b32 v102, 0
    v_mov_b32 v103, 0
    v_mov_b32 v104, 0
    v_mov_b32 v105, 0
    v_mov_b32 v106, 0
    v_mov_b32 v107, 0
    v_mov_b32 v108, 0
    v_mov_b32 v109, 0
    v_mov_b32 v110, 0
    v_mov_b32 v111, 0
    v_mov_b32 v112, 0
    v_mov_b32 v113, 0
    v_mov_b32 v114, 0
    v_mov_b32 v115, 0
    v_mov_b32 v116, 0
    v_mov_b32 v117, 0
    v_mov_b32 v118, 0
    v_mov_b32 v119, 0
    v_mov_b32 v120, 0
    v_mov_b32 v121, 0
    v_mov_b32 v122, 0
    v_mov_b32 v123, 0
    v_mov_b32 v124, 0
    v_mov_b32 v125, 0
    v_mov_b32 v126, 0
    v_mov_b32 v127, 0
    v_mov_b32 v128, 0
    v_mov_b32 v129, 0
    v_mov_b32 v130, 0
    v_mov_b32 v131, 0
    v_mov_b32 v132, 0
    v_mov_b32 v133, 0
    v_mov_b32 v134, 0
    v_mov_b32 v135, 0
    v_mov_b32 v136, 0
    v_mov_b32 v137, 0
    v_mov_b32 v138, 0
    v_mov_b32 v139, 0
    v_mov_b32 v140, 0
    v_mov_b32 v141, 0
    v_mov_b32 v142, 0
    v_mov_b32 v143, 0
    v_mov_b32 v144, 0
    v_mov_b32 v145, 0
    v_mov_b32 v146, 0
    v_mov_b32 v147, 0
    v_mov_b32 v148, 0
    v_mov_b32 v149, 0
    v_mov_b32 v150, 0
    v_mov_b32 v151, 0
    v_mov_b32 v152, 0
    v_mov_b32 v153, 0
    v_mov_b32 v154, 0
    v_mov_b32 v155, 0
    v_mov_b32 v156, 0
    v_mov_b32 v157, 0
    v_mov_b32 v158, 0
    v_mov_b32 v159, 0
    v_mov_b32 v160, 0
    v_mov_b32 v161, 0
    v_mov_b32 v162, 0
    v_mov_b32 v163, 0
    v_mov_b32 v164, 0
    v_mov_b32 v165, 0
    v_mov_b32 v166, 0
    v_mov_b32 v167, 0
    v_mov_b32 v168, 0
    v_mov_b32 v169, 0
    v_mov_b32 v170, 0
    v_mov_b32 v171, 0
    v_mov_b32 v172, 0
    v_mov_b32 v173, 0
    v_mov_b32 v174, 0
    v_mov_b32 v175, 0
    v_mov_b32 v176, 0
    v_mov_b32 v177, 0
    v_mov_b32 v178, 0
    v_mov_b32 v179, 0
    v_mov_b32 v180, 0
    v_mov_b32 v181, 0
    v_mov_b32 v182, 0
    v_mov_b32 v183, 0
    v_mov_b32 v184, 0
    v_mov_b32 v185, 0
    v_mov_b32 v186, 0
    v_mov_b32 v187, 0
    v_mov_b32 v188, 0
    v_mov_b32 v189, 0
    v_mov_b32 v190, 0
    v_mov_b32 v191, 0
    s_mov_b32 s21, 0
    s_mov_b32 s22, 0
    s_lshl_b32 s24, s25, 12
    s_add_u32 m0, s24, 0
    s_add_u32 s23, s21, 0
    buffer_load_dwordx4 v4, s[8:11], s23 offen lds
    s_add_u32 m0, s24, 1024
    s_add_u32 s23, s21, 16384
    buffer_load_dwordx4 v5, s[8:11], s23 offen lds
    s_add_u32 m0, s24, 2048
    s_add_u32 s23, s21, 32768
    buffer_load_dwordx4 v4, s[8:11], s23 offen lds
    s_add_u32 m0, s24, 3072
    s_add_u32 s23, s21, 49152
    buffer_load_dwordx4 v5, s[8:11], s23 offen lds
    s_add_u32 m0, s24, 32768
    s_add_u32 s23, s22, 0
    buffer_load_dwordx4 v6, s[12:15], s23 offen lds
    s_add_u32 m0, s24, 33792
    s_add_u32 s23, s22, 16384
    buffer_load_dwordx4 v7, s[12:15], s23 offen lds
    s_add_u32 m0, s24, 34816
    s_add_u32 s23, s22, 32768
    buffer_load_dwordx4 v6, s[12:15], s23 offen lds
    s_add_u32 m0, s24, 35840
    s_add_u32 s23, s22, 49152
    buffer_load_dwordx4 v7, s[12:15], s23 offen lds
    s_mov_b32 s20, 0
gk_1:
    s_waitcnt vmcnt(0)
    s_barrier
    ds_read_b128 v[192:195], v8 offset:0
    ds_read_b128 v[196:199], v8 offset:4096
    ds_read_b128 v[200:203], v8 offset:8192
    ds_read_b128 v[204:207], v8 offset:12288
    ds_read_b64_tr_b16 v[224:225], v12 offset:0
    ds_read_b64_tr_b16 v[226:227], v12 offset:2048
    ds_read_b64_tr_b16 v[228:229], v13 offset:0
    ds_read_b64_tr_b16 v[230:231], v13 offset:2048
    s_add_u32 s20, s20, 1
    s_cmp_ge_u32 s20, 16
    s_cbranch_scc1 gs_2
    s_add_u32 s21, s21, 128
    s_add_u32 s22, s22, 524288
    s_xor_b32 s24, s24, 0x10000
    s_add_u32 m0, s24, 0
    s_add_u32 s23, s21, 0
    buffer_load_dwordx4 v4, s[8:11], s23 offen lds
    s_add_u32 m0, s24, 1024
    s_add_u32 s23, s21, 16384
    buffer_load_dwordx4 v5, s[8:11], s23 offen lds
    s_add_u32 m0, s24, 2048
    s_add_u32 s23, s21, 32768
    buffer_load_dwordx4 v4, s[8:11], s23 offen lds
    s_add_u32 m0, s24, 3072
    s_add_u32 s23, s21, 49152
    buffer_load_dwordx4 v5, s[8:11], s23 offen lds
    s_add_u32 m0, s24, 32768
    s_add_u32 s23, s22, 0
    buffer_load_dwordx4 v6, s[12:15], s23 offen lds
    s_add_u32 m0, s24, 33792
    s_add_u32 s23, s22, 16384
    buffer_load_dwordx4 v7, s[12:15], s23 offen lds
    s_add_u32 m0, s24, 34816
    s_add_u32 s23, s22, 32768
    buffer_load_dwordx4 v6, s[12:15], s23 offen lds
    s_add_u32 m0, s24, 35840
    s_add_u32 s23, s22, 49152
    buffer_load_dwordx4 v7, s[12:15], s23 offen lds
gs_2:
    ds_read_b128 v[208:211], v9 offset:0
    ds_read_b128 v[212:215], v9 offset:4096
    ds_read_b128 v[216:219], v9 offset:8192
    ds_read_b128 v[220:223], v9 offset:12288
    ds_read_b64_tr_b16 v[232:233], v12 offset:8192
    ds_read_b64_tr_b16 v[234:235], v12 offset:10240
    ds_read_b64_tr_b16 v[236:237], v13 offset:8192
    ds_read_b64_tr_b16 v[238:239], v13 offset:10240
    s_waitcnt lgkmcnt(8)
    v_mfma_f32_32x32x16_bf16 v[64:79], v[224:227], v[192:195], v[64:79]
    v_mfma_f32_32x32x16_bf16 v[80:95], v[228:231], v[192:195], v[80:95]
    v_mfma_f32_32x32x16_bf16 v[96:111], v[224:227], v[196:199], v[96:111]
    v_mfma_f32_32x32x16_bf16 v[112:127], v[228:231], v[196:199], v[112:127]
    v_mfma_f32_32x32x16_bf16 v[128:143], v[224:227], v[200:203], v[128:143]
    v_mfma_f32_32x32x16_bf16 v[144:159], v[228:231], v[200:203], v[144:159]
    v_mfma_f32_32x32x16_bf16 v[160:175], v[224:227], v[204:207], v[160:175]
    v_mfma_f32_32x32x16_bf16 v[176:191], v[228:231], v[204:207], v[176:191]
    ds_read_b128 v[192:195], v10 offset:0
    ds_read_b128 v[196:199], v10 offset:4096
    ds_read_b128 v[200:203], v10 offset:8192
    ds_read_b128 v[204:207], v10 offset:12288
    ds_read_b64_tr_b16 v[224:225], v12 offset:16384
    ds_read_b64_tr_b16 v[226:227], v12 offset:18432
    ds_read_b64_tr_b16 v[228:229], v13 offset:16384
    ds_read_b64_tr_b16 v[230:231], v13 offset:18432
    s_waitcnt lgkmcnt(8)
    v_mfma_f32_32x32x16_bf16 v[64:79], v[232:235], v[208:211], v[64:79]
    v_mfma_f32_32x32x16_bf16 v[80:95], v[236:239], v[208:211], v[80:95]
    v_mfma_f32_32x32x16_bf16 v[96:111], v[232:235], v[212:215], v[96:111]
    v_mfma_f32_32x32x16_bf16 v[112:127], v[236:239], v[212:215], v[112:127]
    v_mfma_f32_32x32x16_bf16 v[128:143], v[232:235], v[216:219], v[128:143]
    v_mfma_f32_32x32x16_bf16 v[144:159], v[236:239], v[216:219], v[144:159]
    v_mfma_f32_32x32x16_bf16 v[160:175], v[232:235], v[220:223], v[160:175]
    v_mfma_f32_32x32x16_bf16 v[176:191], v[236:239], v[220:223], v[176:191]
    ds_read_b128 v[208:211], v11 offset:0
    ds_read_b128 v[212:215], v11 offset:4096
    ds_read_b128 v[216:219], v11 offset:8192
    ds_read_b128 v[220:223], v11 offset:12288
    ds_read_b64_tr_b16 v[232:233], v12 offset:24576
    ds_read_b64_tr_b16 v[234:235], v12 offset:26624
    ds_read_b64_tr_b16 v[236:237], v13 offset:24576
    ds_read_b64_tr_b16 v[238:239], v13 offset:26624
    s_waitcnt lgkmcnt(8)
    v_mfma_f32_32x32x16_bf16 v[64:79], v[224:227], v[192:195], v[64:79]
    v_mfma_f32_32x32x16_bf16 v[80:95], v[228:231], v[192:195], v[80:95]
    v_mfma_f32_32x32x16_bf16 v[96:111], v[224:227], v[196:199], v[96:111]
    v_mfma_f32_32x32x16_bf16 v[112:127], v[228:231], v[196:199], v[112:127]
    v_mfma_f32_32x32x16_bf16 v[128:143], v[224:227], v[200:203], v[128:143]
    v_mfma_f32_32x32x16_bf16 v[144:159], v[228:231], v[200:203], v[144:159]
    v_mfma_f32_32x32x16_bf16 v[160:175], v[224:227], v[204:207], v[160:175]
    v_mfma_f32_32x32x16_bf16 v[176:191], v[228:231], v[204:207], v[176:191]
    s_waitcnt lgkmcnt(0)
    v_mfma_f32_32x32x16_bf16 v[64:79], v[232:235], v[208:211], v[64:79]
    v_mfma_f32_32x32x16_bf16 v[80:95], v[236:239], v[208:211], v[80:95]
    v_mfma_f32_32x32x16_bf16 v[96:111], v[232:235], v[212:215], v[96:111]
    v_mfma_f32_32x32x16_bf16 v[112:127], v[236:239], v[212:215], v[112:127]
    v_mfma_f32_32x32x16_bf16 v[128:143], v[232:235], v[216:219], v[128:143]
    v_mfma_f32_32x32x16_bf16 v[144:159], v[236:239], v[216:219], v[144:159]
    v_mfma_f32_32x32x16_bf16 v[160:175], v[232:235], v[220:223], v[160:175]
    v_mfma_f32_32x32x16_bf16 v[176:191], v[236:239], v[220:223], v[176:191]
    v_xor_b32 v8, 0x10000, v8
    v_xor_b32 v9, 0x10000, v9
    v_xor_b32 v10, 0x10000, v10
    v_xor_b32 v11, 0x10000, v11
    v_xor_b32 v12, 0x10000, v12
    v_xor_b32 v13, 0x10000, v13
    s_cmp_lt_u32 s20, 16
    s_cbranch_scc1 gk_1
    s_nop 15
    s_barrier
    v_and_b32 v3, 31, v2
    v_lshrrev_b32 v14, 5, v2
    s_lshl_b32 s30, s28, 7
    v_add_u32 v3, s30, v3
    v_mul_u32_u24 v3, 528, v3
    v_lshl_add_u32 v3, v14, 3, v3
    s_lshl_b32 s30, s29, 7
    v_add_u32 v3, s30, v3
    v_cvt_pk_bf16_f32 v16, v64, v65
    v_cvt_pk_bf16_f32 v17, v66, v67
    ds_write_b64 v3, v[16:17] offset:0
    v_cvt_pk_bf16_f32 v18, v68, v69
    v_cvt_pk_bf16_f32 v19, v70, v71
    ds_write_b64 v3, v[18:19] offset:16
    v_cvt_pk_bf16_f32 v16, v72, v73
    v_cvt_pk_bf16_f32 v17, v74, v75
    ds_write_b64 v3, v[16:17] offset:32
    v_cvt_pk_bf16_f32 v18, v76, v77
    v_cvt_pk_bf16_f32 v19, v78, v79
    ds_write_b64 v3, v[18:19] offset:48
    v_cvt_pk_bf16_f32 v16, v80, v81
    v_cvt_pk_bf16_f32 v17, v82, v83
    ds_write_b64 v3, v[16:17] offset:64
    v_cvt_pk_bf16_f32 v18, v84, v85
    v_cvt_pk_bf16_f32 v19, v86, v87
    ds_write_b64 v3, v[18:19] offset:80
    v_cvt_pk_bf16_f32 v16, v88, v89
    v_cvt_pk_bf16_f32 v17, v90, v91
    ds_write_b64 v3, v[16:17] offset:96
    v_cvt_pk_bf16_f32 v18, v92, v93
    v_cvt_pk_bf16_f32 v19, v94, v95
    ds_write_b64 v3, v[18:19] offset:112
    v_cvt_pk_bf16_f32 v16, v96, v97
    v_cvt_pk_bf16_f32 v17, v98, v99
    ds_write_b64 v3, v[16:17] offset:16896
    v_cvt_pk_bf16_f32 v18, v100, v101
    v_cvt_pk_bf16_f32 v19, v102, v103
    ds_write_b64 v3, v[18:19] offset:16912
    v_cvt_pk_bf16_f32 v16, v104, v105
    v_cvt_pk_bf16_f32 v17, v106, v107
    ds_write_b64 v3, v[16:17] offset:16928
    v_cvt_pk_bf16_f32 v18, v108, v109
    v_cvt_pk_bf16_f32 v19, v110, v111
    ds_write_b64 v3, v[18:19] offset:16944
    v_cvt_pk_bf16_f32 v16, v112, v113
    v_cvt_pk_bf16_f32 v17, v114, v115
    ds_write_b64 v3, v[16:17] offset:16960
    v_cvt_pk_bf16_f32 v18, v116, v117
    v_cvt_pk_bf16_f32 v19, v118, v119
    ds_write_b64 v3, v[18:19] offset:16976
    v_cvt_pk_bf16_f32 v16, v120, v121
    v_cvt_pk_bf16_f32 v17, v122, v123
    ds_write_b64 v3, v[16:17] offset:16992
    v_cvt_pk_bf16_f32 v18, v124, v125
    v_cvt_pk_bf16_f32 v19, v126, v127
    ds_write_b64 v3, v[18:19] offset:17008
    v_cvt_pk_bf16_f32 v16, v128, v129
    v_cvt_pk_bf16_f32 v17, v130, v131
    ds_write_b64 v3, v[16:17] offset:33792
    v_cvt_pk_bf16_f32 v18, v132, v133
    v_cvt_pk_bf16_f32 v19, v134, v135
    ds_write_b64 v3, v[18:19] offset:33808
    v_cvt_pk_bf16_f32 v16, v136, v137
    v_cvt_pk_bf16_f32 v17, v138, v139
    ds_write_b64 v3, v[16:17] offset:33824
    v_cvt_pk_bf16_f32 v18, v140, v141
    v_cvt_pk_bf16_f32 v19, v142, v143
    ds_write_b64 v3, v[18:19] offset:33840
    v_cvt_pk_bf16_f32 v16, v144, v145
    v_cvt_pk_bf16_f32 v17, v146, v147
    ds_write_b64 v3, v[16:17] offset:33856
    v_cvt_pk_bf16_f32 v18, v148, v149
    v_cvt_pk_bf16_f32 v19, v150, v151
    ds_write_b64 v3, v[18:19] offset:33872
    v_cvt_pk_bf16_f32 v16, v152, v153
    v_cvt_pk_bf16_f32 v17, v154, v155
    ds_write_b64 v3, v[16:17] offset:33888
    v_cvt_pk_bf16_f32 v18, v156, v157
    v_cvt_pk_bf16_f32 v19, v158, v159
    ds_write_b64 v3, v[18:19] offset:33904
    v_cvt_pk_bf16_f32 v16, v160, v161
    v_cvt_pk_bf16_f32 v17, v162, v163
    ds_write_b64 v3, v[16:17] offset:50688
    v_cvt_pk_bf16_f32 v18, v164, v165
    v_cvt_pk_bf16_f32 v19, v166, v167
    ds_write_b64 v3, v[18:19] offset:50704
    v_cvt_pk_bf16_f32 v16, v168, v169
    v_cvt_pk_bf16_f32 v17, v170, v171
    ds_write_b64 v3, v[16:17] offset:50720
    v_cvt_pk_bf16_f32 v18, v172, v173
    v_cvt_pk_bf16_f32 v19, v174, v175
    ds_write_b64 v3, v[18:19] offset:50736
    v_cvt_pk_bf16_f32 v16, v176, v177
    v_cvt_pk_bf16_f32 v17, v178, v179
    ds_write_b64 v3, v[16:17] offset:50752
    v_cvt_pk_bf16_f32 v18, v180, v181
    v_cvt_pk_bf16_f32 v19, v182, v183
    ds_write_b64 v3, v[18:19] offset:50768
    v_cvt_pk_bf16_f32 v16, v184, v185
    v_cvt_pk_bf16_f32 v17, v186, v187
    ds_write_b64 v3, v[16:17] offset:50784
    v_cvt_pk_bf16_f32 v18, v188, v189
    v_cvt_pk_bf16_f32 v19, v190, v191
    ds_write_b64 v3, v[18:19] offset:50800
    s_waitcnt lgkmcnt(0)
    s_barrier
    v_lshrrev_b32 v3, 5, v2
    s_lshl_b32 s30, s25, 5
    v_add_u32 v3, s30, v3
    v_and_b32 v14, 31, v2
    v_mul_u32_u24 v15, 528, v3
    v_lshl_add_u32 v15, v14, 4, v15
    v_add_u32 v3, s26, v3
    s_mov_b32 s31, 8192
    v_mul_lo_u32 v3, v3, s31
    v_lshl_add_u32 v3, v14, 4, v3
    s_lshl_b32 s30, s27, 1
    v_add_u32 v3, s30, v3
    ds_read_b128 v[20:23], v15 offset:0
    ds_read_b128 v[24:27], v15 offset:1056
    ds_read_b128 v[28:31], v15 offset:2112
    ds_read_b128 v[32:35], v15 offset:3168
    s_waitcnt lgkmcnt(3)
    s_mov_b32 s30, 0
    buffer_store_dwordx4 v[20:23], v3, s[16:19], s30 offen
    s_waitcnt lgkmcnt(2)
    s_mov_b32 s30, 16384
    buffer_store_dwordx4 v[24:27], v3, s[16:19], s30 offen
    s_waitcnt lgkmcnt(1)
    s_mov_b32 s30, 32768
    buffer_store_dwordx4 v[28:31], v3, s[16:19], s30 offen
    s_waitcnt lgkmcnt(0)
    s_mov_b32 s30, 49152
    buffer_store_dwordx4 v[32:35], v3, s[16:19], s30 offen
    s_nop 1
    ds_read_b128 v[20:23], v15 offset:4224
    ds_read_b128 v[24:27], v15 offset:5280
    ds_read_b128 v[28:31], v15 offset:6336
    ds_read_b128 v[32:35], v15 offset:7392
    s_waitcnt lgkmcnt(3)
    s_mov_b32 s30, 65536
    buffer_store_dwordx4 v[20:23], v3, s[16:19], s30 offen
    s_waitcnt lgkmcnt(2)
    s_mov_b32 s30, 81920
    buffer_store_dwordx4 v[24:27], v3, s[16:19], s30 offen
    s_waitcnt lgkmcnt(1)
    s_mov_b32 s30, 98304
    buffer_store_dwordx4 v[28:31], v3, s[16:19], s30 offen
    s_waitcnt lgkmcnt(0)
    s_mov_b32 s30, 114688
    buffer_store_dwordx4 v[32:35], v3, s[16:19], s30 offen
    s_nop 1
    ds_read_b128 v[20:23], v15 offset:8448
    ds_read_b128 v[24:27], v15 offset:9504
    ds_read_b128 v[28:31], v15 offset:10560
    ds_read_b128 v[32:35], v15 offset:11616
    s_waitcnt lgkmcnt(3)
    s_mov_b32 s30, 131072
    buffer_store_dwordx4 v[20:23], v3, s[16:19], s30 offen
    s_waitcnt lgkmcnt(2)
    s_mov_b32 s30, 147456
    buffer_store_dwordx4 v[24:27], v3, s[16:19], s30 offen
    s_waitcnt lgkmcnt(1)
    s_mov_b32 s30, 163840
    buffer_store_dwordx4 v[28:31], v3, s[16:19], s30 offen
    s_waitcnt lgkmcnt(0)
    s_mov_b32 s30, 180224
    buffer_store_dwordx4 v[32:35], v3, s[16:19], s30 offen
    s_nop 1
    ds_read_b128 v[20:23], v15 offset:12672
    ds_read_b128 v[24:27], v15 offset:13728
    ds_read_b128 v[28:31], v15 offset:14784
    ds_read_b128 v[32:35], v15 offset:15840
    s_waitcnt lgkmcnt(3)
    s_mov_b32 s30, 196608
    buffer_store_dwordx4 v[20:23], v3, s[16:19], s30 offen
    s_waitcnt lgkmcnt(2)
    s_mov_b32 s30, 212992
    buffer_store_dwordx4 v[24:27], v3, s[16:19], s30 offen
    s_waitcnt lgkmcnt(1)
    s_mov_b32 s30, 229376
    buffer_store_dwordx4 v[28:31], v3, s[16:19], s30 offen
    s_waitcnt lgkmcnt(0)
    s_mov_b32 s30, 245760
    buffer_store_dwordx4 v[32:35], v3, s[16:19], s30 offen
    s_nop 1
    s_endpgm
k1_v:
    s_add_u32 s16, s4, 37748736
    s_addc_u32 s17, s5, 0
    s_mov_b32 s18, 16777216
    s_mov_b32 s19, 0x00020000
    s_and_b32 s28, s25, 1
    s_lshr_b32 s29, s25, 1
    v_lshrrev_b32 v3, 3, v2
    s_lshl_b32 s30, s25, 5
    s_add_u32 s30, s30, s26
    v_add_u32 v3, s30, v3
    s_mov_b32 s31, 2048
    v_mul_lo_u32 v3, v3, s31
    v_and_b32 v14, 7, v2
    v_lshrrev_b32 v15, 4, v2
    v_xor_b32 v16, v14, v15
    v_lshl_add_u32 v4, v16, 4, v3
    v_add_u32 v15, 4, v15
    v_xor_b32 v16, v14, v15
    v_lshl_add_u32 v5, v16, 4, v3
    v_lshrrev_b32 v3, 5, v2
    s_lshl_b32 s30, s25, 3
    v_add_u32 v14, s30, v3
    s_mov_b32 s31, 8192
    v_mul_lo_u32 v14, v14, s31
    s_lshl_b32 s30, s27, 1
    v_add_u32 v14, s30, v14
    v_and_b32 v15, 3, v2
    v_lshl_add_u32 v14, v15, 4, v14
    v_bfe_u32 v15, v2, 2, 3
    v_xor_b32 v16, v15, v3
    v_lshl_add_u32 v6, v16, 6, v14
    v_add_u32 v3, 2, v3
    v_xor_b32 v16, v15, v3
    v_lshl_add_u32 v7, v16, 6, v14
    v_and_b32 v3, 31, v2
    v_lshrrev_b32 v14, 5, v2
    v_bfe_u32 v15, v2, 1, 3
    v_xor_b32 v14, v14, v15
    v_lshlrev_b32 v3, 7, v3
    v_lshl_add_u32 v3, v14, 4, v3
    s_lshl_b32 s30, s28, 14
    v_add_u32 v3, s30, v3
    v_xor_b32 v8, 0, v3
    v_xor_b32 v9, 32, v3
    v_xor_b32 v10, 64, v3
    v_xor_b32 v11, 96, v3
    v_lshrrev_b32 v3, 5, v2
    v_bfe_u32 v14, v2, 2, 2
    v_lshl_add_u32 v3, v3, 3, v14
    v_lshlrev_b32 v3, 9, v3
    v_bfe_u32 v15, v2, 4, 1
    v_lshl_add_u32 v3, v15, 5, v3
    v_and_b32 v15, 3, v2
    v_lshl_add_u32 v3, v15, 3, v3
    v_add_u32 v3, 0x8000, v3
    s_lshl_b32 s30, s29, 1
    s_add_u32 s30, s30, 0
    s_lshr_b32 s31, s30, 2
    s_lshl_b32 s31, s31, 8
    s_and_b32 s30, s30, 3
    v_xor_b32 v15, s30, v14
    v_lshl_add_u32 v15, v15, 6, v3
    v_add_u32 v12, s31, v15
    s_lshl_b32 s30, s29, 1
    s_add_u32 s30, s30, 1
    s_lshr_b32 s31, s30, 2
    s_lshl_b32 s31, s31, 8
    s_and_b32 s30, s30, 3
    v_xor_b32 v15, s30, v14
    v_lshl_add_u32 v15, v15, 6, v3
    v_add_u32 v13, s31, v15
    v_mov_b32 v64, 0
    v_mov_b32 v65, 0
    v_mov_b32 v66, 0
    v_mov_b32 v67, 0
    v_mov_b32 v68, 0
    v_mov_b32 v69, 0
    v_mov_b32 v70, 0
    v_mov_b32 v71, 0
    v_mov_b32 v72, 0
    v_mov_b32 v73, 0
    v_mov_b32 v74, 0
    v_mov_b32 v75, 0
    v_mov_b32 v76, 0
    v_mov_b32 v77, 0
    v_mov_b32 v78, 0
    v_mov_b32 v79, 0
    v_mov_b32 v80, 0
    v_mov_b32 v81, 0
    v_mov_b32 v82, 0
    v_mov_b32 v83, 0
    v_mov_b32 v84, 0
    v_mov_b32 v85, 0
    v_mov_b32 v86, 0
    v_mov_b32 v87, 0
    v_mov_b32 v88, 0
    v_mov_b32 v89, 0
    v_mov_b32 v90, 0
    v_mov_b32 v91, 0
    v_mov_b32 v92, 0
    v_mov_b32 v93, 0
    v_mov_b32 v94, 0
    v_mov_b32 v95, 0
    v_mov_b32 v96, 0
    v_mov_b32 v97, 0
    v_mov_b32 v98, 0
    v_mov_b32 v99, 0
    v_mov_b32 v100, 0
    v_mov_b32 v101, 0
    v_mov_b32 v102, 0
    v_mov_b32 v103, 0
    v_mov_b32 v104, 0
    v_mov_b32 v105, 0
    v_mov_b32 v106, 0
    v_mov_b32 v107, 0
    v_mov_b32 v108, 0
    v_mov_b32 v109, 0
    v_mov_b32 v110, 0
    v_mov_b32 v111, 0
    v_mov_b32 v112, 0
    v_mov_b32 v113, 0
    v_mov_b32 v114, 0
    v_mov_b32 v115, 0
    v_mov_b32 v116, 0
    v_mov_b32 v117, 0
    v_mov_b32 v118, 0
    v_mov_b32 v119, 0
    v_mov_b32 v120, 0
    v_mov_b32 v121, 0
    v_mov_b32 v122, 0
    v_mov_b32 v123, 0
    v_mov_b32 v124, 0
    v_mov_b32 v125, 0
    v_mov_b32 v126, 0
    v_mov_b32 v127, 0
    v_mov_b32 v128, 0
    v_mov_b32 v129, 0
    v_mov_b32 v130, 0
    v_mov_b32 v131, 0
    v_mov_b32 v132, 0
    v_mov_b32 v133, 0
    v_mov_b32 v134, 0
    v_mov_b32 v135, 0
    v_mov_b32 v136, 0
    v_mov_b32 v137, 0
    v_mov_b32 v138, 0
    v_mov_b32 v139, 0
    v_mov_b32 v140, 0
    v_mov_b32 v141, 0
    v_mov_b32 v142, 0
    v_mov_b32 v143, 0
    v_mov_b32 v144, 0
    v_mov_b32 v145, 0
    v_mov_b32 v146, 0
    v_mov_b32 v147, 0
    v_mov_b32 v148, 0
    v_mov_b32 v149, 0
    v_mov_b32 v150, 0
    v_mov_b32 v151, 0
    v_mov_b32 v152, 0
    v_mov_b32 v153, 0
    v_mov_b32 v154, 0
    v_mov_b32 v155, 0
    v_mov_b32 v156, 0
    v_mov_b32 v157, 0
    v_mov_b32 v158, 0
    v_mov_b32 v159, 0
    v_mov_b32 v160, 0
    v_mov_b32 v161, 0
    v_mov_b32 v162, 0
    v_mov_b32 v163, 0
    v_mov_b32 v164, 0
    v_mov_b32 v165, 0
    v_mov_b32 v166, 0
    v_mov_b32 v167, 0
    v_mov_b32 v168, 0
    v_mov_b32 v169, 0
    v_mov_b32 v170, 0
    v_mov_b32 v171, 0
    v_mov_b32 v172, 0
    v_mov_b32 v173, 0
    v_mov_b32 v174, 0
    v_mov_b32 v175, 0
    v_mov_b32 v176, 0
    v_mov_b32 v177, 0
    v_mov_b32 v178, 0
    v_mov_b32 v179, 0
    v_mov_b32 v180, 0
    v_mov_b32 v181, 0
    v_mov_b32 v182, 0
    v_mov_b32 v183, 0
    v_mov_b32 v184, 0
    v_mov_b32 v185, 0
    v_mov_b32 v186, 0
    v_mov_b32 v187, 0
    v_mov_b32 v188, 0
    v_mov_b32 v189, 0
    v_mov_b32 v190, 0
    v_mov_b32 v191, 0
    s_mov_b32 s21, 0
    s_mov_b32 s22, 0
    s_lshl_b32 s24, s25, 12
    s_add_u32 m0, s24, 0
    s_add_u32 s23, s21, 0
    buffer_load_dwordx4 v4, s[8:11], s23 offen lds
    s_add_u32 m0, s24, 1024
    s_add_u32 s23, s21, 16384
    buffer_load_dwordx4 v5, s[8:11], s23 offen lds
    s_add_u32 m0, s24, 2048
    s_add_u32 s23, s21, 32768
    buffer_load_dwordx4 v4, s[8:11], s23 offen lds
    s_add_u32 m0, s24, 3072
    s_add_u32 s23, s21, 49152
    buffer_load_dwordx4 v5, s[8:11], s23 offen lds
    s_add_u32 m0, s24, 32768
    s_add_u32 s23, s22, 0
    buffer_load_dwordx4 v6, s[12:15], s23 offen lds
    s_add_u32 m0, s24, 33792
    s_add_u32 s23, s22, 16384
    buffer_load_dwordx4 v7, s[12:15], s23 offen lds
    s_add_u32 m0, s24, 34816
    s_add_u32 s23, s22, 32768
    buffer_load_dwordx4 v6, s[12:15], s23 offen lds
    s_add_u32 m0, s24, 35840
    s_add_u32 s23, s22, 49152
    buffer_load_dwordx4 v7, s[12:15], s23 offen lds
    s_mov_b32 s20, 0
gk_3:
    s_waitcnt vmcnt(0)
    s_barrier
    ds_read_b128 v[192:195], v8 offset:0
    ds_read_b128 v[196:199], v8 offset:4096
    ds_read_b128 v[200:203], v8 offset:8192
    ds_read_b128 v[204:207], v8 offset:12288
    ds_read_b64_tr_b16 v[224:225], v12 offset:0
    ds_read_b64_tr_b16 v[226:227], v12 offset:2048
    ds_read_b64_tr_b16 v[228:229], v13 offset:0
    ds_read_b64_tr_b16 v[230:231], v13 offset:2048
    s_add_u32 s20, s20, 1
    s_cmp_ge_u32 s20, 16
    s_cbranch_scc1 gs_4
    s_add_u32 s21, s21, 128
    s_add_u32 s22, s22, 524288
    s_xor_b32 s24, s24, 0x10000
    s_add_u32 m0, s24, 0
    s_add_u32 s23, s21, 0
    buffer_load_dwordx4 v4, s[8:11], s23 offen lds
    s_add_u32 m0, s24, 1024
    s_add_u32 s23, s21, 16384
    buffer_load_dwordx4 v5, s[8:11], s23 offen lds
    s_add_u32 m0, s24, 2048
    s_add_u32 s23, s21, 32768
    buffer_load_dwordx4 v4, s[8:11], s23 offen lds
    s_add_u32 m0, s24, 3072
    s_add_u32 s23, s21, 49152
    buffer_load_dwordx4 v5, s[8:11], s23 offen lds
    s_add_u32 m0, s24, 32768
    s_add_u32 s23, s22, 0
    buffer_load_dwordx4 v6, s[12:15], s23 offen lds
    s_add_u32 m0, s24, 33792
    s_add_u32 s23, s22, 16384
    buffer_load_dwordx4 v7, s[12:15], s23 offen lds
    s_add_u32 m0, s24, 34816
    s_add_u32 s23, s22, 32768
    buffer_load_dwordx4 v6, s[12:15], s23 offen lds
    s_add_u32 m0, s24, 35840
    s_add_u32 s23, s22, 49152
    buffer_load_dwordx4 v7, s[12:15], s23 offen lds
gs_4:
    ds_read_b128 v[208:211], v9 offset:0
    ds_read_b128 v[212:215], v9 offset:4096
    ds_read_b128 v[216:219], v9 offset:8192
    ds_read_b128 v[220:223], v9 offset:12288
    ds_read_b64_tr_b16 v[232:233], v12 offset:8192
    ds_read_b64_tr_b16 v[234:235], v12 offset:10240
    ds_read_b64_tr_b16 v[236:237], v13 offset:8192
    ds_read_b64_tr_b16 v[238:239], v13 offset:10240
    s_waitcnt lgkmcnt(8)
    v_mfma_f32_32x32x16_bf16 v[64:79], v[192:195], v[224:227], v[64:79]
    v_mfma_f32_32x32x16_bf16 v[80:95], v[192:195], v[228:231], v[80:95]
    v_mfma_f32_32x32x16_bf16 v[96:111], v[196:199], v[224:227], v[96:111]
    v_mfma_f32_32x32x16_bf16 v[112:127], v[196:199], v[228:231], v[112:127]
    v_mfma_f32_32x32x16_bf16 v[128:143], v[200:203], v[224:227], v[128:143]
    v_mfma_f32_32x32x16_bf16 v[144:159], v[200:203], v[228:231], v[144:159]
    v_mfma_f32_32x32x16_bf16 v[160:175], v[204:207], v[224:227], v[160:175]
    v_mfma_f32_32x32x16_bf16 v[176:191], v[204:207], v[228:231], v[176:191]
    ds_read_b128 v[192:195], v10 offset:0
    ds_read_b128 v[196:199], v10 offset:4096
    ds_read_b128 v[200:203], v10 offset:8192
    ds_read_b128 v[204:207], v10 offset:12288
    ds_read_b64_tr_b16 v[224:225], v12 offset:16384
    ds_read_b64_tr_b16 v[226:227], v12 offset:18432
    ds_read_b64_tr_b16 v[228:229], v13 offset:16384
    ds_read_b64_tr_b16 v[230:231], v13 offset:18432
    s_waitcnt lgkmcnt(8)
    v_mfma_f32_32x32x16_bf16 v[64:79], v[208:211], v[232:235], v[64:79]
    v_mfma_f32_32x32x16_bf16 v[80:95], v[208:211], v[236:239], v[80:95]
    v_mfma_f32_32x32x16_bf16 v[96:111], v[212:215], v[232:235], v[96:111]
    v_mfma_f32_32x32x16_bf16 v[112:127], v[212:215], v[236:239], v[112:127]
    v_mfma_f32_32x32x16_bf16 v[128:143], v[216:219], v[232:235], v[128:143]
    v_mfma_f32_32x32x16_bf16 v[144:159], v[216:219], v[236:239], v[144:159]
    v_mfma_f32_32x32x16_bf16 v[160:175], v[220:223], v[232:235], v[160:175]
    v_mfma_f32_32x32x16_bf16 v[176:191], v[220:223], v[236:239], v[176:191]
    ds_read_b128 v[208:211], v11 offset:0
    ds_read_b128 v[212:215], v11 offset:4096
    ds_read_b128 v[216:219], v11 offset:8192
    ds_read_b128 v[220:223], v11 offset:12288
    ds_read_b64_tr_b16 v[232:233], v12 offset:24576
    ds_read_b64_tr_b16 v[234:235], v12 offset:26624
    ds_read_b64_tr_b16 v[236:237], v13 offset:24576
    ds_read_b64_tr_b16 v[238:239], v13 offset:26624
    s_waitcnt lgkmcnt(8)
    v_mfma_f32_32x32x16_bf16 v[64:79], v[192:195], v[224:227], v[64:79]
    v_mfma_f32_32x32x16_bf16 v[80:95], v[192:195], v[228:231], v[80:95]
    v_mfma_f32_32x32x16_bf16 v[96:111], v[196:199], v[224:227], v[96:111]
    v_mfma_f32_32x32x16_bf16 v[112:127], v[196:199], v[228:231], v[112:127]
    v_mfma_f32_32x32x16_bf16 v[128:143], v[200:203], v[224:227], v[128:143]
    v_mfma_f32_32x32x16_bf16 v[144:159], v[200:203], v[228:231], v[144:159]
    v_mfma_f32_32x32x16_bf16 v[160:175], v[204:207], v[224:227], v[160:175]
    v_mfma_f32_32x32x16_bf16 v[176:191], v[204:207], v[228:231], v[176:191]
    s_waitcnt lgkmcnt(0)
    v_mfma_f32_32x32x16_bf16 v[64:79], v[208:211], v[232:235], v[64:79]
    v_mfma_f32_32x32x16_bf16 v[80:95], v[208:211], v[236:239], v[80:95]
    v_mfma_f32_32x32x16_bf16 v[96:111], v[212:215], v[232:235], v[96:111]
    v_mfma_f32_32x32x16_bf16 v[112:127], v[212:215], v[236:239], v[112:127]
    v_mfma_f32_32x32x16_bf16 v[128:143], v[216:219], v[232:235], v[128:143]
    v_mfma_f32_32x32x16_bf16 v[144:159], v[216:219], v[236:239], v[144:159]
    v_mfma_f32_32x32x16_bf16 v[160:175], v[220:223], v[232:235], v[160:175]
    v_mfma_f32_32x32x16_bf16 v[176:191], v[220:223], v[236:239], v[176:191]
    v_xor_b32 v8, 0x10000, v8
    v_xor_b32 v9, 0x10000, v9
    v_xor_b32 v10, 0x10000, v10
    v_xor_b32 v11, 0x10000, v11
    v_xor_b32 v12, 0x10000, v12
    v_xor_b32 v13, 0x10000, v13
    s_cmp_lt_u32 s20, 16
    s_cbranch_scc1 gk_3
    s_nop 15
    s_barrier
    v_and_b32 v3, 31, v2
    v_lshrrev_b32 v14, 5, v2
    s_lshl_b32 s30, s29, 6
    v_add_u32 v3, s30, v3
    v_mul_u32_u24 v3, 528, v3
    v_lshl_add_u32 v3, v14, 4, v3
    s_lshl_b32 s30, s28, 8
    v_add_u32 v3, s30, v3
    v_cvt_pk_bf16_f32 v16, v64, v65
    v_cvt_pk_bf16_f32 v17, v66, v67
    ds_write_b64 v3, v[16:17] offset:0
    v_cvt_pk_bf16_f32 v18, v68, v69
    v_cvt_pk_bf16_f32 v19, v70, v71
    ds_write_b64 v3, v[18:19] offset:8
    v_cvt_pk_bf16_f32 v16, v72, v73
    v_cvt_pk_bf16_f32 v17, v74, v75
    ds_write_b64 v3, v[16:17] offset:32
    v_cvt_pk_bf16_f32 v18, v76, v77
    v_cvt_pk_bf16_f32 v19, v78, v79
    ds_write_b64 v3, v[18:19] offset:40
    v_cvt_pk_bf16_f32 v16, v80, v81
    v_cvt_pk_bf16_f32 v17, v82, v83
    ds_write_b64 v3, v[16:17] offset:16896
    v_cvt_pk_bf16_f32 v18, v84, v85
    v_cvt_pk_bf16_f32 v19, v86, v87
    ds_write_b64 v3, v[18:19] offset:16904
    v_cvt_pk_bf16_f32 v16, v88, v89
    v_cvt_pk_bf16_f32 v17, v90, v91
    ds_write_b64 v3, v[16:17] offset:16928
    v_cvt_pk_bf16_f32 v18, v92, v93
    v_cvt_pk_bf16_f32 v19, v94, v95
    ds_write_b64 v3, v[18:19] offset:16936
    v_cvt_pk_bf16_f32 v16, v96, v97
    v_cvt_pk_bf16_f32 v17, v98, v99
    ds_write_b64 v3, v[16:17] offset:64
    v_cvt_pk_bf16_f32 v18, v100, v101
    v_cvt_pk_bf16_f32 v19, v102, v103
    ds_write_b64 v3, v[18:19] offset:72
    v_cvt_pk_bf16_f32 v16, v104, v105
    v_cvt_pk_bf16_f32 v17, v106, v107
    ds_write_b64 v3, v[16:17] offset:96
    v_cvt_pk_bf16_f32 v18, v108, v109
    v_cvt_pk_bf16_f32 v19, v110, v111
    ds_write_b64 v3, v[18:19] offset:104
    v_cvt_pk_bf16_f32 v16, v112, v113
    v_cvt_pk_bf16_f32 v17, v114, v115
    ds_write_b64 v3, v[16:17] offset:16960
    v_cvt_pk_bf16_f32 v18, v116, v117
    v_cvt_pk_bf16_f32 v19, v118, v119
    ds_write_b64 v3, v[18:19] offset:16968
    v_cvt_pk_bf16_f32 v16, v120, v121
    v_cvt_pk_bf16_f32 v17, v122, v123
    ds_write_b64 v3, v[16:17] offset:16992
    v_cvt_pk_bf16_f32 v18, v124, v125
    v_cvt_pk_bf16_f32 v19, v126, v127
    ds_write_b64 v3, v[18:19] offset:17000
    v_cvt_pk_bf16_f32 v16, v128, v129
    v_cvt_pk_bf16_f32 v17, v130, v131
    ds_write_b64 v3, v[16:17] offset:128
    v_cvt_pk_bf16_f32 v18, v132, v133
    v_cvt_pk_bf16_f32 v19, v134, v135
    ds_write_b64 v3, v[18:19] offset:136
    v_cvt_pk_bf16_f32 v16, v136, v137
    v_cvt_pk_bf16_f32 v17, v138, v139
    ds_write_b64 v3, v[16:17] offset:160
    v_cvt_pk_bf16_f32 v18, v140, v141
    v_cvt_pk_bf16_f32 v19, v142, v143
    ds_write_b64 v3, v[18:19] offset:168
    v_cvt_pk_bf16_f32 v16, v144, v145
    v_cvt_pk_bf16_f32 v17, v146, v147
    ds_write_b64 v3, v[16:17] offset:17024
    v_cvt_pk_bf16_f32 v18, v148, v149
    v_cvt_pk_bf16_f32 v19, v150, v151
    ds_write_b64 v3, v[18:19] offset:17032
    v_cvt_pk_bf16_f32 v16, v152, v153
    v_cvt_pk_bf16_f32 v17, v154, v155
    ds_write_b64 v3, v[16:17] offset:17056
    v_cvt_pk_bf16_f32 v18, v156, v157
    v_cvt_pk_bf16_f32 v19, v158, v159
    ds_write_b64 v3, v[18:19] offset:17064
    v_cvt_pk_bf16_f32 v16, v160, v161
    v_cvt_pk_bf16_f32 v17, v162, v163
    ds_write_b64 v3, v[16:17] offset:192
    v_cvt_pk_bf16_f32 v18, v164, v165
    v_cvt_pk_bf16_f32 v19, v166, v167
    ds_write_b64 v3, v[18:19] offset:200
    v_cvt_pk_bf16_f32 v16, v168, v169
    v_cvt_pk_bf16_f32 v17, v170, v171
    ds_write_b64 v3, v[16:17] offset:224
    v_cvt_pk_bf16_f32 v18, v172, v173
    v_cvt_pk_bf16_f32 v19, v174, v175
    ds_write_b64 v3, v[18:19] offset:232
    v_cvt_pk_bf16_f32 v16, v176, v177
    v_cvt_pk_bf16_f32 v17, v178, v179
    ds_write_b64 v3, v[16:17] offset:17088
    v_cvt_pk_bf16_f32 v18, v180, v181
    v_cvt_pk_bf16_f32 v19, v182, v183
    ds_write_b64 v3, v[18:19] offset:17096
    v_cvt_pk_bf16_f32 v16, v184, v185
    v_cvt_pk_bf16_f32 v17, v186, v187
    ds_write_b64 v3, v[16:17] offset:17120
    v_cvt_pk_bf16_f32 v18, v188, v189
    v_cvt_pk_bf16_f32 v19, v190, v191
    ds_write_b64 v3, v[18:19] offset:17128
    s_waitcnt lgkmcnt(0)
    s_barrier
    v_lshrrev_b32 v3, 5, v2
    s_lshl_b32 s30, s25, 5
    v_add_u32 v3, s30, v3
    v_and_b32 v14, 31, v2
    v_mul_u32_u24 v15, 528, v3
    v_lshl_add_u32 v15, v14, 4, v15
    v_add_u32 v3, s27, v3
    s_mov_b32 s31, 4096
    v_mul_lo_u32 v3, v3, s31
    v_lshl_add_u32 v3, v14, 4, v3
    s_lshl_b32 s30, s26, 1
    v_add_u32 v3, s30, v3
    ds_read_b128 v[20:23], v15 offset:0
    ds_read_b128 v[24:27], v15 offset:1056
    ds_read_b128 v[28:31], v15 offset:2112
    ds_read_b128 v[32:35], v15 offset:3168
    s_waitcnt lgkmcnt(3)
    s_mov_b32 s30, 0
    buffer_store_dwordx4 v[20:23], v3, s[16:19], s30 offen
    s_waitcnt lgkmcnt(2)
    s_mov_b32 s30, 8192
    buffer_store_dwordx4 v[24:27], v3, s[16:19], s30 offen
    s_waitcnt lgkmcnt(1)
    s_mov_b32 s30, 16384
    buffer_store_dwordx4 v[28:31], v3, s[16:19], s30 offen
    s_waitcnt lgkmcnt(0)
    s_mov_b32 s30, 24576
    buffer_store_dwordx4 v[32:35], v3, s[16:19], s30 offen
    s_nop 1
    ds_read_b128 v[20:23], v15 offset:4224
    ds_read_b128 v[24:27], v15 offset:5280
    ds_read_b128 v[28:31], v15 offset:6336
    ds_read_b128 v[32:35], v15 offset:7392
    s_waitcnt lgkmcnt(3)
    s_mov_b32 s30, 32768
    buffer_store_dwordx4 v[20:23], v3, s[16:19], s30 offen
    s_waitcnt lgkmcnt(2)
    s_mov_b32 s30, 40960
    buffer_store_dwordx4 v[24:27], v3, s[16:19], s30 offen
    s_waitcnt lgkmcnt(1)
    s_mov_b32 s30, 49152
    buffer_store_dwordx4 v[28:31], v3, s[16:19], s30 offen
    s_waitcnt lgkmcnt(0)
    s_mov_b32 s30, 57344
    buffer_store_dwordx4 v[32:35], v3, s[16:19], s30 offen
    s_nop 1
    ds_read_b128 v[20:23], v15 offset:8448
    ds_read_b128 v[24:27], v15 offset:9504
    ds_read_b128 v[28:31], v15 offset:10560
    ds_read_b128 v[32:35], v15 offset:11616
    s_waitcnt lgkmcnt(3)
    s_mov_b32 s30, 65536
    buffer_store_dwordx4 v[20:23], v3, s[16:19], s30 offen
    s_waitcnt lgkmcnt(2)
    s_mov_b32 s30, 73728
    buffer_store_dwordx4 v[24:27], v3, s[16:19], s30 offen
    s_waitcnt lgkmcnt(1)
    s_mov_b32 s30, 81920
    buffer_store_dwordx4 v[28:31], v3, s[16:19], s30 offen
    s_waitcnt lgkmcnt(0)
    s_mov_b32 s30, 90112
    buffer_store_dwordx4 v[32:35], v3, s[16:19], s30 offen
    s_nop 1
    ds_read_b128 v[20:23], v15 offset:12672
    ds_read_b128 v[24:27], v15 offset:13728
    ds_read_b128 v[28:31], v15 offset:14784
    ds_read_b128 v[32:35], v15 offset:15840
    s_waitcnt lgkmcnt(3)
    s_mov_b32 s30, 98304
    buffer_store_dwordx4 v[20:23], v3, s[16:19], s30 offen
    s_waitcnt lgkmcnt(2)
    s_mov_b32 s30, 106496
    buffer_store_dwordx4 v[24:27], v3, s[16:19], s30 offen
    s_waitcnt lgkmcnt(1)
    s_mov_b32 s30, 114688
    buffer_store_dwordx4 v[28:31], v3, s[16:19], s30 offen
    s_waitcnt lgkmcnt(0)
    s_mov_b32 s30, 122880
    buffer_store_dwordx4 v[32:35], v3, s[16:19], s30 offen
    s_nop 1
    s_endpgm
k1_ln:
    s_load_dwordx2 s[6:7], s[0:1], 0
    s_sub_u32 s30, s2, 256
    s_lshl_b32 s30, s30, 3
    s_add_u32 s30, s30, s25
    s_lshl_b32 s30, s30, 3
    s_mul_i32 s30, s30, 896
    s_waitcnt lgkmcnt(0)
    s_mov_b32 s8, s6
    s_mov_b32 s9, s7
    s_mov_b32 s10, 1835008
    s_mov_b32 s11, 0x00020000
    s_mov_b32 s16, s4
    s_mov_b32 s17, s5
    s_mov_b32 s18, 1835008
    s_mov_b32 s19, 0x00020000
    v_lshlrev_b32 v3, 4, v2
    v_cmp_gt_u32 vcc, 56, v2
    s_and_saveexec_b64 s[40:41], vcc
    s_add_u32 s43, s30, 0
    buffer_load_dwordx4 v[64:67], v3, s[8:11], s43 offen
    s_add_u32 s43, s30, 896
    buffer_load_dwordx4 v[68:71], v3, s[8:11], s43 offen
    s_add_u32 s43, s30, 1792
    buffer_load_dwordx4 v[72:75], v3, s[8:11], s43 offen
    s_add_u32 s43, s30, 2688
    buffer_load_dwordx4 v[76:79], v3, s[8:11], s43 offen
    s_add_u32 s43, s30, 3584
    buffer_load_dwordx4 v[80:83], v3, s[8:11], s43 offen
    s_add_u32 s43, s30, 4480
    buffer_load_dwordx4 v[84:87], v3, s[8:11], s43 offen
    s_add_u32 s43, s30, 5376
    buffer_load_dwordx4 v[88:91], v3, s[8:11], s43 offen
    s_add_u32 s43, s30, 6272
    buffer_load_dwordx4 v[92:95], v3, s[8:11], s43 offen
    s_mov_b64 exec, s[40:41]
    s_mov_b32 s31, 0xffff0000
    s_waitcnt vmcnt(7)
    v_lshlrev_b32 v16, 16, v64
    v_and_b32 v17, s31, v64
    v_lshlrev_b32 v18, 16, v65
    v_and_b32 v19, s31, v65
    v_lshlrev_b32 v20, 16, v66
    v_and_b32 v21, s31, v66
    v_lshlrev_b32 v22, 16, v67
    v_and_b32 v23, s31, v67
    s_nop 0
    v_cndmask_b32 v16, 0, v16, vcc
    v_cndmask_b32 v17, 0, v17, vcc
    v_cndmask_b32 v18, 0, v18, vcc
    v_cndmask_b32 v19, 0, v19, vcc
    v_cndmask_b32 v20, 0, v20, vcc
    v_cndmask_b32 v21, 0, v21, vcc
    v_cndmask_b32 v22, 0, v22, vcc
    v_cndmask_b32 v23, 0, v23, vcc
    v_add_f32 v24, v16, v17
    v_add_f32 v24, v24, v18
    v_add_f32 v24, v24, v19
    v_add_f32 v24, v24, v20
    v_add_f32 v24, v24, v21
    v_add_f32 v24, v24, v22
    v_add_f32 v24, v24, v23
    s_nop 1
    v_add_f32_dpp v24, v24, v24 row_shr:1 row_mask:0xf bank_mask:0xf
    s_nop 1
    v_add_f32_dpp v24, v24, v24 row_shr:2 row_mask:0xf bank_mask:0xf
    s_nop 1
    v_add_f32_dpp v24, v24, v24 row_shr:4 row_mask:0xf bank_mask:0xf
    s_nop 1
    v_add_f32_dpp v24, v24, v24 row_shr:8 row_mask:0xf bank_mask:0xf
    s_nop 1
    v_add_f32_dpp v24, v24, v24 row_bcast:15 row_mask:0xa bank_mask:0xf
    s_nop 1
    v_add_f32_dpp v24, v24, v24 row_bcast:31 row_mask:0xc bank_mask:0xf
    s_nop 1
    v_readlane_b32 s42, v24, 63
    s_nop 1
    v_mov_b32 v25, s42
    v_mul_f32 v25, 0x3b124925, v25
    v_sub_f32 v32, v16, v25
    v_cndmask_b32 v32, 0, v32, vcc
    v_sub_f32 v33, v17, v25
    v_cndmask_b32 v33, 0, v33, vcc
    v_sub_f32 v34, v18, v25
    v_cndmask_b32 v34, 0, v34, vcc
    v_sub_f32 v35, v19, v25
    v_cndmask_b32 v35, 0, v35, vcc
    v_sub_f32 v36, v20, v25
    v_cndmask_b32 v36, 0, v36, vcc
    v_sub_f32 v37, v21, v25
    v_cndmask_b32 v37, 0, v37, vcc
    v_sub_f32 v38, v22, v25
    v_cndmask_b32 v38, 0, v38, vcc
    v_sub_f32 v39, v23, v25
    v_cndmask_b32 v39, 0, v39, vcc
    v_mul_f32 v24, v32, v32
    v_fmac_f32 v24, v33, v33
    v_fmac_f32 v24, v34, v34
    v_fmac_f32 v24, v35, v35
    v_fmac_f32 v24, v36, v36
    v_fmac_f32 v24, v37, v37
    v_fmac_f32 v24, v38, v38
    v_fmac_f32 v24, v39, v39
    s_nop 1
    v_add_f32_dpp v24, v24, v24 row_shr:1 row_mask:0xf bank_mask:0xf
    s_nop 1
    v_add_f32_dpp v24, v24, v24 row_shr:2 row_mask:0xf bank_mask:0xf
    s_nop 1
    v_add_f32_dpp v24, v24, v24 row_shr:4 row_mask:0xf bank_mask:0xf
    s_nop 1
    v_add_f32_dpp v24, v24, v24 row_shr:8 row_mask:0xf bank_mask:0xf
    s_nop 1
    v_add_f32_dpp v24, v24, v24 row_bcast:15 row_mask:0xa bank_mask:0xf
    s_nop 1
    v_add_f32_dpp v24, v24, v24 row_bcast:31 row_mask:0xc bank_mask:0xf
    s_nop 1
    v_readlane_b32 s42, v24, 63
    s_nop 1
    v_mov_b32 v26, s42
    v_mul_f32 v26, 0x3b124925, v26
    v_cvt_pk_bf16_f32 v27, v25, v25
    v_lshlrev_b32 v25, 16, v27
    v_cvt_pk_bf16_f32 v27, v26, v26
    v_lshlrev_b32 v26, 16, v27
    v_add_f32 v26, 0x3727c5ac, v26
    v_cvt_pk_bf16_f32 v27, v26, v26
    v_lshlrev_b32 v26, 16, v27
    v_sqrt_f32 v26, v26
    s_nop 0
    v_cvt_pk_bf16_f32 v27, v26, v26
    v_lshlrev_b32 v26, 16, v27
    v_rcp_f32 v28, v26
    s_nop 0
    v_sub_f32 v32, v16, v25
    v_sub_f32 v33, v17, v25
    v_sub_f32 v34, v18, v25
    v_sub_f32 v35, v19, v25
    v_sub_f32 v36, v20, v25
    v_sub_f32 v37, v21, v25
    v_sub_f32 v38, v22, v25
    v_sub_f32 v39, v23, v25
    v_cvt_pk_bf16_f32 v40, v32, v33
    v_cvt_pk_bf16_f32 v41, v34, v35
    v_cvt_pk_bf16_f32 v42, v36, v37
    v_cvt_pk_bf16_f32 v43, v38, v39
    v_lshlrev_b32 v32, 16, v40
    v_and_b32 v33, s31, v40
    v_lshlrev_b32 v34, 16, v41
    v_and_b32 v35, s31, v41
    v_lshlrev_b32 v36, 16, v42
    v_and_b32 v37, s31, v42
    v_lshlrev_b32 v38, 16, v43
    v_and_b32 v39, s31, v43
    v_mul_f32 v48, v32, v28
    v_fma_f32 v56, -v48, v26, v32
    v_fmac_f32 v48, v56, v28
    v_mul_f32 v49, v33, v28
    v_fma_f32 v56, -v49, v26, v33
    v_fmac_f32 v49, v56, v28
    v_mul_f32 v50, v34, v28
    v_fma_f32 v56, -v50, v26, v34
    v_fmac_f32 v50, v56, v28
    v_mul_f32 v51, v35, v28
    v_fma_f32 v56, -v51, v26, v35
    v_fmac_f32 v51, v56, v28
    v_mul_f32 v52, v36, v28
    v_fma_f32 v56, -v52, v26, v36
    v_fmac_f32 v52, v56, v28
    v_mul_f32 v53, v37, v28
    v_fma_f32 v56, -v53, v26, v37
    v_fmac_f32 v53, v56, v28
    v_mul_f32 v54, v38, v28
    v_fma_f32 v56, -v54, v26, v38
    v_fmac_f32 v54, v56, v28
    v_mul_f32 v55, v39, v28
    v_fma_f32 v56, -v55, v26, v39
    v_fmac_f32 v55, v56, v28
    v_cvt_pk_bf16_f32 v40, v48, v49
    v_cvt_pk_bf16_f32 v41, v50, v51
    v_cvt_pk_bf16_f32 v42, v52, v53
    v_cvt_pk_bf16_f32 v43, v54, v55
    s_and_saveexec_b64 s[40:41], vcc
    s_add_u32 s43, s30, 0
    buffer_store_dwordx4 v[40:43], v3, s[16:19], s43 offen
    s_mov_b64 exec, s[40:41]
    s_nop 1
    s_waitcnt vmcnt(6)
    v_lshlrev_b32 v16, 16, v68
    v_and_b32 v17, s31, v68
    v_lshlrev_b32 v18, 16, v69
    v_and_b32 v19, s31, v69
    v_lshlrev_b32 v20, 16, v70
    v_and_b32 v21, s31, v70
    v_lshlrev_b32 v22, 16, v71
    v_and_b32 v23, s31, v71
    s_nop 0
    v_cndmask_b32 v16, 0, v16, vcc
    v_cndmask_b32 v17, 0, v17, vcc
    v_cndmask_b32 v18, 0, v18, vcc
    v_cndmask_b32 v19, 0, v19, vcc
    v_cndmask_b32 v20, 0, v20, vcc
    v_cndmask_b32 v21, 0, v21, vcc
    v_cndmask_b32 v22, 0, v22, vcc
    v_cndmask_b32 v23, 0, v23, vcc
    v_add_f32 v24, v16, v17
    v_add_f32 v24, v24, v18
    v_add_f32 v24, v24, v19
    v_add_f32 v24, v24, v20
    v_add_f32 v24, v24, v21
    v_add_f32 v24, v24, v22
    v_add_f32 v24, v24, v23
    s_nop 1
    v_add_f32_dpp v24, v24, v24 row_shr:1 row_mask:0xf bank_mask:0xf
    s_nop 1
    v_add_f32_dpp v24, v24, v24 row_shr:2 row_mask:0xf bank_mask:0xf
    s_nop 1
    v_add_f32_dpp v24, v24, v24 row_shr:4 row_mask:0xf bank_mask:0xf
    s_nop 1
    v_add_f32_dpp v24, v24, v24 row_shr:8 row_mask:0xf bank_mask:0xf
    s_nop 1
    v_add_f32_dpp v24, v24, v24 row_bcast:15 row_mask:0xa bank_mask:0xf
    s_nop 1
    v_add_f32_dpp v24, v24, v24 row_bcast:31 row_mask:0xc bank_mask:0xf
    s_nop 1
    v_readlane_b32 s42, v24, 63
    s_nop 1
    v_mov_b32 v25, s42
    v_mul_f32 v25, 0x3b124925, v25
    v_sub_f32 v32, v16, v25
    v_cndmask_b32 v32, 0, v32, vcc
    v_sub_f32 v33, v17, v25
    v_cndmask_b32 v33, 0, v33, vcc
    v_sub_f32 v34, v18, v25
    v_cndmask_b32 v34, 0, v34, vcc
    v_sub_f32 v35, v19, v25
    v_cndmask_b32 v35, 0, v35, vcc
    v_sub_f32 v36, v20, v25
    v_cndmask_b32 v36, 0, v36, vcc
    v_sub_f32 v37, v21, v25
    v_cndmask_b32 v37, 0, v37, vcc
    v_sub_f32 v38, v22, v25
    v_cndmask_b32 v38, 0, v38, vcc
    v_sub_f32 v39, v23, v25
    v_cndmask_b32 v39, 0, v39, vcc
    v_mul_f32 v24, v32, v32
    v_fmac_f32 v24, v33, v33
    v_fmac_f32 v24, v34, v34
    v_fmac_f32 v24, v35, v35
    v_fmac_f32 v24, v36, v36
    v_fmac_f32 v24, v37, v37
    v_fmac_f32 v24, v38, v38
    v_fmac_f32 v24, v39, v39
    s_nop 1
    v_add_f32_dpp v24, v24, v24 row_shr:1 row_mask:0xf bank_mask:0xf
    s_nop 1
    v_add_f32_dpp v24, v24, v24 row_shr:2 row_mask:0xf bank_mask:0xf
    s_nop 1
    v_add_f32_dpp v24, v24, v24 row_shr:4 row_mask:0xf bank_mask:0xf
    s_nop 1
    v_add_f32_dpp v24, v24, v24 row_shr:8 row_mask:0xf bank_mask:0xf
    s_nop 1
    v_add_f32_dpp v24, v24, v24 row_bcast:15 row_mask:0xa bank_mask:0xf
    s_nop 1
    v_add_f32_dpp v24, v24, v24 row_bcast:31 row_mask:0xc bank_mask:0xf
    s_nop 1
    v_readlane_b32 s42, v24, 63
    s_nop 1
    v_mov_b32 v26, s42
    v_mul_f32 v26, 0x3b124925, v26
    v_cvt_pk_bf16_f32 v27, v25, v25
    v_lshlrev_b32 v25, 16, v27
    v_cvt_pk_bf16_f32 v27, v26, v26
    v_lshlrev_b32 v26, 16, v27
    v_add_f32 v26, 0x3727c5ac, v26
    v_cvt_pk_bf16_f32 v27, v26, v26
    v_lshlrev_b32 v26, 16, v27
    v_sqrt_f32 v26, v26
    s_nop 0
    v_cvt_pk_bf16_f32 v27, v26, v26
    v_lshlrev_b32 v26, 16, v27
    v_rcp_f32 v28, v26
    s_nop 0
    v_sub_f32 v32, v16, v25
    v_sub_f32 v33, v17, v25
    v_sub_f32 v34, v18, v25
    v_sub_f32 v35, v19, v25
    v_sub_f32 v36, v20, v25
    v_sub_f32 v37, v21, v25
    v_sub_f32 v38, v22, v25
    v_sub_f32 v39, v23, v25
    v_cvt_pk_bf16_f32 v40, v32, v33
    v_cvt_pk_bf16_f32 v41, v34, v35
    v_cvt_pk_bf16_f32 v42, v36, v37
    v_cvt_pk_bf16_f32 v43, v38, v39
    v_lshlrev_b32 v32, 16, v40
    v_and_b32 v33, s31, v40
    v_lshlrev_b32 v34, 16, v41
    v_and_b32 v35, s31, v41
    v_lshlrev_b32 v36, 16, v42
    v_and_b32 v37, s31, v42
    v_lshlrev_b32 v38, 16, v43
    v_and_b32 v39, s31, v43
    v_mul_f32 v48, v32, v28
    v_fma_f32 v56, -v48, v26, v32
    v_fmac_f32 v48, v56, v28
    v_mul_f32 v49, v33, v28
    v_fma_f32 v56, -v49, v26, v33
    v_fmac_f32 v49, v56, v28
    v_mul_f32 v50, v34, v28
    v_fma_f32 v56, -v50, v26, v34
    v_fmac_f32 v50, v56, v28
    v_mul_f32 v51, v35, v28
    v_fma_f32 v56, -v51, v26, v35
    v_fmac_f32 v51, v56, v28
    v_mul_f32 v52, v36, v28
    v_fma_f32 v56, -v52, v26, v36
    v_fmac_f32 v52, v56, v28
    v_mul_f32 v53, v37, v28
    v_fma_f32 v56, -v53, v26, v37
    v_fmac_f32 v53, v56, v28
    v_mul_f32 v54, v38, v28
    v_fma_f32 v56, -v54, v26, v38
    v_fmac_f32 v54, v56, v28
    v_mul_f32 v55, v39, v28
    v_fma_f32 v56, -v55, v26, v39
    v_fmac_f32 v55, v56, v28
    v_cvt_pk_bf16_f32 v40, v48, v49
    v_cvt_pk_bf16_f32 v41, v50, v51
    v_cvt_pk_bf16_f32 v42, v52, v53
    v_cvt_pk_bf16_f32 v43, v54, v55
    s_and_saveexec_b64 s[40:41], vcc
    s_add_u32 s43, s30, 896
    buffer_store_dwordx4 v[40:43], v3, s[16:19], s43 offen
    s_mov_b64 exec, s[40:41]
    s_nop 1
    s_waitcnt vmcnt(5)
    v_lshlrev_b32 v16, 16, v72
    v_and_b32 v17, s31, v72
    v_lshlrev_b32 v18, 16, v73
    v_and_b32 v19, s31, v73
    v_lshlrev_b32 v20, 16, v74
    v_and_b32 v21, s31, v74
    v_lshlrev_b32 v22, 16, v75
    v_and_b32 v23, s31, v75
    s_nop 0
    v_cndmask_b32 v16, 0, v16, vcc
    v_cndmask_b32 v17, 0, v17, vcc
    v_cndmask_b32 v18, 0, v18, vcc
    v_cndmask_b32 v19, 0, v19, vcc
    v_cndmask_b32 v20, 0, v20, vcc
    v_cndmask_b32 v21, 0, v21, vcc
    v_cndmask_b32 v22, 0, v22, vcc
    v_cndmask_b32 v23, 0, v23, vcc
    v_add_f32 v24, v16, v17
    v_add_f32 v24, v24, v18
    v_add_f32 v24, v24, v19
    v_add_f32 v24, v24, v20
    v_add_f32 v24, v24, v21
    v_add_f32 v24, v24, v22
    v_add_f32 v24, v24, v23
    s_nop 1
    v_add_f32_dpp v24, v24, v24 row_shr:1 row_mask:0xf bank_mask:0xf
    s_nop 1
    v_add_f32_dpp v24, v24, v24 row_shr:2 row_mask:0xf bank_mask:0xf
    s_nop 1
    v_add_f32_dpp v24, v24, v24 row_shr:4 row_mask:0xf bank_mask:0xf
    s_nop 1
    v_add_f32_dpp v24, v24, v24 row_shr:8 row_mask:0xf bank_mask:0xf
    s_nop 1
    v_add_f32_dpp v24, v24, v24 row_bcast:15 row_mask:0xa bank_mask:0xf
    s_nop 1
    v_add_f32_dpp v24, v24, v24 row_bcast:31 row_mask:0xc bank_mask:0xf
    s_nop 1
    v_readlane_b32 s42, v24, 63
    s_nop 1
    v_mov_b32 v25, s42
    v_mul_f32 v25, 0x3b124925, v25
    v_sub_f32 v32, v16, v25
    v_cndmask_b32 v32, 0, v32, vcc
    v_sub_f32 v33, v17, v25
    v_cndmask_b32 v33, 0, v33, vcc
    v_sub_f32 v34, v18, v25
    v_cndmask_b32 v34, 0, v34, vcc
    v_sub_f32 v35, v19, v25
    v_cndmask_b32 v35, 0, v35, vcc
    v_sub_f32 v36, v20, v25
    v_cndmask_b32 v36, 0, v36, vcc
    v_sub_f32 v37, v21, v25
    v_cndmask_b32 v37, 0, v37, vcc
    v_sub_f32 v38, v22, v25
    v_cndmask_b32 v38, 0, v38, vcc
    v_sub_f32 v39, v23, v25
    v_cndmask_b32 v39, 0, v39, vcc
    v_mul_f32 v24, v32, v32
    v_fmac_f32 v24, v33, v33
    v_fmac_f32 v24, v34, v34
    v_fmac_f32 v24, v35, v35
    v_fmac_f32 v24, v36, v36
    v_fmac_f32 v24, v37, v37
    v_fmac_f32 v24, v38, v38
    v_fmac_f32 v24, v39, v39
    s_nop 1
    v_add_f32_dpp v24, v24, v24 row_shr:1 row_mask:0xf bank_mask:0xf
    s_nop 1
    v_add_f32_dpp v24, v24, v24 row_shr:2 row_mask:0xf bank_mask:0xf
    s_nop 1
    v_add_f32_dpp v24, v24, v24 row_shr:4 row_mask:0xf bank_mask:0xf
    s_nop 1
    v_add_f32_dpp v24, v24, v24 row_shr:8 row_mask:0xf bank_mask:0xf
    s_nop 1
    v_add_f32_dpp v24, v24, v24 row_bcast:15 row_mask:0xa bank_mask:0xf
    s_nop 1
    v_add_f32_dpp v24, v24, v24 row_bcast:31 row_mask:0xc bank_mask:0xf
    s_nop 1
    v_readlane_b32 s42, v24, 63
    s_nop 1
    v_mov_b32 v26, s42
    v_mul_f32 v26, 0x3b124925, v26
    v_cvt_pk_bf16_f32 v27, v25, v25
    v_lshlrev_b32 v25, 16, v27
    v_cvt_pk_bf16_f32 v27, v26, v26
    v_lshlrev_b32 v26, 16, v27
    v_add_f32 v26, 0x3727c5ac, v26
    v_cvt_pk_bf16_f32 v27, v26, v26
    v_lshlrev_b32 v26, 16, v27
    v_sqrt_f32 v26, v26
    s_nop 0
    v_cvt_pk_bf16_f32 v27, v26, v26
    v_lshlrev_b32 v26, 16, v27
    v_rcp_f32 v28, v26
    s_nop 0
    v_sub_f32 v32, v16, v25
    v_sub_f32 v33, v17, v25
    v_sub_f32 v34, v18, v25
    v_sub_f32 v35, v19, v25
    v_sub_f32 v36, v20, v25
    v_sub_f32 v37, v21, v25
    v_sub_f32 v38, v22, v25
    v_sub_f32 v39, v23, v25
    v_cvt_pk_bf16_f32 v40, v32, v33
    v_cvt_pk_bf16_f32 v41, v34, v35
    v_cvt_pk_bf16_f32 v42, v36, v37
    v_cvt_pk_bf16_f32 v43, v38, v39
    v_lshlrev_b32 v32, 16, v40
    v_and_b32 v33, s31, v40
    v_lshlrev_b32 v34, 16, v41
    v_and_b32 v35, s31, v41
    v_lshlrev_b32 v36, 16, v42
    v_and_b32 v37, s31, v42
    v_lshlrev_b32 v38, 16, v43
    v_and_b32 v39, s31, v43
    v_mul_f32 v48, v32, v28
    v_fma_f32 v56, -v48, v26, v32
    v_fmac_f32 v48, v56, v28
    v_mul_f32 v49, v33, v28
    v_fma_f32 v56, -v49, v26, v33
    v_fmac_f32 v49, v56, v28
    v_mul_f32 v50, v34, v28
    v_fma_f32 v56, -v50, v26, v34
    v_fmac_f32 v50, v56, v28
    v_mul_f32 v51, v35, v28
    v_fma_f32 v56, -v51, v26, v35
    v_fmac_f32 v51, v56, v28
    v_mul_f32 v52, v36, v28
    v_fma_f32 v56, -v52, v26, v36
    v_fmac_f32 v52, v56, v28
    v_mul_f32 v53, v37, v28
    v_fma_f32 v56, -v53, v26, v37
    v_fmac_f32 v53, v56, v28
    v_mul_f32 v54, v38, v28
    v_fma_f32 v56, -v54, v26, v38
    v_fmac_f32 v54, v56, v28
    v_mul_f32 v55, v39, v28
    v_fma_f32 v56, -v55, v26, v39
    v_fmac_f32 v55, v56, v28
    v_cvt_pk_bf16_f32 v40, v48, v49
    v_cvt_pk_bf16_f32 v41, v50, v51
    v_cvt_pk_bf16_f32 v42, v52, v53
    v_cvt_pk_bf16_f32 v43, v54, v55
    s_and_saveexec_b64 s[40:41], vcc
    s_add_u32 s43, s30, 1792
    buffer_store_dwordx4 v[40:43], v3, s[16:19], s43 offen
    s_mov_b64 exec, s[40:41]
    s_nop 1
    s_waitcnt vmcnt(4)
    v_lshlrev_b32 v16, 16, v76
    v_and_b32 v17, s31, v76
    v_lshlrev_b32 v18, 16, v77
    v_and_b32 v19, s31, v77
    v_lshlrev_b32 v20, 16, v78
    v_and_b32 v21, s31, v78
    v_lshlrev_b32 v22, 16, v79
    v_and_b32 v23, s31, v79
    s_nop 0
    v_cndmask_b32 v16, 0, v16, vcc
    v_cndmask_b32 v17, 0, v17, vcc
    v_cndmask_b32 v18, 0, v18, vcc
    v_cndmask_b32 v19, 0, v19, vcc
    v_cndmask_b32 v20, 0, v20, vcc
    v_cndmask_b32 v21, 0, v21, vcc
    v_cndmask_b32 v22, 0, v22, vcc
    v_cndmask_b32 v23, 0, v23, vcc
    v_add_f32 v24, v16, v17
    v_add_f32 v24, v24, v18
    v_add_f32 v24, v24, v19
    v_add_f32 v24, v24, v20
    v_add_f32 v24, v24, v21
    v_add_f32 v24, v24, v22
    v_add_f32 v24, v24, v23
    s_nop 1
    v_add_f32_dpp v24, v24, v24 row_shr:1 row_mask:0xf bank_mask:0xf
    s_nop 1
    v_add_f32_dpp v24, v24, v24 row_shr:2 row_mask:0xf bank_mask:0xf
    s_nop 1
    v_add_f32_dpp v24, v24, v24 row_shr:4 row_mask:0xf bank_mask:0xf
    s_nop 1
    v_add_f32_dpp v24, v24, v24 row_shr:8 row_mask:0xf bank_mask:0xf
    s_nop 1
    v_add_f32_dpp v24, v24, v24 row_bcast:15 row_mask:0xa bank_mask:0xf
    s_nop 1
    v_add_f32_dpp v24, v24, v24 row_bcast:31 row_mask:0xc bank_mask:0xf
    s_nop 1
    v_readlane_b32 s42, v24, 63
    s_nop 1
    v_mov_b32 v25, s42
    v_mul_f32 v25, 0x3b124925, v25
    v_sub_f32 v32, v16, v25
    v_cndmask_b32 v32, 0, v32, vcc
    v_sub_f32 v33, v17, v25
    v_cndmask_b32 v33, 0, v33, vcc
    v_sub_f32 v34, v18, v25
    v_cndmask_b32 v34, 0, v34, vcc
    v_sub_f32 v35, v19, v25
    v_cndmask_b32 v35, 0, v35, vcc
    v_sub_f32 v36, v20, v25
    v_cndmask_b32 v36, 0, v36, vcc
    v_sub_f32 v37, v21, v25
    v_cndmask_b32 v37, 0, v37, vcc
    v_sub_f32 v38, v22, v25
    v_cndmask_b32 v38, 0, v38, vcc
    v_sub_f32 v39, v23, v25
    v_cndmask_b32 v39, 0, v39, vcc
    v_mul_f32 v24, v32, v32
    v_fmac_f32 v24, v33, v33
    v_fmac_f32 v24, v34, v34
    v_fmac_f32 v24, v35, v35
    v_fmac_f32 v24, v36, v36
    v_fmac_f32 v24, v37, v37
    v_fmac_f32 v24, v38, v38
    v_fmac_f32 v24, v39, v39
    s_nop 1
    v_add_f32_dpp v24, v24, v24 row_shr:1 row_mask:0xf bank_mask:0xf
    s_nop 1
    v_add_f32_dpp v24, v24, v24 row_shr:2 row_mask:0xf bank_mask:0xf
    s_nop 1
    v_add_f32_dpp v24, v24, v24 row_shr:4 row_mask:0xf bank_mask:0xf
    s_nop 1
    v_add_f32_dpp v24, v24, v24 row_shr:8 row_mask:0xf bank_mask:0xf
    s_nop 1
    v_add_f32_dpp v24, v24, v24 row_bcast:15 row_mask:0xa bank_mask:0xf
    s_nop 1
    v_add_f32_dpp v24, v24, v24 row_bcast:31 row_mask:0xc bank_mask:0xf
    s_nop 1
    v_readlane_b32 s42, v24, 63
    s_nop 1
    v_mov_b32 v26, s42
    v_mul_f32 v26, 0x3b124925, v26
    v_cvt_pk_bf16_f32 v27, v25, v25
    v_lshlrev_b32 v25, 16, v27
    v_cvt_pk_bf16_f32 v27, v26, v26
    v_lshlrev_b32 v26, 16, v27
    v_add_f32 v26, 0x3727c5ac, v26
    v_cvt_pk_bf16_f32 v27, v26, v26
    v_lshlrev_b32 v26, 16, v27
    v_sqrt_f32 v26, v26
    s_nop 0
    v_cvt_pk_bf16_f32 v27, v26, v26
    v_lshlrev_b32 v26, 16, v27
    v_rcp_f32 v28, v26
    s_nop 0
    v_sub_f32 v32, v16, v25
    v_sub_f32 v33, v17, v25
    v_sub_f32 v34, v18, v25
    v_sub_f32 v35, v19, v25
    v_sub_f32 v36, v20, v25
    v_sub_f32 v37, v21, v25
    v_sub_f32 v38, v22, v25
    v_sub_f32 v39, v23, v25
    v_cvt_pk_bf16_f32 v40, v32, v33
    v_cvt_pk_bf16_f32 v41, v34, v35
    v_cvt_pk_bf16_f32 v42, v36, v37
    v_cvt_pk_bf16_f32 v43, v38, v39
    v_lshlrev_b32 v32, 16, v40
    v_and_b32 v33, s31, v40
    v_lshlrev_b32 v34, 16, v41
    v_and_b32 v35, s31, v41
    v_lshlrev_b32 v36, 16, v42
    v_and_b32 v37, s31, v42
    v_lshlrev_b32 v38, 16, v43
    v_and_b32 v39, s31, v43
    v_mul_f32 v48, v32, v28
    v_fma_f32 v56, -v48, v26, v32
    v_fmac_f32 v48, v56, v28
    v_mul_f32 v49, v33, v28
    v_fma_f32 v56, -v49, v26, v33
    v_fmac_f32 v49, v56, v28
    v_mul_f32 v50, v34, v28
    v_fma_f32 v56, -v50, v26, v34
    v_fmac_f32 v50, v56, v28
    v_mul_f32 v51, v35, v28
    v_fma_f32 v56, -v51, v26, v35
    v_fmac_f32 v51, v56, v28
    v_mul_f32 v52, v36, v28
    v_fma_f32 v56, -v52, v26, v36
    v_fmac_f32 v52, v56, v28
    v_mul_f32 v53, v37, v28
    v_fma_f32 v56, -v53, v26, v37
    v_fmac_f32 v53, v56, v28
    v_mul_f32 v54, v38, v28
    v_fma_f32 v56, -v54, v26, v38
    v_fmac_f32 v54, v56, v28
    v_mul_f32 v55, v39, v28
    v_fma_f32 v56, -v55, v26, v39
    v_fmac_f32 v55, v56, v28
    v_cvt_pk_bf16_f32 v40, v48, v49
    v_cvt_pk_bf16_f32 v41, v50, v51
    v_cvt_pk_bf16_f32 v42, v52, v53
    v_cvt_pk_bf16_f32 v43, v54, v55
    s_and_saveexec_b64 s[40:41], vcc
    s_add_u32 s43, s30, 2688
    buffer_store_dwordx4 v[40:43], v3, s[16:19], s43 offen
    s_mov_b64 exec, s[40:41]
    s_nop 1
    s_waitcnt vmcnt(3)
    v_lshlrev_b32 v16, 16, v80
    v_and_b32 v17, s31, v80
    v_lshlrev_b32 v18, 16, v81
    v_and_b32 v19, s31, v81
    v_lshlrev_b32 v20, 16, v82
    v_and_b32 v21, s31, v82
    v_lshlrev_b32 v22, 16, v83
    v_and_b32 v23, s31, v83
    s_nop 0
    v_cndmask_b32 v16, 0, v16, vcc
    v_cndmask_b32 v17, 0, v17, vcc
    v_cndmask_b32 v18, 0, v18, vcc
    v_cndmask_b32 v19, 0, v19, vcc
    v_cndmask_b32 v20, 0, v20, vcc
    v_cndmask_b32 v21, 0, v21, vcc
    v_cndmask_b32 v22, 0, v22, vcc
    v_cndmask_b32 v23, 0, v23, vcc
    v_add_f32 v24, v16, v17
    v_add_f32 v24, v24, v18
    v_add_f32 v24, v24, v19
    v_add_f32 v24, v24, v20
    v_add_f32 v24, v24, v21
    v_add_f32 v24, v24, v22
    v_add_f32 v24, v24, v23
    s_nop 1
    v_add_f32_dpp v24, v24, v24 row_shr:1 row_mask:0xf bank_mask:0xf
    s_nop 1
    v_add_f32_dpp v24, v24, v24 row_shr:2 row_mask:0xf bank_mask:0xf
    s_nop 1
    v_add_f32_dpp v24, v24, v24 row_shr:4 row_mask:0xf bank_mask:0xf
    s_nop 1
    v_add_f32_dpp v24, v24, v24 row_shr:8 row_mask:0xf bank_mask:0xf
    s_nop 1
    v_add_f32_dpp v24, v24, v24 row_bcast:15 row_mask:0xa bank_mask:0xf
    s_nop 1
    v_add_f32_dpp v24, v24, v24 row_bcast:31 row_mask:0xc bank_mask:0xf
    s_nop 1
    v_readlane_b32 s42, v24, 63
    s_nop 1
    v_mov_b32 v25, s42
    v_mul_f32 v25, 0x3b124925, v25
    v_sub_f32 v32, v16, v25
    v_cndmask_b32 v32, 0, v32, vcc
    v_sub_f32 v33, v17, v25
    v_cndmask_b32 v33, 0, v33, vcc
    v_sub_f32 v34, v18, v25
    v_cndmask_b32 v34, 0, v34, vcc
    v_sub_f32 v35, v19, v25
    v_cndmask_b32 v35, 0, v35, vcc
    v_sub_f32 v36, v20, v25
    v_cndmask_b32 v36, 0, v36, vcc
    v_sub_f32 v37, v21, v25
    v_cndmask_b32 v37, 0, v37, vcc
    v_sub_f32 v38, v22, v25
    v_cndmask_b32 v38, 0, v38, vcc
    v_sub_f32 v39, v23, v25
    v_cndmask_b32 v39, 0, v39, vcc
    v_mul_f32 v24, v32, v32
    v_fmac_f32 v24, v33, v33
    v_fmac_f32 v24, v34, v34
    v_fmac_f32 v24, v35, v35
    v_fmac_f32 v24, v36, v36
    v_fmac_f32 v24, v37, v37
    v_fmac_f32 v24, v38, v38
    v_fmac_f32 v24, v39, v39
    s_nop 1
    v_add_f32_dpp v24, v24, v24 row_shr:1 row_mask:0xf bank_mask:0xf
    s_nop 1
    v_add_f32_dpp v24, v24, v24 row_shr:2 row_mask:0xf bank_mask:0xf
    s_nop 1
    v_add_f32_dpp v24, v24, v24 row_shr:4 row_mask:0xf bank_mask:0xf
    s_nop 1
    v_add_f32_dpp v24, v24, v24 row_shr:8 row_mask:0xf bank_mask:0xf
    s_nop 1
    v_add_f32_dpp v24, v24, v24 row_bcast:15 row_mask:0xa bank_mask:0xf
    s_nop 1
    v_add_f32_dpp v24, v24, v24 row_bcast:31 row_mask:0xc bank_mask:0xf
    s_nop 1
    v_readlane_b32 s42, v24, 63
    s_nop 1
    v_mov_b32 v26, s42
    v_mul_f32 v26, 0x3b124925, v26
    v_cvt_pk_bf16_f32 v27, v25, v25
    v_lshlrev_b32 v25, 16, v27
    v_cvt_pk_bf16_f32 v27, v26, v26
    v_lshlrev_b32 v26, 16, v27
    v_add_f32 v26, 0x3727c5ac, v26
    v_cvt_pk_bf16_f32 v27, v26, v26
    v_lshlrev_b32 v26, 16, v27
    v_sqrt_f32 v26, v26
    s_nop 0
    v_cvt_pk_bf16_f32 v27, v26, v26
    v_lshlrev_b32 v26, 16, v27
    v_rcp_f32 v28, v26
    s_nop 0
    v_sub_f32 v32, v16, v25
    v_sub_f32 v33, v17, v25
    v_sub_f32 v34, v18, v25
    v_sub_f32 v35, v19, v25
    v_sub_f32 v36, v20, v25
    v_sub_f32 v37, v21, v25
    v_sub_f32 v38, v22, v25
    v_sub_f32 v39, v23, v25
    v_cvt_pk_bf16_f32 v40, v32, v33
    v_cvt_pk_bf16_f32 v41, v34, v35
    v_cvt_pk_bf16_f32 v42, v36, v37
    v_cvt_pk_bf16_f32 v43, v38, v39
    v_lshlrev_b32 v32, 16, v40
    v_and_b32 v33, s31, v40
    v_lshlrev_b32 v34, 16, v41
    v_and_b32 v35, s31, v41
    v_lshlrev_b32 v36, 16, v42
    v_and_b32 v37, s31, v42
    v_lshlrev_b32 v38, 16, v43
    v_and_b32 v39, s31, v43
    v_mul_f32 v48, v32, v28
    v_fma_f32 v56, -v48, v26, v32
    v_fmac_f32 v48, v56, v28
    v_mul_f32 v49, v33, v28
    v_fma_f32 v56, -v49, v26, v33
    v_fmac_f32 v49, v56, v28
    v_mul_f32 v50, v34, v28
    v_fma_f32 v56, -v50, v26, v34
    v_fmac_f32 v50, v56, v28
    v_mul_f32 v51, v35, v28
    v_fma_f32 v56, -v51, v26, v35
    v_fmac_f32 v51, v56, v28
    v_mul_f32 v52, v36, v28
    v_fma_f32 v56, -v52, v26, v36
    v_fmac_f32 v52, v56, v28
    v_mul_f32 v53, v37, v28
    v_fma_f32 v56, -v53, v26, v37
    v_fmac_f32 v53, v56, v28
    v_mul_f32 v54, v38, v28
    v_fma_f32 v56, -v54, v26, v38
    v_fmac_f32 v54, v56, v28
    v_mul_f32 v55, v39, v28
    v_fma_f32 v56, -v55, v26, v39
    v_fmac_f32 v55, v56, v28
    v_cvt_pk_bf16_f32 v40, v48, v49
    v_cvt_pk_bf16_f32 v41, v50, v51
    v_cvt_pk_bf16_f32 v42, v52, v53
    v_cvt_pk_bf16_f32 v43, v54, v55
    s_and_saveexec_b64 s[40:41], vcc
    s_add_u32 s43, s30, 3584
    buffer_store_dwordx4 v[40:43], v3, s[16:19], s43 offen
    s_mov_b64 exec, s[40:41]
    s_nop 1
    s_waitcnt vmcnt(2)
    v_lshlrev_b32 v16, 16, v84
    v_and_b32 v17, s31, v84
    v_lshlrev_b32 v18, 16, v85
    v_and_b32 v19, s31, v85
    v_lshlrev_b32 v20, 16, v86
    v_and_b32 v21, s31, v86
    v_lshlrev_b32 v22, 16, v87
    v_and_b32 v23, s31, v87
    s_nop 0
    v_cndmask_b32 v16, 0, v16, vcc
    v_cndmask_b32 v17, 0, v17, vcc
    v_cndmask_b32 v18, 0, v18, vcc
    v_cndmask_b32 v19, 0, v19, vcc
    v_cndmask_b32 v20, 0, v20, vcc
    v_cndmask_b32 v21, 0, v21, vcc
    v_cndmask_b32 v22, 0, v22, vcc
    v_cndmask_b32 v23, 0, v23, vcc
    v_add_f32 v24, v16, v17
    v_add_f32 v24, v24, v18
    v_add_f32 v24, v24, v19
    v_add_f32 v24, v24, v20
    v_add_f32 v24, v24, v21
    v_add_f32 v24, v24, v22
    v_add_f32 v24, v24, v23
    s_nop 1
    v_add_f32_dpp v24, v24, v24 row_shr:1 row_mask:0xf bank_mask:0xf
    s_nop 1
    v_add_f32_dpp v24, v24, v24 row_shr:2 row_mask:0xf bank_mask:0xf
    s_nop 1
    v_add_f32_dpp v24, v24, v24 row_shr:4 row_mask:0xf bank_mask:0xf
    s_nop 1
    v_add_f32_dpp v24, v24, v24 row_shr:8 row_mask:0xf bank_mask:0xf
    s_nop 1
    v_add_f32_dpp v24, v24, v24 row_bcast:15 row_mask:0xa bank_mask:0xf
    s_nop 1
    v_add_f32_dpp v24, v24, v24 row_bcast:31 row_mask:0xc bank_mask:0xf
    s_nop 1
    v_readlane_b32 s42, v24, 63
    s_nop 1
    v_mov_b32 v25, s42
    v_mul_f32 v25, 0x3b124925, v25
    v_sub_f32 v32, v16, v25
    v_cndmask_b32 v32, 0, v32, vcc
    v_sub_f32 v33, v17, v25
    v_cndmask_b32 v33, 0, v33, vcc
    v_sub_f32 v34, v18, v25
    v_cndmask_b32 v34, 0, v34, vcc
    v_sub_f32 v35, v19, v25
    v_cndmask_b32 v35, 0, v35, vcc
    v_sub_f32 v36, v20, v25
    v_cndmask_b32 v36, 0, v36, vcc
    v_sub_f32 v37, v21, v25
    v_cndmask_b32 v37, 0, v37, vcc
    v_sub_f32 v38, v22, v25
    v_cndmask_b32 v38, 0, v38, vcc
    v_sub_f32 v39, v23, v25
    v_cndmask_b32 v39, 0, v39, vcc
    v_mul_f32 v24, v32, v32
    v_fmac_f32 v24, v33, v33
    v_fmac_f32 v24, v34, v34
    v_fmac_f32 v24, v35, v35
    v_fmac_f32 v24, v36, v36
    v_fmac_f32 v24, v37, v37
    v_fmac_f32 v24, v38, v38
    v_fmac_f32 v24, v39, v39
    s_nop 1
    v_add_f32_dpp v24, v24, v24 row_shr:1 row_mask:0xf bank_mask:0xf
    s_nop 1
    v_add_f32_dpp v24, v24, v24 row_shr:2 row_mask:0xf bank_mask:0xf
    s_nop 1
    v_add_f32_dpp v24, v24, v24 row_shr:4 row_mask:0xf bank_mask:0xf
    s_nop 1
    v_add_f32_dpp v24, v24, v24 row_shr:8 row_mask:0xf bank_mask:0xf
    s_nop 1
    v_add_f32_dpp v24, v24, v24 row_bcast:15 row_mask:0xa bank_mask:0xf
    s_nop 1
    v_add_f32_dpp v24, v24, v24 row_bcast:31 row_mask:0xc bank_mask:0xf
    s_nop 1
    v_readlane_b32 s42, v24, 63
    s_nop 1
    v_mov_b32 v26, s42
    v_mul_f32 v26, 0x3b124925, v26
    v_cvt_pk_bf16_f32 v27, v25, v25
    v_lshlrev_b32 v25, 16, v27
    v_cvt_pk_bf16_f32 v27, v26, v26
    v_lshlrev_b32 v26, 16, v27
    v_add_f32 v26, 0x3727c5ac, v26
    v_cvt_pk_bf16_f32 v27, v26, v26
    v_lshlrev_b32 v26, 16, v27
    v_sqrt_f32 v26, v26
    s_nop 0
    v_cvt_pk_bf16_f32 v27, v26, v26
    v_lshlrev_b32 v26, 16, v27
    v_rcp_f32 v28, v26
    s_nop 0
    v_sub_f32 v32, v16, v25
    v_sub_f32 v33, v17, v25
    v_sub_f32 v34, v18, v25
    v_sub_f32 v35, v19, v25
    v_sub_f32 v36, v20, v25
    v_sub_f32 v37, v21, v25
    v_sub_f32 v38, v22, v25
    v_sub_f32 v39, v23, v25
    v_cvt_pk_bf16_f32 v40, v32, v33
    v_cvt_pk_bf16_f32 v41, v34, v35
    v_cvt_pk_bf16_f32 v42, v36, v37
    v_cvt_pk_bf16_f32 v43, v38, v39
    v_lshlrev_b32 v32, 16, v40
    v_and_b32 v33, s31, v40
    v_lshlrev_b32 v34, 16, v41
    v_and_b32 v35, s31, v41
    v_lshlrev_b32 v36, 16, v42
    v_and_b32 v37, s31, v42
    v_lshlrev_b32 v38, 16, v43
    v_and_b32 v39, s31, v43
    v_mul_f32 v48, v32, v28
    v_fma_f32 v56, -v48, v26, v32
    v_fmac_f32 v48, v56, v28
    v_mul_f32 v49, v33, v28
    v_fma_f32 v56, -v49, v26, v33
    v_fmac_f32 v49, v56, v28
    v_mul_f32 v50, v34, v28
    v_fma_f32 v56, -v50, v26, v34
    v_fmac_f32 v50, v56, v28
    v_mul_f32 v51, v35, v28
    v_fma_f32 v56, -v51, v26, v35
    v_fmac_f32 v51, v56, v28
    v_mul_f32 v52, v36, v28
    v_fma_f32 v56, -v52, v26, v36
    v_fmac_f32 v52, v56, v28
    v_mul_f32 v53, v37, v28
    v_fma_f32 v56, -v53, v26, v37
    v_fmac_f32 v53, v56, v28
    v_mul_f32 v54, v38, v28
    v_fma_f32 v56, -v54, v26, v38
    v_fmac_f32 v54, v56, v28
    v_mul_f32 v55, v39, v28
    v_fma_f32 v56, -v55, v26, v39
    v_fmac_f32 v55, v56, v28
    v_cvt_pk_bf16_f32 v40, v48, v49
    v_cvt_pk_bf16_f32 v41, v50, v51
    v_cvt_pk_bf16_f32 v42, v52, v53
    v_cvt_pk_bf16_f32 v43, v54, v55
    s_and_saveexec_b64 s[40:41], vcc
    s_add_u32 s43, s30, 4480
    buffer_store_dwordx4 v[40:43], v3, s[16:19], s43 offen
    s_mov_b64 exec, s[40:41]
    s_nop 1
    s_waitcnt vmcnt(1)
    v_lshlrev_b32 v16, 16, v88
    v_and_b32 v17, s31, v88
    v_lshlrev_b32 v18, 16, v89
    v_and_b32 v19, s31, v89
    v_lshlrev_b32 v20, 16, v90
    v_and_b32 v21, s31, v90
    v_lshlrev_b32 v22, 16, v91
    v_and_b32 v23, s31, v91
    s_nop 0
    v_cndmask_b32 v16, 0, v16, vcc
    v_cndmask_b32 v17, 0, v17, vcc
    v_cndmask_b32 v18, 0, v18, vcc
    v_cndmask_b32 v19, 0, v19, vcc
    v_cndmask_b32 v20, 0, v20, vcc
    v_cndmask_b32 v21, 0, v21, vcc
    v_cndmask_b32 v22, 0, v22, vcc
    v_cndmask_b32 v23, 0, v23, vcc
    v_add_f32 v24, v16, v17
    v_add_f32 v24, v24, v18
    v_add_f32 v24, v24, v19
    v_add_f32 v24, v24, v20
    v_add_f32 v24, v24, v21
    v_add_f32 v24, v24, v22
    v_add_f32 v24, v24, v23
    s_nop 1
    v_add_f32_dpp v24, v24, v24 row_shr:1 row_mask:0xf bank_mask:0xf
    s_nop 1
    v_add_f32_dpp v24, v24, v24 row_shr:2 row_mask:0xf bank_mask:0xf
    s_nop 1
    v_add_f32_dpp v24, v24, v24 row_shr:4 row_mask:0xf bank_mask:0xf
    s_nop 1
    v_add_f32_dpp v24, v24, v24 row_shr:8 row_mask:0xf bank_mask:0xf
    s_nop 1
    v_add_f32_dpp v24, v24, v24 row_bcast:15 row_mask:0xa bank_mask:0xf
    s_nop 1
    v_add_f32_dpp v24, v24, v24 row_bcast:31 row_mask:0xc bank_mask:0xf
    s_nop 1
    v_readlane_b32 s42, v24, 63
    s_nop 1
    v_mov_b32 v25, s42
    v_mul_f32 v25, 0x3b124925, v25
    v_sub_f32 v32, v16, v25
    v_cndmask_b32 v32, 0, v32, vcc
    v_sub_f32 v33, v17, v25
    v_cndmask_b32 v33, 0, v33, vcc
    v_sub_f32 v34, v18, v25
    v_cndmask_b32 v34, 0, v34, vcc
    v_sub_f32 v35, v19, v25
    v_cndmask_b32 v35, 0, v35, vcc
    v_sub_f32 v36, v20, v25
    v_cndmask_b32 v36, 0, v36, vcc
    v_sub_f32 v37, v21, v25
    v_cndmask_b32 v37, 0, v37, vcc
    v_sub_f32 v38, v22, v25
    v_cndmask_b32 v38, 0, v38, vcc
    v_sub_f32 v39, v23, v25
    v_cndmask_b32 v39, 0, v39, vcc
    v_mul_f32 v24, v32, v32
    v_fmac_f32 v24, v33, v33
    v_fmac_f32 v24, v34, v34
    v_fmac_f32 v24, v35, v35
    v_fmac_f32 v24, v36, v36
    v_fmac_f32 v24, v37, v37
    v_fmac_f32 v24, v38, v38
    v_fmac_f32 v24, v39, v39
    s_nop 1
    v_add_f32_dpp v24, v24, v24 row_shr:1 row_mask:0xf bank_mask:0xf
    s_nop 1
    v_add_f32_dpp v24, v24, v24 row_shr:2 row_mask:0xf bank_mask:0xf
    s_nop 1
    v_add_f32_dpp v24, v24, v24 row_shr:4 row_mask:0xf bank_mask:0xf
    s_nop 1
    v_add_f32_dpp v24, v24, v24 row_shr:8 row_mask:0xf bank_mask:0xf
    s_nop 1
    v_add_f32_dpp v24, v24, v24 row_bcast:15 row_mask:0xa bank_mask:0xf
    s_nop 1
    v_add_f32_dpp v24, v24, v24 row_bcast:31 row_mask:0xc bank_mask:0xf
    s_nop 1
    v_readlane_b32 s42, v24, 63
    s_nop 1
    v_mov_b32 v26, s42
    v_mul_f32 v26, 0x3b124925, v26
    v_cvt_pk_bf16_f32 v27, v25, v25
    v_lshlrev_b32 v25, 16, v27
    v_cvt_pk_bf16_f32 v27, v26, v26
    v_lshlrev_b32 v26, 16, v27
    v_add_f32 v26, 0x3727c5ac, v26
    v_cvt_pk_bf16_f32 v27, v26, v26
    v_lshlrev_b32 v26, 16, v27
    v_sqrt_f32 v26, v26
    s_nop 0
    v_cvt_pk_bf16_f32 v27, v26, v26
    v_lshlrev_b32 v26, 16, v27
    v_rcp_f32 v28, v26
    s_nop 0
    v_sub_f32 v32, v16, v25
    v_sub_f32 v33, v17, v25
    v_sub_f32 v34, v18, v25
    v_sub_f32 v35, v19, v25
    v_sub_f32 v36, v20, v25
    v_sub_f32 v37, v21, v25
    v_sub_f32 v38, v22, v25
    v_sub_f32 v39, v23, v25
    v_cvt_pk_bf16_f32 v40, v32, v33
    v_cvt_pk_bf16_f32 v41, v34, v35
    v_cvt_pk_bf16_f32 v42, v36, v37
    v_cvt_pk_bf16_f32 v43, v38, v39
    v_lshlrev_b32 v32, 16, v40
    v_and_b32 v33, s31, v40
    v_lshlrev_b32 v34, 16, v41
    v_and_b32 v35, s31, v41
    v_lshlrev_b32 v36, 16, v42
    v_and_b32 v37, s31, v42
    v_lshlrev_b32 v38, 16, v43
    v_and_b32 v39, s31, v43
    v_mul_f32 v48, v32, v28
    v_fma_f32 v56, -v48, v26, v32
    v_fmac_f32 v48, v56, v28
    v_mul_f32 v49, v33, v28
    v_fma_f32 v56, -v49, v26, v33
    v_fmac_f32 v49, v56, v28
    v_mul_f32 v50, v34, v28
    v_fma_f32 v56, -v50, v26, v34
    v_fmac_f32 v50, v56, v28
    v_mul_f32 v51, v35, v28
    v_fma_f32 v56, -v51, v26, v35
    v_fmac_f32 v51, v56, v28
    v_mul_f32 v52, v36, v28
    v_fma_f32 v56, -v52, v26, v36
    v_fmac_f32 v52, v56, v28
    v_mul_f32 v53, v37, v28
    v_fma_f32 v56, -v53, v26, v37
    v_fmac_f32 v53, v56, v28
    v_mul_f32 v54, v38, v28
    v_fma_f32 v56, -v54, v26, v38
    v_fmac_f32 v54, v56, v28
    v_mul_f32 v55, v39, v28
    v_fma_f32 v56, -v55, v26, v39
    v_fmac_f32 v55, v56, v28
    v_cvt_pk_bf16_f32 v40, v48, v49
    v_cvt_pk_bf16_f32 v41, v50, v51
    v_cvt_pk_bf16_f32 v42, v52, v53
    v_cvt_pk_bf16_f32 v43, v54, v55
    s_and_saveexec_b64 s[40:41], vcc
    s_add_u32 s43, s30, 5376
    buffer_store_dwordx4 v[40:43], v3, s[16:19], s43 offen
    s_mov_b64 exec, s[40:41]
    s_nop 1
    s_waitcnt vmcnt(0)
    v_lshlrev_b32 v16, 16, v92
    v_and_b32 v17, s31, v92
    v_lshlrev_b32 v18, 16, v93
    v_and_b32 v19, s31, v93
    v_lshlrev_b32 v20, 16, v94
    v_and_b32 v21, s31, v94
    v_lshlrev_b32 v22, 16, v95
    v_and_b32 v23, s31, v95
    s_nop 0
    v_cndmask_b32 v16, 0, v16, vcc
    v_cndmask_b32 v17, 0, v17, vcc
    v_cndmask_b32 v18, 0, v18, vcc
    v_cndmask_b32 v19, 0, v19, vcc
    v_cndmask_b32 v20, 0, v20, vcc
    v_cndmask_b32 v21, 0, v21, vcc
    v_cndmask_b32 v22, 0, v22, vcc
    v_cndmask_b32 v23, 0, v23, vcc
    v_add_f32 v24, v16, v17
    v_add_f32 v24, v24, v18
    v_add_f32 v24, v24, v19
    v_add_f32 v24, v24, v20
    v_add_f32 v24, v24, v21
    v_add_f32 v24, v24, v22
    v_add_f32 v24, v24, v23
    s_nop 1
    v_add_f32_dpp v24, v24, v24 row_shr:1 row_mask:0xf bank_mask:0xf
    s_nop 1
    v_add_f32_dpp v24, v24, v24 row_shr:2 row_mask:0xf bank_mask:0xf
    s_nop 1
    v_add_f32_dpp v24, v24, v24 row_shr:4 row_mask:0xf bank_mask:0xf
    s_nop 1
    v_add_f32_dpp v24, v24, v24 row_shr:8 row_mask:0xf bank_mask:0xf
    s_nop 1
    v_add_f32_dpp v24, v24, v24 row_bcast:15 row_mask:0xa bank_mask:0xf
    s_nop 1
    v_add_f32_dpp v24, v24, v24 row_bcast:31 row_mask:0xc bank_mask:0xf
    s_nop 1
    v_readlane_b32 s42, v24, 63
    s_nop 1
    v_mov_b32 v25, s42
    v_mul_f32 v25, 0x3b124925, v25
    v_sub_f32 v32, v16, v25
    v_cndmask_b32 v32, 0, v32, vcc
    v_sub_f32 v33, v17, v25
    v_cndmask_b32 v33, 0, v33, vcc
    v_sub_f32 v34, v18, v25
    v_cndmask_b32 v34, 0, v34, vcc
    v_sub_f32 v35, v19, v25
    v_cndmask_b32 v35, 0, v35, vcc
    v_sub_f32 v36, v20, v25
    v_cndmask_b32 v36, 0, v36, vcc
    v_sub_f32 v37, v21, v25
    v_cndmask_b32 v37, 0, v37, vcc
    v_sub_f32 v38, v22, v25
    v_cndmask_b32 v38, 0, v38, vcc
    v_sub_f32 v39, v23, v25
    v_cndmask_b32 v39, 0, v39, vcc
    v_mul_f32 v24, v32, v32
    v_fmac_f32 v24, v33, v33
    v_fmac_f32 v24, v34, v34
    v_fmac_f32 v24, v35, v35
    v_fmac_f32 v24, v36, v36
    v_fmac_f32 v24, v37, v37
    v_fmac_f32 v24, v38, v38
    v_fmac_f32 v24, v39, v39
    s_nop 1
    v_add_f32_dpp v24, v24, v24 row_shr:1 row_mask:0xf bank_mask:0xf
    s_nop 1
    v_add_f32_dpp v24, v24, v24 row_shr:2 row_mask:0xf bank_mask:0xf
    s_nop 1
    v_add_f32_dpp v24, v24, v24 row_shr:4 row_mask:0xf bank_mask:0xf
    s_nop 1
    v_add_f32_dpp v24, v24, v24 row_shr:8 row_mask:0xf bank_mask:0xf
    s_nop 1
    v_add_f32_dpp v24, v24, v24 row_bcast:15 row_mask:0xa bank_mask:0xf
    s_nop 1
    v_add_f32_dpp v24, v24, v24 row_bcast:31 row_mask:0xc bank_mask:0xf
    s_nop 1
    v_readlane_b32 s42, v24, 63
    s_nop 1
    v_mov_b32 v26, s42
    v_mul_f32 v26, 0x3b124925, v26
    v_cvt_pk_bf16_f32 v27, v25, v25
    v_lshlrev_b32 v25, 16, v27
    v_cvt_pk_bf16_f32 v27, v26, v26
    v_lshlrev_b32 v26, 16, v27
    v_add_f32 v26, 0x3727c5ac, v26
    v_cvt_pk_bf16_f32 v27, v26, v26
    v_lshlrev_b32 v26, 16, v27
    v_sqrt_f32 v26, v26
    s_nop 0
    v_cvt_pk_bf16_f32 v27, v26, v26
    v_lshlrev_b32 v26, 16, v27
    v_rcp_f32 v28, v26
    s_nop 0
    v_sub_f32 v32, v16, v25
    v_sub_f32 v33, v17, v25
    v_sub_f32 v34, v18, v25
    v_sub_f32 v35, v19, v25
    v_sub_f32 v36, v20, v25
    v_sub_f32 v37, v21, v25
    v_sub_f32 v38, v22, v25
    v_sub_f32 v39, v23, v25
    v_cvt_pk_bf16_f32 v40, v32, v33
    v_cvt_pk_bf16_f32 v41, v34, v35
    v_cvt_pk_bf16_f32 v42, v36, v37
    v_cvt_pk_bf16_f32 v43, v38, v39
    v_lshlrev_b32 v32, 16, v40
    v_and_b32 v33, s31, v40
    v_lshlrev_b32 v34, 16, v41
    v_and_b32 v35, s31, v41
    v_lshlrev_b32 v36, 16, v42
    v_and_b32 v37, s31, v42
    v_lshlrev_b32 v38, 16, v43
    v_and_b32 v39, s31, v43
    v_mul_f32 v48, v32, v28
    v_fma_f32 v56, -v48, v26, v32
    v_fmac_f32 v48, v56, v28
    v_mul_f32 v49, v33, v28
    v_fma_f32 v56, -v49, v26, v33
    v_fmac_f32 v49, v56, v28
    v_mul_f32 v50, v34, v28
    v_fma_f32 v56, -v50, v26, v34
    v_fmac_f32 v50, v56, v28
    v_mul_f32 v51, v35, v28
    v_fma_f32 v56, -v51, v26, v35
    v_fmac_f32 v51, v56, v28
    v_mul_f32 v52, v36, v28
    v_fma_f32 v56, -v52, v26, v36
    v_fmac_f32 v52, v56, v28
    v_mul_f32 v53, v37, v28
    v_fma_f32 v56, -v53, v26, v37
    v_fmac_f32 v53, v56, v28
    v_mul_f32 v54, v38, v28
    v_fma_f32 v56, -v54, v26, v38
    v_fmac_f32 v54, v56, v28
    v_mul_f32 v55, v39, v28
    v_fma_f32 v56, -v55, v26, v39
    v_fmac_f32 v55, v56, v28
    v_cvt_pk_bf16_f32 v40, v48, v49
    v_cvt_pk_bf16_f32 v41, v50, v51
    v_cvt_pk_bf16_f32 v42, v52, v53
    v_cvt_pk_bf16_f32 v43, v54, v55
    s_and_saveexec_b64 s[40:41], vcc
    s_add_u32 s43, s30, 6272
    buffer_store_dwordx4 v[40:43], v3, s[16:19], s43 offen
    s_mov_b64 exec, s[40:41]
    s_nop 1
k1_end:
    s_endpgm
.p2align 8
k2_kernel:
    s_load_dwordx2 s[4:5], s[0:1], 96
    v_lshrrev_b32 v1, 6, v0
    v_and_b32 v2, 63, v0
    s_nop 0
    v_readfirstlane_b32 s25, v1
    s_cmp_ge_u32 s2, 184
    s_cbranch_scc1 k2_end
    s_load_dwordx2 s[32:33], s[0:1], 16
    s_load_dwordx4 s[36:39], s[0:1], 56
    s_and_b32 s26, s2, 7
    s_lshl_b32 s26, s26, 8
    s_lshr_b32 s31, s2, 3
    s_waitcnt lgkmcnt(0)
    s_mov_b32 s8, s4
    s_mov_b32 s9, s5
    s_mov_b32 s10, 1835008
    s_mov_b32 s11, 0x00020000
    s_cmp_ge_u32 s31, 16
    s_cbranch_scc1 k2_h
    s_lshl_b32 s27, s31, 8
    s_mov_b32 s12, s32
    s_mov_b32 s13, s33
    s_mov_b32 s14, 3670016
    s_mov_b32 s15, 0x00020000
    s_add_u32 s16, s4, 4194304
    s_addc_u32 s17, s5, 0
    s_mov_b32 s18, 16777216
    s_mov_b32 s19, 0x00020000
    s_and_b32 s28, s25, 1
    s_lshr_b32 s29, s25, 1
    v_lshrrev_b32 v3, 3, v2
    s_lshl_b32 s30, s25, 5
    s_add_u32 s30, s30, s26
    v_add_u32 v3, s30, v3
    s_mov_b32 s31, 896
    v_mul_lo_u32 v3, v3, s31
    v_and_b32 v14, 7, v2
    v_lshrrev_b32 v15, 4, v2
    v_xor_b32 v16, v14, v15
    v_lshl_add_u32 v4, v16, 4, v3
    v_add_u32 v15, 4, v15
    v_xor_b32 v16, v14, v15
    v_lshl_add_u32 v5, v16, 4, v3
    v_lshrrev_b32 v3, 5, v2
    s_lshl_b32 s30, s25, 3
    v_add_u32 v14, s30, v3
    s_mov_b32 s31, 8192
    v_mul_lo_u32 v14, v14, s31
    s_lshl_b32 s30, s27, 1
    v_add_u32 v14, s30, v14
    v_and_b32 v15, 3, v2
    v_lshl_add_u32 v14, v15, 4, v14
    v_bfe_u32 v15, v2, 2, 3
    v_xor_b32 v16, v15, v3
    v_lshl_add_u32 v6, v16, 6, v14
    v_add_u32 v3, 2, v3
    v_xor_b32 v16, v15, v3
    v_lshl_add_u32 v7, v16, 6, v14
    v_and_b32 v3, 31, v2
    v_lshrrev_b32 v14, 5, v2
    v_bfe_u32 v15, v2, 1, 3
    v_xor_b32 v14, v14, v15
    v_lshlrev_b32 v3, 7, v3
    v_lshl_add_u32 v3, v14, 4, v3
    s_lshl_b32 s30, s28, 14
    v_add_u32 v3, s30, v3
    v_xor_b32 v8, 0, v3
    v_xor_b32 v9, 32, v3
    v_xor_b32 v10, 64, v3
    v_xor_b32 v11, 96, v3
    v_lshrrev_b32 v3, 5, v2
    v_bfe_u32 v14, v2, 2, 2
    v_lshl_add_u32 v3, v3, 3, v14
    v_lshlrev_b32 v3, 9, v3
    v_bfe_u32 v15, v2, 4, 1
    v_lshl_add_u32 v3, v15, 5, v3
    v_and_b32 v15, 3, v2
    v_lshl_add_u32 v3, v15, 3, v3
    v_add_u32 v3, 0x8000, v3
    s_lshl_b32 s30, s29, 1
    s_add_u32 s30, s30, 0
    s_lshr_b32 s31, s30, 2
    s_lshl_b32 s31, s31, 8
    s_and_b32 s30, s30, 3
    v_xor_b32 v15, s30, v14
    v_lshl_add_u32 v15, v15, 6, v3
    v_add_u32 v12, s31, v15
    s_lshl_b32 s30, s29, 1
    s_add_u32 s30, s30, 1
    s_lshr_b32 s31, s30, 2
    s_lshl_b32 s31, s31, 8
    s_and_b32 s30, s30, 3
    v_xor_b32 v15, s30, v14
    v_lshl_add_u32 v15, v15, 6, v3
    v_add_u32 v13, s31, v15
    v_mov_b32 v64, 0
    v_mov_b32 v65, 0
    v_mov_b32 v66, 0
    v_mov_b32 v67, 0
    v_mov_b32 v68, 0
    v_mov_b32 v69, 0
    v_mov_b32 v70, 0
    v_mov_b32 v71, 0
    v_mov_b32 v72, 0
    v_mov_b32 v73, 0
    v_mov_b32 v74, 0
    v_mov_b32 v75, 0
    v_mov_b32 v76, 0
    v_mov_b32 v77, 0
    v_mov_b32 v78, 0
    v_mov_b32 v79, 0
    v_mov_b32 v80, 0
    v_mov_b32 v81, 0
    v_mov_b32 v82, 0
    v_mov_b32 v83, 0
    v_mov_b32 v84, 0
    v_mov_b32 v85, 0
    v_mov_b32 v86, 0
    v_mov_b32 v87, 0
    v_mov_b32 v88, 0
    v_mov_b32 v89, 0
    v_mov_b32 v90, 0
    v_mov_b32 v91, 0
    v_mov_b32 v92, 0
    v_mov_b32 v93, 0
    v_mov_b32 v94, 0
    v_mov_b32 v95, 0
    v_mov_b32 v96, 0
    v_mov_b32 v97, 0
    v_mov_b32 v98, 0
    v_mov_b32 v99, 0
    v_mov_b32 v100, 0
    v_mov_b32 v101, 0
    v_mov_b32 v102, 0
    v_mov_b32 v103, 0
    v_mov_b32 v104, 0
    v_mov_b32 v105, 0
    v_mov_b32 v106, 0
    v_mov_b32 v107, 0
    v_mov_b32 v108, 0
    v_mov_b32 v109, 0
    v_mov_b32 v110, 0
    v_mov_b32 v111, 0
    v_mov_b32 v112, 0
    v_mov_b32 v113, 0
    v_mov_b32 v114, 0
    v_mov_b32 v115, 0
    v_mov_b32 v116, 0
    v_mov_b32 v117, 0
    v_mov_b32 v118, 0
    v_mov_b32 v119, 0
    v_mov_b32 v120, 0
    v_mov_b32 v121, 0
    v_mov_b32 v122, 0
    v_mov_b32 v123, 0
    v_mov_b32 v124, 0
    v_mov_b32 v125, 0
    v_mov_b32 v126, 0
    v_mov_b32 v127, 0
    v_mov_b32 v128, 0
    v_mov_b32 v129, 0
    v_mov_b32 v130, 0
    v_mov_b32 v131, 0
    v_mov_b32 v132, 0
    v_mov_b32 v133, 0
    v_mov_b32 v134, 0
    v_mov_b32 v135, 0
    v_mov_b32 v136, 0
    v_mov_b32 v137, 0
    v_mov_b32 v138, 0
    v_mov_b32 v139, 0
    v_mov_b32 v140, 0
    v_mov_b32 v141, 0
    v_mov_b32 v142, 0
    v_mov_b32 v143, 0
    v_mov_b32 v144, 0
    v_mov_b32 v145, 0
    v_mov_b32 v146, 0
    v_mov_b32 v147, 0
    v_mov_b32 v148, 0
    v_mov_b32 v149, 0
    v_mov_b32 v150, 0
    v_mov_b32 v151, 0
    v_mov_b32 v152, 0
    v_mov_b32 v153, 0
    v_mov_b32 v154, 0
    v_mov_b32 v155, 0
    v_mov_b32 v156, 0
    v_mov_b32 v157, 0
    v_mov_b32 v158, 0
    v_mov_b32 v159, 0
    v_mov_b32 v160, 0
    v_mov_b32 v161, 0
    v_mov_b32 v162, 0
    v_mov_b32 v163, 0
    v_mov_b32 v164, 0
    v_mov_b32 v165, 0
    v_mov_b32 v166, 0
    v_mov_b32 v167, 0
    v_mov_b32 v168, 0
    v_mov_b32 v169, 0
    v_mov_b32 v170, 0
    v_mov_b32 v171, 0
    v_mov_b32 v172, 0
    v_mov_b32 v173, 0
    v_mov_b32 v174, 0
    v_mov_b32 v175, 0
    v_mov_b32 v176, 0
    v_mov_b32 v177, 0
    v_mov_b32 v178, 0
    v_mov_b32 v179, 0
    v_mov_b32 v180, 0
    v_mov_b32 v181, 0
    v_mov_b32 v182, 0
    v_mov_b32 v183, 0
    v_mov_b32 v184, 0
    v_mov_b32 v185, 0
    v_mov_b32 v186, 0
    v_mov_b32 v187, 0
    v_mov_b32 v188, 0
    v_mov_b32 v189, 0
    v_mov_b32 v190, 0
    v_mov_b32 v191, 0
    s_mov_b32 s21, 0
    s_mov_b32 s22, 0
    s_lshl_b32 s24, s25, 12
    s_add_u32 m0, s24, 0
    s_add_u32 s23, s21, 0
    buffer_load_dwordx4 v4, s[8:11], s23 offen lds
    s_add_u32 m0, s24, 1024
    s_add_u32 s23, s21, 7168
    buffer_load_dwordx4 v5, s[8:11], s23 offen lds
    s_add_u32 m0, s24, 2048
    s_add_u32 s23, s21, 14336
    buffer_load_dwordx4 v4, s[8:11], s23 offen lds
    s_add_u32 m0, s24, 3072
    s_add_u32 s23, s21, 21504
    buffer_load_dwordx4 v5, s[8:11], s23 offen lds
    s_add_u32 m0, s24, 32768
    s_add_u32 s23, s22, 0
    buffer_load_dwordx4 v6, s[12:15], s23 offen lds
    s_add_u32 m0, s24, 33792
    s_add_u32 s23, s22, 16384
    buffer_load_dwordx4 v7, s[12:15], s23 offen lds
    s_add_u32 m0, s24, 34816
    s_add_u32 s23, s22, 32768
    buffer_load_dwordx4 v6, s[12:15], s23 offen lds
    s_add_u32 m0, s24, 35840
    s_add_u32 s23, s22, 49152
    buffer_load_dwordx4 v7, s[12:15], s23 offen lds
    s_mov_b32 s20, 0
gk_5:
    s_waitcnt vmcnt(0)
    s_barrier
    ds_read_b128 v[192:195], v8 offset:0
    ds_read_b128 v[196:199], v8 offset:4096
    ds_read_b128 v[200:203], v8 offset:8192
    ds_read_b128 v[204:207], v8 offset:12288
    ds_read_b64_tr_b16 v[224:225], v12 offset:0
    ds_read_b64_tr_b16 v[226:227], v12 offset:2048
    ds_read_b64_tr_b16 v[228:229], v13 offset:0
    ds_read_b64_tr_b16 v[230:231], v13 offset:2048
    s_add_u32 s20, s20, 1
    s_cmp_ge_u32 s20, 7
    s_cbranch_scc1 gs_6
    s_add_u32 s21, s21, 128
    s_add_u32 s22, s22, 524288
    s_xor_b32 s24, s24, 0x10000
    s_add_u32 m0, s24, 0
    s_add_u32 s23, s21, 0
    buffer_load_dwordx4 v4, s[8:11], s23 offen lds
    s_add_u32 m0, s24, 1024
    s_add_u32 s23, s21, 7168
    buffer_load_dwordx4 v5, s[8:11], s23 offen lds
    s_add_u32 m0, s24, 2048
    s_add_u32 s23, s21, 14336
    buffer_load_dwordx4 v4, s[8:11], s23 offen lds
    s_add_u32 m0, s24, 3072
    s_add_u32 s23, s21, 21504
    buffer_load_dwordx4 v5, s[8:11], s23 offen lds
    s_add_u32 m0, s24, 32768
    s_add_u32 s23, s22, 0
    buffer_load_dwordx4 v6, s[12:15], s23 offen lds
    s_add_u32 m0, s24, 33792
    s_add_u32 s23, s22, 16384
    buffer_load_dwordx4 v7, s[12:15], s23 offen lds
    s_add_u32 m0, s24, 34816
    s_add_u32 s23, s22, 32768
    buffer_load_dwordx4 v6, s[12:15], s23 offen lds
    s_add_u32 m0, s24, 35840
    s_add_u32 s23, s22, 49152
    buffer_load_dwordx4 v7, s[12:15], s23 offen lds
gs_6:
    ds_read_b128 v[208:211], v9 offset:0
    ds_read_b128 v[212:215], v9 offset:4096
    ds_read_b128 v[216:219], v9 offset:8192
    ds_read_b128 v[220:223], v9 offset:12288
    ds_read_b64_tr_b16 v[232:233], v12 offset:8192
    ds_read_b64_tr_b16 v[234:235], v12 offset:10240
    ds_read_b64_tr_b16 v[236:237], v13 offset:8192
    ds_read_b64_tr_b16 v[238:239], v13 offset:10240
    s_waitcnt lgkmcnt(8)
    v_mfma_f32_32x32x16_bf16 v[64:79], v[224:227], v[192:195], v[64:79]
    v_mfma_f32_32x32x16_bf16 v[80:95], v[228:231], v[192:195], v[80:95]
    v_mfma_f32_32x32x16_bf16 v[96:111], v[224:227], v[196:199], v[96:111]
    v_mfma_f32_32x32x16_bf16 v[112:127], v[228:231], v[196:199], v[112:127]
    v_mfma_f32_32x32x16_bf16 v[128:143], v[224:227], v[200:203], v[128:143]
    v_mfma_f32_32x32x16_bf16 v[144:159], v[228:231], v[200:203], v[144:159]
    v_mfma_f32_32x32x16_bf16 v[160:175], v[224:227], v[204:207], v[160:175]
    v_mfma_f32_32x32x16_bf16 v[176:191], v[228:231], v[204:207], v[176:191]
    ds_read_b128 v[192:195], v10 offset:0
    ds_read_b128 v[196:199], v10 offset:4096
    ds_read_b128 v[200:203], v10 offset:8192
    ds_read_b128 v[204:207], v10 offset:12288
    ds_read_b64_tr_b16 v[224:225], v12 offset:16384
    ds_read_b64_tr_b16 v[226:227], v12 offset:18432
    ds_read_b64_tr_b16 v[228:229], v13 offset:16384
    ds_read_b64_tr_b16 v[230:231], v13 offset:18432
    s_waitcnt lgkmcnt(8)
    v_mfma_f32_32x32x16_bf16 v[64:79], v[232:235], v[208:211], v[64:79]
    v_mfma_f32_32x32x16_bf16 v[80:95], v[236:239], v[208:211], v[80:95]
    v_mfma_f32_32x32x16_bf16 v[96:111], v[232:235], v[212:215], v[96:111]
    v_mfma_f32_32x32x16_bf16 v[112:127], v[236:239], v[212:215], v[112:127]
    v_mfma_f32_32x32x16_bf16 v[128:143], v[232:235], v[216:219], v[128:143]
    v_mfma_f32_32x32x16_bf16 v[144:159], v[236:239], v[216:219], v[144:159]
    v_mfma_f32_32x32x16_bf16 v[160:175], v[232:235], v[220:223], v[160:175]
    v_mfma_f32_32x32x16_bf16 v[176:191], v[236:239], v[220:223], v[176:191]
    ds_read_b128 v[208:211], v11 offset:0
    ds_read_b128 v[212:215], v11 offset:4096
    ds_read_b128 v[216:219], v11 offset:8192
    ds_read_b128 v[220:223], v11 offset:12288
    ds_read_b64_tr_b16 v[232:233], v12 offset:24576
    ds_read_b64_tr_b16 v[234:235], v12 offset:26624
    ds_read_b64_tr_b16 v[236:237], v13 offset:24576
    ds_read_b64_tr_b16 v[238:239], v13 offset:26624
    s_waitcnt lgkmcnt(8)
    v_mfma_f32_32x32x16_bf16 v[64:79], v[224:227], v[192:195], v[64:79]
    v_mfma_f32_32x32x16_bf16 v[80:95], v[228:231], v[192:195], v[80:95]
    v_mfma_f32_32x32x16_bf16 v[96:111], v[224:227], v[196:199], v[96:111]
    v_mfma_f32_32x32x16_bf16 v[112:127], v[228:231], v[196:199], v[112:127]
    v_mfma_f32_32x32x16_bf16 v[128:143], v[224:227], v[200:203], v[128:143]
    v_mfma_f32_32x32x16_bf16 v[144:159], v[228:231], v[200:203], v[144:159]
    v_mfma_f32_32x32x16_bf16 v[160:175], v[224:227], v[204:207], v[160:175]
    v_mfma_f32_32x32x16_bf16 v[176:191], v[228:231], v[204:207], v[176:191]
    s_waitcnt lgkmcnt(0)
    v_mfma_f32_32x32x16_bf16 v[64:79], v[232:235], v[208:211], v[64:79]
    v_mfma_f32_32x32x16_bf16 v[80:95], v[236:239], v[208:211], v[80:95]
    v_mfma_f32_32x32x16_bf16 v[96:111], v[232:235], v[212:215], v[96:111]
    v_mfma_f32_32x32x16_bf16 v[112:127], v[236:239], v[212:215], v[112:127]
    v_mfma_f32_32x32x16_bf16 v[128:143], v[232:235], v[216:219], v[128:143]
    v_mfma_f32_32x32x16_bf16 v[144:159], v[236:239], v[216:219], v[144:159]
    v_mfma_f32_32x32x16_bf16 v[160:175], v[232:235], v[220:223], v[160:175]
    v_mfma_f32_32x32x16_bf16 v[176:191], v[236:239], v[220:223], v[176:191]
    v_xor_b32 v8, 0x10000, v8
    v_xor_b32 v9, 0x10000, v9
    v_xor_b32 v10, 0x10000, v10
    v_xor_b32 v11, 0x10000, v11
    v_xor_b32 v12, 0x10000, v12
    v_xor_b32 v13, 0x10000, v13
    s_cmp_lt_u32 s20, 7
    s_cbranch_scc1 gk_5
    s_nop 15
    s_barrier
    v_and_b32 v3, 31, v2
    v_lshrrev_b32 v14, 5, v2
    s_lshl_b32 s30, s28, 7
    v_add_u32 v3, s30, v3
    v_mul_u32_u24 v3, 528, v3
    v_lshl_add_u32 v3, v14, 3, v3
    s_lshl_b32 s30, s29, 7
    v_add_u32 v3, s30, v3
    v_cvt_pk_bf16_f32 v16, v64, v65
    v_cvt_pk_bf16_f32 v17, v66, v67
    ds_write_b64 v3, v[16:17] offset:0
    v_cvt_pk_bf16_f32 v18, v68, v69
    v_cvt_pk_bf16_f32 v19, v70, v71
    ds_write_b64 v3, v[18:19] offset:16
    v_cvt_pk_bf16_f32 v16, v72, v73
    v_cvt_pk_bf16_f32 v17, v74, v75
    ds_write_b64 v3, v[16:17] offset:32
    v_cvt_pk_bf16_f32 v18, v76, v77
    v_cvt_pk_bf16_f32 v19, v78, v79
    ds_write_b64 v3, v[18:19] offset:48
    v_cvt_pk_bf16_f32 v16, v80, v81
    v_cvt_pk_bf16_f32 v17, v82, v83
    ds_write_b64 v3, v[16:17] offset:64
    v_cvt_pk_bf16_f32 v18, v84, v85
    v_cvt_pk_bf16_f32 v19, v86, v87
    ds_write_b64 v3, v[18:19] offset:80
    v_cvt_pk_bf16_f32 v16, v88, v89
    v_cvt_pk_bf16_f32 v17, v90, v91
    ds_write_b64 v3, v[16:17] offset:96
    v_cvt_pk_bf16_f32 v18, v92, v93
    v_cvt_pk_bf16_f32 v19, v94, v95
    ds_write_b64 v3, v[18:19] offset:112
    v_cvt_pk_bf16_f32 v16, v96, v97
    v_cvt_pk_bf16_f32 v17, v98, v99
    ds_write_b64 v3, v[16:17] offset:16896
    v_cvt_pk_bf16_f32 v18, v100, v101
    v_cvt_pk_bf16_f32 v19, v102, v103
    ds_write_b64 v3, v[18:19] offset:16912
    v_cvt_pk_bf16_f32 v16, v104, v105
    v_cvt_pk_bf16_f32 v17, v106, v107
    ds_write_b64 v3, v[16:17] offset:16928
    v_cvt_pk_bf16_f32 v18, v108, v109
    v_cvt_pk_bf16_f32 v19, v110, v111
    ds_write_b64 v3, v[18:19] offset:16944
    v_cvt_pk_bf16_f32 v16, v112, v113
    v_cvt_pk_bf16_f32 v17, v114, v115
    ds_write_b64 v3, v[16:17] offset:16960
    v_cvt_pk_bf16_f32 v18, v116, v117
    v_cvt_pk_bf16_f32 v19, v118, v119
    ds_write_b64 v3, v[18:19] offset:16976
    v_cvt_pk_bf16_f32 v16, v120, v121
    v_cvt_pk_bf16_f32 v17, v122, v123
    ds_write_b64 v3, v[16:17] offset:16992
    v_cvt_pk_bf16_f32 v18, v124, v125
    v_cvt_pk_bf16_f32 v19, v126, v127
    ds_write_b64 v3, v[18:19] offset:17008
    v_cvt_pk_bf16_f32 v16, v128, v129
    v_cvt_pk_bf16_f32 v17, v130, v131
    ds_write_b64 v3, v[16:17] offset:33792
    v_cvt_pk_bf16_f32 v18, v132, v133
    v_cvt_pk_bf16_f32 v19, v134, v135
    ds_write_b64 v3, v[18:19] offset:33808
    v_cvt_pk_bf16_f32 v16, v136, v137
    v_cvt_pk_bf16_f32 v17, v138, v139
    ds_write_b64 v3, v[16:17] offset:33824
    v_cvt_pk_bf16_f32 v18, v140, v141
    v_cvt_pk_bf16_f32 v19, v142, v143
    ds_write_b64 v3, v[18:19] offset:33840
    v_cvt_pk_bf16_f32 v16, v144, v145
    v_cvt_pk_bf16_f32 v17, v146, v147
    ds_write_b64 v3, v[16:17] offset:33856
    v_cvt_pk_bf16_f32 v18, v148, v149
    v_cvt_pk_bf16_f32 v19, v150, v151
    ds_write_b64 v3, v[18:19] offset:33872
    v_cvt_pk_bf16_f32 v16, v152, v153
    v_cvt_pk_bf16_f32 v17, v154, v155
    ds_write_b64 v3, v[16:17] offset:33888
    v_cvt_pk_bf16_f32 v18, v156, v157
    v_cvt_pk_bf16_f32 v19, v158, v159
    ds_write_b64 v3, v[18:19] offset:33904
    v_cvt_pk_bf16_f32 v16, v160, v161
    v_cvt_pk_bf16_f32 v17, v162, v163
    ds_write_b64 v3, v[16:17] offset:50688
    v_cvt_pk_bf16_f32 v18, v164, v165
    v_cvt_pk_bf16_f32 v19, v166, v167
    ds_write_b64 v3, v[18:19] offset:50704
    v_cvt_pk_bf16_f32 v16, v168, v169
    v_cvt_pk_bf16_f32 v17, v170, v171
    ds_write_b64 v3, v[16:17] offset:50720
    v_cvt_pk_bf16_f32 v18, v172, v173
    v_cvt_pk_bf16_f32 v19, v174, v175
    ds_write_b64 v3, v[18:19] offset:50736
    v_cvt_pk_bf16_f32 v16, v176, v177
    v_cvt_pk_bf16_f32 v17, v178, v179
    ds_write_b64 v3, v[16:17] offset:50752
    v_cvt_pk_bf16_f32 v18, v180, v181
    v_cvt_pk_bf16_f32 v19, v182, v183
    ds_write_b64 v3, v[18:19] offset:50768
    v_cvt_pk_bf16_f32 v16, v184, v185
    v_cvt_pk_bf16_f32 v17, v186, v187
    ds_write_b64 v3, v[16:17] offset:50784
    v_cvt_pk_bf16_f32 v18, v188, v189
    v_cvt_pk_bf16_f32 v19, v190, v191
    ds_write_b64 v3, v[18:19] offset:50800
    s_waitcnt lgkmcnt(0)
    s_barrier
    v_lshrrev_b32 v3, 5, v2
    s_lshl_b32 s30, s25, 5
    v_add_u32 v3, s30, v3
    v_and_b32 v14, 31, v2
    v_mul_u32_u24 v15, 528, v3
    v_lshl_add_u32 v15, v14, 4, v15
    v_add_u32 v3, s26, v3
    s_mov_b32 s31, 8192
    v_mul_lo_u32 v3, v3, s31
    v_lshl_add_u32 v3, v14, 4, v3
    s_lshl_b32 s30, s27, 1
    v_add_u32 v3, s30, v3
    ds_read_b128 v[20:23], v15 offset:0
    ds_read_b128 v[24:27], v15 offset:1056
    ds_read_b128 v[28:31], v15 offset:2112
    ds_read_b128 v[32:35], v15 offset:3168
    s_waitcnt lgkmcnt(3)
    s_mov_b32 s30, 0
    buffer_store_dwordx4 v[20:23], v3, s[16:19], s30 offen
    s_waitcnt lgkmcnt(2)
    s_mov_b32 s30, 16384
    buffer_store_dwordx4 v[24:27], v3, s[16:19], s30 offen
    s_waitcnt lgkmcnt(1)
    s_mov_b32 s30, 32768
    buffer_store_dwordx4 v[28:31], v3, s[16:19], s30 offen
    s_waitcnt lgkmcnt(0)
    s_mov_b32 s30, 49152
    buffer_store_dwordx4 v[32:35], v3, s[16:19], s30 offen
    s_nop 1
    ds_read_b128 v[20:23], v15 offset:4224
    ds_read_b128 v[24:27], v15 offset:5280
    ds_read_b128 v[28:31], v15 offset:6336
    ds_read_b128 v[32:35], v15 offset:7392
    s_waitcnt lgkmcnt(3)
    s_mov_b32 s30, 65536
    buffer_store_dwordx4 v[20:23], v3, s[16:19], s30 offen
    s_waitcnt lgkmcnt(2)
    s_mov_b32 s30, 81920
    buffer_store_dwordx4 v[24:27], v3, s[16:19], s30 offen
    s_waitcnt lgkmcnt(1)
    s_mov_b32 s30, 98304
    buffer_store_dwordx4 v[28:31], v3, s[16:19], s30 offen
    s_waitcnt lgkmcnt(0)
    s_mov_b32 s30, 114688
    buffer_store_dwordx4 v[32:35], v3, s[16:19], s30 offen
    s_nop 1
    ds_read_b128 v[20:23], v15 offset:8448
    ds_read_b128 v[24:27], v15 offset:9504
    ds_read_b128 v[28:31], v15 offset:10560
    ds_read_b128 v[32:35], v15 offset:11616
    s_waitcnt lgkmcnt(3)
    s_mov_b32 s30, 131072
    buffer_store_dwordx4 v[20:23], v3, s[16:19], s30 offen
    s_waitcnt lgkmcnt(2)
    s_mov_b32 s30, 147456
    buffer_store_dwordx4 v[24:27], v3, s[16:19], s30 offen
    s_waitcnt lgkmcnt(1)
    s_mov_b32 s30, 163840
    buffer_store_dwordx4 v[28:31], v3, s[16:19], s30 offen
    s_waitcnt lgkmcnt(0)
    s_mov_b32 s30, 180224
    buffer_store_dwordx4 v[32:35], v3, s[16:19], s30 offen
    s_nop 1
    ds_read_b128 v[20:23], v15 offset:12672
    ds_read_b128 v[24:27], v15 offset:13728
    ds_read_b128 v[28:31], v15 offset:14784
    ds_read_b128 v[32:35], v15 offset:15840
    s_waitcnt lgkmcnt(3)
    s_mov_b32 s30, 196608
    buffer_store_dwordx4 v[20:23], v3, s[16:19], s30 offen
    s_waitcnt lgkmcnt(2)
    s_mov_b32 s30, 212992
    buffer_store_dwordx4 v[24:27], v3, s[16:19], s30 offen
    s_waitcnt lgkmcnt(1)
    s_mov_b32 s30, 229376
    buffer_store_dwordx4 v[28:31], v3, s[16:19], s30 offen
    s_waitcnt lgkmcnt(0)
    s_mov_b32 s30, 245760
    buffer_store_dwordx4 v[32:35], v3, s[16:19], s30 offen
    s_nop 1
    s_endpgm
k2_h:
    s_sub_u32 s31, s31, 16
    s_lshl_b32 s27, s31, 8
    s_mov_b32 s12, s36
    s_mov_b32 s13, s37
    s_mov_b32 s14, 1605632
    s_mov_b32 s15, 0x00020000
    s_add_u32 s16, s4, 54525952
    s_addc_u32 s17, s5, 0
    s_mov_b32 s18, 7340032
    s_mov_b32 s19, 0x00020000
    s_and_b32 s28, s25, 1
    s_lshr_b32 s29, s25, 1
    v_lshrrev_b32 v3, 3, v2
    s_lshl_b32 s30, s25, 5
    s_add_u32 s30, s30, s26
    v_add_u32 v3, s30, v3
    s_mov_b32 s31, 896
    v_mul_lo_u32 v3, v3, s31
    v_and_b32 v14, 7, v2
    v_lshrrev_b32 v15, 4, v2
    v_xor_b32 v16, v14, v15
    v_lshl_add_u32 v4, v16, 4, v3
    v_add_u32 v15, 4, v15
    v_xor_b32 v16, v14, v15
    v_lshl_add_u32 v5, v16, 4, v3
    v_lshrrev_b32 v3, 5, v2
    s_lshl_b32 s30, s25, 3
    v_add_u32 v14, s30, v3
    s_mov_b32 s31, 3584
    v_mul_lo_u32 v14, v14, s31
    s_lshl_b32 s30, s27, 1
    v_add_u32 v14, s30, v14
    v_and_b32 v15, 3, v2
    v_lshl_add_u32 v14, v15, 4, v14
    v_bfe_u32 v15, v2, 2, 3
    v_xor_b32 v16, v15, v3
    v_lshl_add_u32 v6, v16, 6, v14
    v_add_u32 v3, 2, v3
    v_xor_b32 v16, v15, v3
    v_lshl_add_u32 v7, v16, 6, v14
    v_and_b32 v3, 31, v2
    v_lshrrev_b32 v14, 5, v2
    v_bfe_u32 v15, v2, 1, 3
    v_xor_b32 v14, v14, v15
    v_lshlrev_b32 v3, 7, v3
    v_lshl_add_u32 v3, v14, 4, v3
    s_lshl_b32 s30, s28, 14
    v_add_u32 v3, s30, v3
    v_xor_b32 v8, 0, v3
    v_xor_b32 v9, 32, v3
    v_xor_b32 v10, 64, v3
    v_xor_b32 v11, 96, v3
    v_lshrrev_b32 v3, 5, v2
    v_bfe_u32 v14, v2, 2, 2
    v_lshl_add_u32 v3, v3, 3, v14
    v_lshlrev_b32 v3, 9, v3
    v_bfe_u32 v15, v2, 4, 1
    v_lshl_add_u32 v3, v15, 5, v3
    v_and_b32 v15, 3, v2
    v_lshl_add_u32 v3, v15, 3, v3
    v_add_u32 v3, 0x8000, v3
    s_lshl_b32 s30, s29, 1
    s_add_u32 s30, s30, 0
    s_lshr_b32 s31, s30, 2
    s_lshl_b32 s31, s31, 8
    s_and_b32 s30, s30, 3
    v_xor_b32 v15, s30, v14
    v_lshl_add_u32 v15, v15, 6, v3
    v_add_u32 v12, s31, v15
    s_lshl_b32 s30, s29, 1
    s_add_u32 s30, s30, 1
    s_lshr_b32 s31, s30, 2
    s_lshl_b32 s31, s31, 8
    s_and_b32 s30, s30, 3
    v_xor_b32 v15, s30, v14
    v_lshl_add_u32 v15, v15, 6, v3
    v_add_u32 v13, s31, v15
    v_mov_b32 v64, 0
    v_mov_b32 v65, 0
    v_mov_b32 v66, 0
    v_mov_b32 v67, 0
    v_mov_b32 v68, 0
    v_mov_b32 v69, 0
    v_mov_b32 v70, 0
    v_mov_b32 v71, 0
    v_mov_b32 v72, 0
    v_mov_b32 v73, 0
    v_mov_b32 v74, 0
    v_mov_b32 v75, 0
    v_mov_b32 v76, 0
    v_mov_b32 v77, 0
    v_mov_b32 v78, 0
    v_mov_b32 v79, 0
    v_mov_b32 v80, 0
    v_mov_b32 v81, 0
    v_mov_b32 v82, 0
    v_mov_b32 v83, 0
    v_mov_b32 v84, 0
    v_mov_b32 v85, 0
    v_mov_b32 v86, 0
    v_mov_b32 v87, 0
    v_mov_b32 v88, 0
    v_mov_b32 v89, 0
    v_mov_b32 v90, 0
    v_mov_b32 v91, 0
    v_mov_b32 v92, 0
    v_mov_b32 v93, 0
    v_mov_b32 v94, 0
    v_mov_b32 v95, 0
    v_mov_b32 v96, 0
    v_mov_b32 v97, 0
    v_mov_b32 v98, 0
    v_mov_b32 v99, 0
    v_mov_b32 v100, 0
    v_mov_b32 v101, 0
    v_mov_b32 v102, 0
    v_mov_b32 v103, 0
    v_mov_b32 v104, 0
    v_mov_b32 v105, 0
    v_mov_b32 v106, 0
    v_mov_b32 v107, 0
    v_mov_b32 v108, 0
    v_mov_b32 v109, 0
    v_mov_b32 v110, 0
    v_mov_b32 v111, 0
    v_mov_b32 v112, 0
    v_mov_b32 v113, 0
    v_mov_b32 v114, 0
    v_mov_b32 v115, 0
    v_mov_b32 v116, 0
    v_mov_b32 v117, 0
    v_mov_b32 v118, 0
    v_mov_b32 v119, 0
    v_mov_b32 v120, 0
    v_mov_b32 v121, 0
    v_mov_b32 v122, 0
    v_mov_b32 v123, 0
    v_mov_b32 v124, 0
    v_mov_b32 v125, 0
    v_mov_b32 v126, 0
    v_mov_b32 v127, 0
    v_mov_b32 v128, 0
    v_mov_b32 v129, 0
    v_mov_b32 v130, 0
    v_mov_b32 v131, 0
    v_mov_b32 v132, 0
    v_mov_b32 v133, 0
    v_mov_b32 v134, 0
    v_mov_b32 v135, 0
    v_mov_b32 v136, 0
    v_mov_b32 v137, 0
    v_mov_b32 v138, 0
    v_mov_b32 v139, 0
    v_mov_b32 v140, 0
    v_mov_b32 v141, 0
    v_mov_b32 v142, 0
    v_mov_b32 v143, 0
    v_mov_b32 v144, 0
    v_mov_b32 v145, 0
    v_mov_b32 v146, 0
    v_mov_b32 v147, 0
    v_mov_b32 v148, 0
    v_mov_b32 v149, 0
    v_mov_b32 v150, 0
    v_mov_b32 v151, 0
    v_mov_b32 v152, 0
    v_mov_b32 v153, 0
    v_mov_b32 v154, 0
    v_mov_b32 v155, 0
    v_mov_b32 v156, 0
    v_mov_b32 v157, 0
    v_mov_b32 v158, 0
    v_mov_b32 v159, 0
    v_mov_b32 v160, 0
    v_mov_b32 v161, 0
    v_mov_b32 v162, 0
    v_mov_b32 v163, 0
    v_mov_b32 v164, 0
    v_mov_b32 v165, 0
    v_mov_b32 v166, 0
    v_mov_b32 v167, 0
    v_mov_b32 v168, 0
    v_mov_b32 v169, 0
    v_mov_b32 v170, 0
    v_mov_b32 v171, 0
    v_mov_b32 v172, 0
    v_mov_b32 v173, 0
    v_mov_b32 v174, 0
    v_mov_b32 v175, 0
    v_mov_b32 v176, 0
    v_mov_b32 v177, 0
    v_mov_b32 v178, 0
    v_mov_b32 v179, 0
    v_mov_b32 v180, 0
    v_mov_b32 v181, 0
    v_mov_b32 v182, 0
    v_mov_b32 v183, 0
    v_mov_b32 v184, 0
    v_mov_b32 v185, 0
    v_mov_b32 v186, 0
    v_mov_b32 v187, 0
    v_mov_b32 v188, 0
    v_mov_b32 v189, 0
    v_mov_b32 v190, 0
    v_mov_b32 v191, 0
    s_mov_b32 s21, 0
    s_mov_b32 s22, 0
    s_lshl_b32 s24, s25, 12
    s_add_u32 m0, s24, 0
    s_add_u32 s23, s21, 0
    buffer_load_dwordx4 v4, s[8:11], s23 offen lds
    s_add_u32 m0, s24, 1024
    s_add_u32 s23, s21, 7168
    buffer_load_dwordx4 v5, s[8:11], s23 offen lds
    s_add_u32 m0, s24, 2048
    s_add_u32 s23, s21, 14336
    buffer_load_dwordx4 v4, s[8:11], s23 offen lds
    s_add_u32 m0, s24, 3072
    s_add_u32 s23, s21, 21504
    buffer_load_dwordx4 v5, s[8:11], s23 offen lds
    s_add_u32 m0, s24, 32768
    s_add_u32 s23, s22, 0
    buffer_load_dwordx4 v6, s[12:15], s23 offen lds
    s_add_u32 m0, s24, 33792
    s_add_u32 s23, s22, 7168
    buffer_load_dwordx4 v7, s[12:15], s23 offen lds
    s_add_u32 m0, s24, 34816
    s_add_u32 s23, s22, 14336
    buffer_load_dwordx4 v6, s[12:15], s23 offen lds
    s_add_u32 m0, s24, 35840
    s_add_u32 s23, s22, 21504
    buffer_load_dwordx4 v7, s[12:15], s23 offen lds
    s_mov_b32 s20, 0
gk_7:
    s_waitcnt vmcnt(0)
    s_barrier
    ds_read_b128 v[192:195], v8 offset:0
    ds_read_b128 v[196:199], v8 offset:4096
    ds_read_b128 v[200:203], v8 offset:8192
    ds_read_b128 v[204:207], v8 offset:12288
    ds_read_b64_tr_b16 v[224:225], v12 offset:0
    ds_read_b64_tr_b16 v[226:227], v12 offset:2048
    ds_read_b64_tr_b16 v[228:229], v13 offset:0
    ds_read_b64_tr_b16 v[230:231], v13 offset:2048
    s_add_u32 s20, s20, 1
    s_cmp_ge_u32 s20, 7
    s_cbranch_scc1 gs_8
    s_add_u32 s21, s21, 128
    s_add_u32 s22, s22, 229376
    s_xor_b32 s24, s24, 0x10000
    s_add_u32 m0, s24, 0
    s_add_u32 s23, s21, 0
    buffer_load_dwordx4 v4, s[8:11], s23 offen lds
    s_add_u32 m0, s24, 1024
    s_add_u32 s23, s21, 7168
    buffer_load_dwordx4 v5, s[8:11], s23 offen lds
    s_add_u32 m0, s24, 2048
    s_add_u32 s23, s21, 14336
    buffer_load_dwordx4 v4, s[8:11], s23 offen lds
    s_add_u32 m0, s24, 3072
    s_add_u32 s23, s21, 21504
    buffer_load_dwordx4 v5, s[8:11], s23 offen lds
    s_add_u32 m0, s24, 32768
    s_add_u32 s23, s22, 0
    buffer_load_dwordx4 v6, s[12:15], s23 offen lds
    s_add_u32 m0, s24, 33792
    s_add_u32 s23, s22, 7168
    buffer_load_dwordx4 v7, s[12:15], s23 offen lds
    s_add_u32 m0, s24, 34816
    s_add_u32 s23, s22, 14336
    buffer_load_dwordx4 v6, s[12:15], s23 offen lds
    s_add_u32 m0, s24, 35840
    s_add_u32 s23, s22, 21504
    buffer_load_dwordx4 v7, s[12:15], s23 offen lds
gs_8:
    ds_read_b128 v[208:211], v9 offset:0
    ds_read_b128 v[212:215], v9 offset:4096
    ds_read_b128 v[216:219], v9 offset:8192
    ds_read_b128 v[220:223], v9 offset:12288
    ds_read_b64_tr_b16 v[232:233], v12 offset:8192
    ds_read_b64_tr_b16 v[234:235], v12 offset:10240
    ds_read_b64_tr_b16 v[236:237], v13 offset:8192
    ds_read_b64_tr_b16 v[238:239], v13 offset:10240
    s_waitcnt lgkmcnt(8)
    v_mfma_f32_32x32x16_bf16 v[64:79], v[224:227], v[192:195], v[64:79]
    v_mfma_f32_32x32x16_bf16 v[80:95], v[228:231], v[192:195], v[80:95]
    v_mfma_f32_32x32x16_bf16 v[96:111], v[224:227], v[196:199], v[96:111]
    v_mfma_f32_32x32x16_bf16 v[112:127], v[228:231], v[196:199], v[112:127]
    v_mfma_f32_32x32x16_bf16 v[128:143], v[224:227], v[200:203], v[128:143]
    v_mfma_f32_32x32x16_bf16 v[144:159], v[228:231], v[200:203], v[144:159]
    v_mfma_f32_32x32x16_bf16 v[160:175], v[224:227], v[204:207], v[160:175]
    v_mfma_f32_32x32x16_bf16 v[176:191], v[228:231], v[204:207], v[176:191]
    ds_read_b128 v[192:195], v10 offset:0
    ds_read_b128 v[196:199], v10 offset:4096
    ds_read_b128 v[200:203], v10 offset:8192
    ds_read_b128 v[204:207], v10 offset:12288
    ds_read_b64_tr_b16 v[224:225], v12 offset:16384
    ds_read_b64_tr_b16 v[226:227], v12 offset:18432
    ds_read_b64_tr_b16 v[228:229], v13 offset:16384
    ds_read_b64_tr_b16 v[230:231], v13 offset:18432
    s_waitcnt lgkmcnt(8)
    v_mfma_f32_32x32x16_bf16 v[64:79], v[232:235], v[208:211], v[64:79]
    v_mfma_f32_32x32x16_bf16 v[80:95], v[236:239], v[208:211], v[80:95]
    v_mfma_f32_32x32x16_bf16 v[96:111], v[232:235], v[212:215], v[96:111]
    v_mfma_f32_32x32x16_bf16 v[112:127], v[236:239], v[212:215], v[112:127]
    v_mfma_f32_32x32x16_bf16 v[128:143], v[232:235], v[216:219], v[128:143]
    v_mfma_f32_32x32x16_bf16 v[144:159], v[236:239], v[216:219], v[144:159]
    v_mfma_f32_32x32x16_bf16 v[160:175], v[232:235], v[220:223], v[160:175]
    v_mfma_f32_32x32x16_bf16 v[176:191], v[236:239], v[220:223], v[176:191]
    ds_read_b128 v[208:211], v11 offset:0
    ds_read_b128 v[212:215], v11 offset:4096
    ds_read_b128 v[216:219], v11 offset:8192
    ds_read_b128 v[220:223], v11 offset:12288
    ds_read_b64_tr_b16 v[232:233], v12 offset:24576
    ds_read_b64_tr_b16 v[234:235], v12 offset:26624
    ds_read_b64_tr_b16 v[236:237], v13 offset:24576
    ds_read_b64_tr_b16 v[238:239], v13 offset:26624
    s_waitcnt lgkmcnt(8)
    v_mfma_f32_32x32x16_bf16 v[64:79], v[224:227], v[192:195], v[64:79]
    v_mfma_f32_32x32x16_bf16 v[80:95], v[228:231], v[192:195], v[80:95]
    v_mfma_f32_32x32x16_bf16 v[96:111], v[224:227], v[196:199], v[96:111]
    v_mfma_f32_32x32x16_bf16 v[112:127], v[228:231], v[196:199], v[112:127]
    v_mfma_f32_32x32x16_bf16 v[128:143], v[224:227], v[200:203], v[128:143]
    v_mfma_f32_32x32x16_bf16 v[144:159], v[228:231], v[200:203], v[144:159]
    v_mfma_f32_32x32x16_bf16 v[160:175], v[224:227], v[204:207], v[160:175]
    v_mfma_f32_32x32x16_bf16 v[176:191], v[228:231], v[204:207], v[176:191]
    s_waitcnt lgkmcnt(0)
    v_mfma_f32_32x32x16_bf16 v[64:79], v[232:235], v[208:211], v[64:79]
    v_mfma_f32_32x32x16_bf16 v[80:95], v[236:239], v[208:211], v[80:95]
    v_mfma_f32_32x32x16_bf16 v[96:111], v[232:235], v[212:215], v[96:111]
    v_mfma_f32_32x32x16_bf16 v[112:127], v[236:239], v[212:215], v[112:127]
    v_mfma_f32_32x32x16_bf16 v[128:143], v[232:235], v[216:219], v[128:143]
    v_mfma_f32_32x32x16_bf16 v[144:159], v[236:239], v[216:219], v[144:159]
    v_mfma_f32_32x32x16_bf16 v[160:175], v[232:235], v[220:223], v[160:175]
    v_mfma_f32_32x32x16_bf16 v[176:191], v[236:239], v[220:223], v[176:191]
    v_xor_b32 v8, 0x10000, v8
    v_xor_b32 v9, 0x10000, v9
    v_xor_b32 v10, 0x10000, v10
    v_xor_b32 v11, 0x10000, v11
    v_xor_b32 v12, 0x10000, v12
    v_xor_b32 v13, 0x10000, v13
    s_cmp_lt_u32 s20, 7
    s_cbranch_scc1 gk_7
    s_nop 15
    s_barrier
    s_mov_b32 s44, s38
    s_mov_b32 s45, s39
    s_mov_b32 s46, 3584
    s_mov_b32 s47, 0x00020000
    v_lshrrev_b32 v3, 5, v2
    v_lshlrev_b32 v3, 3, v3
    s_lshl_b32 s30, s29, 6
    s_add_u32 s30, s30, s27
    s_lshl_b32 s30, s30, 1
    v_add_u32 v3, s30, v3
    buffer_load_dwordx2 v[192:193], v3, s[44:47], 0 offen offset:0
    buffer_load_dwordx2 v[196:197], v3, s[44:47], 0 offen offset:16
    buffer_load_dwordx2 v[200:201], v3, s[44:47], 0 offen offset:32
    buffer_load_dwordx2 v[204:205], v3, s[44:47], 0 offen offset:48
    buffer_load_dwordx2 v[208:209], v3, s[44:47], 0 offen offset:64
    buffer_load_dwordx2 v[212:213], v3, s[44:47], 0 offen offset:80
    buffer_load_dwordx2 v[216:217], v3, s[44:47], 0 offen offset:96
    buffer_load_dwordx2 v[220:221], v3, s[44:47], 0 offen offset:112
    s_waitcnt vmcnt(0)
    s_mov_b32 s31, 0xffff0000
    v_lshlrev_b32 v194, 16, v193
    v_and_b32 v195, s31, v193
    v_and_b32 v193, s31, v192
    v_lshlrev_b32 v192, 16, v192
    v_lshlrev_b32 v198, 16, v197
    v_and_b32 v199, s31, v197
    v_and_b32 v197, s31, v196
    v_lshlrev_b32 v196, 16, v196
    v_lshlrev_b32 v202, 16, v201
    v_and_b32 v203, s31, v201
    v_and_b32 v201, s31, v200
    v_lshlrev_b32 v200, 16, v200
    v_lshlrev_b32 v206, 16, v205
    v_and_b32 v207, s31, v205
    v_and_b32 v205, s31, v204
    v_lshlrev_b32 v204, 16, v204
    v_lshlrev_b32 v210, 16, v209
    v_and_b32 v211, s31, v209
    v_and_b32 v209, s31, v208
    v_lshlrev_b32 v208, 16, v208
    v_lshlrev_b32 v214, 16, v213
    v_and_b32 v215, s31, v213
    v_and_b32 v213, s31, v212
    v_lshlrev_b32 v212, 16, v212
    v_lshlrev_b32 v218, 16, v217
    v_and_b32 v219, s31, v217
    v_and_b32 v217, s31, v216
    v_lshlrev_b32 v216, 16, v216
    v_lshlrev_b32 v222, 16, v221
    v_and_b32 v223, s31, v221
    v_and_b32 v221, s31, v220
    v_lshlrev_b32 v220, 16, v220
    s_mov_b32 s44, 0x3fb8aa3b
    s_mov_b32 s45, 0x41f00000
    v_and_b32 v3, 31, v2
    v_lshrrev_b32 v14, 5, v2
    s_lshl_b32 s30, s28, 7
    v_add_u32 v3, s30, v3
    v_mul_u32_u24 v3, 528, v3
    v_lshl_add_u32 v3, v14, 3, v3
    s_lshl_b32 s30, s29, 7
    v_add_u32 v3, s30, v3
    v_cvt_pk_bf16_f32 v240, v64, v65
    v_lshlrev_b32 v64, 16, v240
    v_and_b32 v65, s31, v240
    v_cvt_pk_bf16_f32 v240, v66, v67
    v_lshlrev_b32 v66, 16, v240
    v_and_b32 v67, s31, v240
    v_cvt_pk_bf16_f32 v240, v68, v69
    v_lshlrev_b32 v68, 16, v240
    v_and_b32 v69, s31, v240
    v_cvt_pk_bf16_f32 v240, v70, v71
    v_lshlrev_b32 v70, 16, v240
    v_and_b32 v71, s31, v240
    v_cvt_pk_bf16_f32 v240, v72, v73
    v_lshlrev_b32 v72, 16, v240
    v_and_b32 v73, s31, v240
    v_cvt_pk_bf16_f32 v240, v74, v75
    v_lshlrev_b32 v74, 16, v240
    v_and_b32 v75, s31, v240
    v_cvt_pk_bf16_f32 v240, v76, v77
    v_lshlrev_b32 v76, 16, v240
    v_and_b32 v77, s31, v240
    v_cvt_pk_bf16_f32 v240, v78, v79
    v_lshlrev_b32 v78, 16, v240
    v_and_b32 v79, s31, v240
    v_add_f32 v64, v64, v192
    v_add_f32 v65, v65, v193
    v_add_f32 v66, v66, v194
    v_add_f32 v67, v67, v195
    v_add_f32 v68, v68, v196
    v_add_f32 v69, v69, v197
    v_add_f32 v70, v70, v198
    v_add_f32 v71, v71, v199
    v_add_f32 v72, v72, v200
    v_add_f32 v73, v73, v201
    v_add_f32 v74, v74, v202
    v_add_f32 v75, v75, v203
    v_add_f32 v76, v76, v204
    v_add_f32 v77, v77, v205
    v_add_f32 v78, v78, v206
    v_add_f32 v79, v79, v207
    v_cvt_pk_bf16_f32 v240, v64, v65
    v_lshlrev_b32 v64, 16, v240
    v_and_b32 v65, s31, v240
    v_cvt_pk_bf16_f32 v240, v66, v67
    v_lshlrev_b32 v66, 16, v240
    v_and_b32 v67, s31, v240
    v_cvt_pk_bf16_f32 v240, v68, v69
    v_lshlrev_b32 v68, 16, v240
    v_and_b32 v69, s31, v240
    v_cvt_pk_bf16_f32 v240, v70, v71
    v_lshlrev_b32 v70, 16, v240
    v_and_b32 v71, s31, v240
    v_cvt_pk_bf16_f32 v240, v72, v73
    v_lshlrev_b32 v72, 16, v240
    v_and_b32 v73, s31, v240
    v_cvt_pk_bf16_f32 v240, v74, v75
    v_lshlrev_b32 v74, 16, v240
    v_and_b32 v75, s31, v240
    v_cvt_pk_bf16_f32 v240, v76, v77
    v_lshlrev_b32 v76, 16, v240
    v_and_b32 v77, s31, v240
    v_cvt_pk_bf16_f32 v240, v78, v79
    v_lshlrev_b32 v78, 16, v240
    v_and_b32 v79, s31, v240
    v_min_f32 v241, s45, v64
    v_mul_f32 v241, s44, v241
    v_exp_f32 v241, v241
    s_nop 0
    v_add_f32 v242, 2.0, v241
    v_mul_f32 v242, v242, v241
    v_add_f32 v243, 2.0, v242
    v_rcp_f32 v243, v243
    s_nop 0
    v_mul_f32 v242, v242, v243
    v_mul_f32 v64, v64, v242
    v_min_f32 v241, s45, v65
    v_mul_f32 v241, s44, v241
    v_exp_f32 v241, v241
    s_nop 0
    v_add_f32 v242, 2.0, v241
    v_mul_f32 v242, v242, v241
    v_add_f32 v243, 2.0, v242
    v_rcp_f32 v243, v243
    s_nop 0
    v_mul_f32 v242, v242, v243
    v_mul_f32 v65, v65, v242
    v_min_f32 v241, s45, v66
    v_mul_f32 v241, s44, v241
    v_exp_f32 v241, v241
    s_nop 0
    v_add_f32 v242, 2.0, v241
    v_mul_f32 v242, v242, v241
    v_add_f32 v243, 2.0, v242
    v_rcp_f32 v243, v243
    s_nop 0
    v_mul_f32 v242, v242, v243
    v_mul_f32 v66, v66, v242
    v_min_f32 v241, s45, v67
    v_mul_f32 v241, s44, v241
    v_exp_f32 v241, v241
    s_nop 0
    v_add_f32 v242, 2.0, v241
    v_mul_f32 v242, v242, v241
    v_add_f32 v243, 2.0, v242
    v_rcp_f32 v243, v243
    s_nop 0
    v_mul_f32 v242, v242, v243
    v_mul_f32 v67, v67, v242
    v_min_f32 v241, s45, v68
    v_mul_f32 v241, s44, v241
    v_exp_f32 v241, v241
    s_nop 0
    v_add_f32 v242, 2.0, v241
    v_mul_f32 v242, v242, v241
    v_add_f32 v243, 2.0, v242
    v_rcp_f32 v243, v243
    s_nop 0
    v_mul_f32 v242, v242, v243
    v_mul_f32 v68, v68, v242
    v_min_f32 v241, s45, v69
    v_mul_f32 v241, s44, v241
    v_exp_f32 v241, v241
    s_nop 0
    v_add_f32 v242, 2.0, v241
    v_mul_f32 v242, v242, v241
    v_add_f32 v243, 2.0, v242
    v_rcp_f32 v243, v243
    s_nop 0
    v_mul_f32 v242, v242, v243
    v_mul_f32 v69, v69, v242
    v_min_f32 v241, s45, v70
    v_mul_f32 v241, s44, v241
    v_exp_f32 v241, v241
    s_nop 0
    v_add_f32 v242, 2.0, v241
    v_mul_f32 v242, v242, v241
    v_add_f32 v243, 2.0, v242
    v_rcp_f32 v243, v243
    s_nop 0
    v_mul_f32 v242, v242, v243
    v_mul_f32 v70, v70, v242
    v_min_f32 v241, s45, v71
    v_mul_f32 v241, s44, v241
    v_exp_f32 v241, v241
    s_nop 0
    v_add_f32 v242, 2.0, v241
    v_mul_f32 v242, v242, v241
    v_add_f32 v243, 2.0, v242
    v_rcp_f32 v243, v243
    s_nop 0
    v_mul_f32 v242, v242, v243
    v_mul_f32 v71, v71, v242
    v_min_f32 v241, s45, v72
    v_mul_f32 v241, s44, v241
    v_exp_f32 v241, v241
    s_nop 0
    v_add_f32 v242, 2.0, v241
    v_mul_f32 v242, v242, v241
    v_add_f32 v243, 2.0, v242
    v_rcp_f32 v243, v243
    s_nop 0
    v_mul_f32 v242, v242, v243
    v_mul_f32 v72, v72, v242
    v_min_f32 v241, s45, v73
    v_mul_f32 v241, s44, v241
    v_exp_f32 v241, v241
    s_nop 0
    v_add_f32 v242, 2.0, v241
    v_mul_f32 v242, v242, v241
    v_add_f32 v243, 2.0, v242
    v_rcp_f32 v243, v243
    s_nop 0
    v_mul_f32 v242, v242, v243
    v_mul_f32 v73, v73, v242
    v_min_f32 v241, s45, v74
    v_mul_f32 v241, s44, v241
    v_exp_f32 v241, v241
    s_nop 0
    v_add_f32 v242, 2.0, v241
    v_mul_f32 v242, v242, v241
    v_add_f32 v243, 2.0, v242
    v_rcp_f32 v243, v243
    s_nop 0
    v_mul_f32 v242, v242, v243
    v_mul_f32 v74, v74, v242
    v_min_f32 v241, s45, v75
    v_mul_f32 v241, s44, v241
    v_exp_f32 v241, v241
    s_nop 0
    v_add_f32 v242, 2.0, v241
    v_mul_f32 v242, v242, v241
    v_add_f32 v243, 2.0, v242
    v_rcp_f32 v243, v243
    s_nop 0
    v_mul_f32 v242, v242, v243
    v_mul_f32 v75, v75, v242
    v_min_f32 v241, s45, v76
    v_mul_f32 v241, s44, v241
    v_exp_f32 v241, v241
    s_nop 0
    v_add_f32 v242, 2.0, v241
    v_mul_f32 v242, v242, v241
    v_add_f32 v243, 2.0, v242
    v_rcp_f32 v243, v243
    s_nop 0
    v_mul_f32 v242, v242, v243
    v_mul_f32 v76, v76, v242
    v_min_f32 v241, s45, v77
    v_mul_f32 v241, s44, v241
    v_exp_f32 v241, v241
    s_nop 0
    v_add_f32 v242, 2.0, v241
    v_mul_f32 v242, v242, v241
    v_add_f32 v243, 2.0, v242
    v_rcp_f32 v243, v243
    s_nop 0
    v_mul_f32 v242, v242, v243
    v_mul_f32 v77, v77, v242
    v_min_f32 v241, s45, v78
    v_mul_f32 v241, s44, v241
    v_exp_f32 v241, v241
    s_nop 0
    v_add_f32 v242, 2.0, v241
    v_mul_f32 v242, v242, v241
    v_add_f32 v243, 2.0, v242
    v_rcp_f32 v243, v243
    s_nop 0
    v_mul_f32 v242, v242, v243
    v_mul_f32 v78, v78, v242
    v_min_f32 v241, s45, v79
    v_mul_f32 v241, s44, v241
    v_exp_f32 v241, v241
    s_nop 0
    v_add_f32 v242, 2.0, v241
    v_mul_f32 v242, v242, v241
    v_add_f32 v243, 2.0, v242
    v_rcp_f32 v243, v243
    s_nop 0
    v_mul_f32 v242, v242, v243
    v_mul_f32 v79, v79, v242
    v_cvt_pk_bf16_f32 v16, v64, v65
    v_cvt_pk_bf16_f32 v17, v66, v67
    ds_write_b64 v3, v[16:17] offset:0
    v_cvt_pk_bf16_f32 v18, v68, v69
    v_cvt_pk_bf16_f32 v19, v70, v71
    ds_write_b64 v3, v[18:19] offset:16
    v_cvt_pk_bf16_f32 v16, v72, v73
    v_cvt_pk_bf16_f32 v17, v74, v75
    ds_write_b64 v3, v[16:17] offset:32
    v_cvt_pk_bf16_f32 v18, v76, v77
    v_cvt_pk_bf16_f32 v19, v78, v79
    ds_write_b64 v3, v[18:19] offset:48
    v_cvt_pk_bf16_f32 v240, v80, v81
    v_lshlrev_b32 v80, 16, v240
    v_and_b32 v81, s31, v240
    v_cvt_pk_bf16_f32 v240, v82, v83
    v_lshlrev_b32 v82, 16, v240
    v_and_b32 v83, s31, v240
    v_cvt_pk_bf16_f32 v240, v84, v85
    v_lshlrev_b32 v84, 16, v240
    v_and_b32 v85, s31, v240
    v_cvt_pk_bf16_f32 v240, v86, v87
    v_lshlrev_b32 v86, 16, v240
    v_and_b32 v87, s31, v240
    v_cvt_pk_bf16_f32 v240, v88, v89
    v_lshlrev_b32 v88, 16, v240
    v_and_b32 v89, s31, v240
    v_cvt_pk_bf16_f32 v240, v90, v91
    v_lshlrev_b32 v90, 16, v240
    v_and_b32 v91, s31, v240
    v_cvt_pk_bf16_f32 v240, v92, v93
    v_lshlrev_b32 v92, 16, v240
    v_and_b32 v93, s31, v240
    v_cvt_pk_bf16_f32 v240, v94, v95
    v_lshlrev_b32 v94, 16, v240
    v_and_b32 v95, s31, v240
    v_add_f32 v80, v80, v208
    v_add_f32 v81, v81, v209
    v_add_f32 v82, v82, v210
    v_add_f32 v83, v83, v211
    v_add_f32 v84, v84, v212
    v_add_f32 v85, v85, v213
    v_add_f32 v86, v86, v214
    v_add_f32 v87, v87, v215
    v_add_f32 v88, v88, v216
    v_add_f32 v89, v89, v217
    v_add_f32 v90, v90, v218
    v_add_f32 v91, v91, v219
    v_add_f32 v92, v92, v220
    v_add_f32 v93, v93, v221
    v_add_f32 v94, v94, v222
    v_add_f32 v95, v95, v223
    v_cvt_pk_bf16_f32 v240, v80, v81
    v_lshlrev_b32 v80, 16, v240
    v_and_b32 v81, s31, v240
    v_cvt_pk_bf16_f32 v240, v82, v83
    v_lshlrev_b32 v82, 16, v240
    v_and_b32 v83, s31, v240
    v_cvt_pk_bf16_f32 v240, v84, v85
    v_lshlrev_b32 v84, 16, v240
    v_and_b32 v85, s31, v240
    v_cvt_pk_bf16_f32 v240, v86, v87
    v_lshlrev_b32 v86, 16, v240
    v_and_b32 v87, s31, v240
    v_cvt_pk_bf16_f32 v240, v88, v89
    v_lshlrev_b32 v88, 16, v240
    v_and_b32 v89, s31, v240
    v_cvt_pk_bf16_f32 v240, v90, v91
    v_lshlrev_b32 v90, 16, v240
    v_and_b32 v91, s31, v240
    v_cvt_pk_bf16_f32 v240, v92, v93
    v_lshlrev_b32 v92, 16, v240
    v_and_b32 v93, s31, v240
    v_cvt_pk_bf16_f32 v240, v94, v95
    v_lshlrev_b32 v94, 16, v240
    v_and_b32 v95, s31, v240
    v_min_f32 v241, s45, v80
    v_mul_f32 v241, s44, v241
    v_exp_f32 v241, v241
    s_nop 0
    v_add_f32 v242, 2.0, v241
    v_mul_f32 v242, v242, v241
    v_add_f32 v243, 2.0, v242
    v_rcp_f32 v243, v243
    s_nop 0
    v_mul_f32 v242, v242, v243
    v_mul_f32 v80, v80, v242
    v_min_f32 v241, s45, v81
    v_mul_f32 v241, s44, v241
    v_exp_f32 v241, v241
    s_nop 0
    v_add_f32 v242, 2.0, v241
    v_mul_f32 v242, v242, v241
    v_add_f32 v243, 2.0, v242
    v_rcp_f32 v243, v243
    s_nop 0
    v_mul_f32 v242, v242, v243
    v_mul_f32 v81, v81, v242
    v_min_f32 v241, s45, v82
    v_mul_f32 v241, s44, v241
    v_exp_f32 v241, v241
    s_nop 0
    v_add_f32 v242, 2.0, v241
    v_mul_f32 v242, v242, v241
    v_add_f32 v243, 2.0, v242
    v_rcp_f32 v243, v243
    s_nop 0
    v_mul_f32 v242, v242, v243
    v_mul_f32 v82, v82, v242
    v_min_f32 v241, s45, v83
    v_mul_f32 v241, s44, v241
    v_exp_f32 v241, v241
    s_nop 0
    v_add_f32 v242, 2.0, v241
    v_mul_f32 v242, v242, v241
    v_add_f32 v243, 2.0, v242
    v_rcp_f32 v243, v243
    s_nop 0
    v_mul_f32 v242, v242, v243
    v_mul_f32 v83, v83, v242
    v_min_f32 v241, s45, v84
    v_mul_f32 v241, s44, v241
    v_exp_f32 v241, v241
    s_nop 0
    v_add_f32 v242, 2.0, v241
    v_mul_f32 v242, v242, v241
    v_add_f32 v243, 2.0, v242
    v_rcp_f32 v243, v243
    s_nop 0
    v_mul_f32 v242, v242, v243
    v_mul_f32 v84, v84, v242
    v_min_f32 v241, s45, v85
    v_mul_f32 v241, s44, v241
    v_exp_f32 v241, v241
    s_nop 0
    v_add_f32 v242, 2.0, v241
    v_mul_f32 v242, v242, v241
    v_add_f32 v243, 2.0, v242
    v_rcp_f32 v243, v243
    s_nop 0
    v_mul_f32 v242, v242, v243
    v_mul_f32 v85, v85, v242
    v_min_f32 v241, s45, v86
    v_mul_f32 v241, s44, v241
    v_exp_f32 v241, v241
    s_nop 0
    v_add_f32 v242, 2.0, v241
    v_mul_f32 v242, v242, v241
    v_add_f32 v243, 2.0, v242
    v_rcp_f32 v243, v243
    s_nop 0
    v_mul_f32 v242, v242, v243
    v_mul_f32 v86, v86, v242
    v_min_f32 v241, s45, v87
    v_mul_f32 v241, s44, v241
    v_exp_f32 v241, v241
    s_nop 0
    v_add_f32 v242, 2.0, v241
    v_mul_f32 v242, v242, v241
    v_add_f32 v243, 2.0, v242
    v_rcp_f32 v243, v243
    s_nop 0
    v_mul_f32 v242, v242, v243
    v_mul_f32 v87, v87, v242
    v_min_f32 v241, s45, v88
    v_mul_f32 v241, s44, v241
    v_exp_f32 v241, v241
    s_nop 0
    v_add_f32 v242, 2.0, v241
    v_mul_f32 v242, v242, v241
    v_add_f32 v243, 2.0, v242
    v_rcp_f32 v243, v243
    s_nop 0
    v_mul_f32 v242, v242, v243
    v_mul_f32 v88, v88, v242
    v_min_f32 v241, s45, v89
    v_mul_f32 v241, s44, v241
    v_exp_f32 v241, v241
    s_nop 0
    v_add_f32 v242, 2.0, v241
    v_mul_f32 v242, v242, v241
    v_add_f32 v243, 2.0, v242
    v_rcp_f32 v243, v243
    s_nop 0
    v_mul_f32 v242, v242, v243
    v_mul_f32 v89, v89, v242
    v_min_f32 v241, s45, v90
    v_mul_f32 v241, s44, v241
    v_exp_f32 v241, v241
    s_nop 0
    v_add_f32 v242, 2.0, v241
    v_mul_f32 v242, v242, v241
    v_add_f32 v243, 2.0, v242
    v_rcp_f32 v243, v243
    s_nop 0
    v_mul_f32 v242, v242, v243
    v_mul_f32 v90, v90, v242
    v_min_f32 v241, s45, v91
    v_mul_f32 v241, s44, v241
    v_exp_f32 v241, v241
    s_nop 0
    v_add_f32 v242, 2.0, v241
    v_mul_f32 v242, v242, v241
    v_add_f32 v243, 2.0, v242
    v_rcp_f32 v243, v243
    s_nop 0
    v_mul_f32 v242, v242, v243
    v_mul_f32 v91, v91, v242
    v_min_f32 v241, s45, v92
    v_mul_f32 v241, s44, v241
    v_exp_f32 v241, v241
    s_nop 0
    v_add_f32 v242, 2.0, v241
    v_mul_f32 v242, v242, v241
    v_add_f32 v243, 2.0, v242
    v_rcp_f32 v243, v243
    s_nop 0
    v_mul_f32 v242, v242, v243
    v_mul_f32 v92, v92, v242
    v_min_f32 v241, s45, v93
    v_mul_f32 v241, s44, v241
    v_exp_f32 v241, v241
    s_nop 0
    v_add_f32 v242, 2.0, v241
    v_mul_f32 v242, v242, v241
    v_add_f32 v243, 2.0, v242
    v_rcp_f32 v243, v243
    s_nop 0
    v_mul_f32 v242, v242, v243
    v_mul_f32 v93, v93, v242
    v_min_f32 v241, s45, v94
    v_mul_f32 v241, s44, v241
    v_exp_f32 v241, v241
    s_nop 0
    v_add_f32 v242, 2.0, v241
    v_mul_f32 v242, v242, v241
    v_add_f32 v243, 2.0, v242
    v_rcp_f32 v243, v243
    s_nop 0
    v_mul_f32 v242, v242, v243
    v_mul_f32 v94, v94, v242
    v_min_f32 v241, s45, v95
    v_mul_f32 v241, s44, v241
    v_exp_f32 v241, v241
    s_nop 0
    v_add_f32 v242, 2.0, v241
    v_mul_f32 v242, v242, v241
    v_add_f32 v243, 2.0, v242
    v_rcp_f32 v243, v243
    s_nop 0
    v_mul_f32 v242, v242, v243
    v_mul_f32 v95, v95, v242
    v_cvt_pk_bf16_f32 v16, v80, v81
    v_cvt_pk_bf16_f32 v17, v82, v83
    ds_write_b64 v3, v[16:17] offset:64
    v_cvt_pk_bf16_f32 v18, v84, v85
    v_cvt_pk_bf16_f32 v19, v86, v87
    ds_write_b64 v3, v[18:19] offset:80
    v_cvt_pk_bf16_f32 v16, v88, v89
    v_cvt_pk_bf16_f32 v17, v90, v91
    ds_write_b64 v3, v[16:17] offset:96
    v_cvt_pk_bf16_f32 v18, v92, v93
    v_cvt_pk_bf16_f32 v19, v94, v95
    ds_write_b64 v3, v[18:19] offset:112
    v_cvt_pk_bf16_f32 v240, v96, v97
    v_lshlrev_b32 v96, 16, v240
    v_and_b32 v97, s31, v240
    v_cvt_pk_bf16_f32 v240, v98, v99
    v_lshlrev_b32 v98, 16, v240
    v_and_b32 v99, s31, v240
    v_cvt_pk_bf16_f32 v240, v100, v101
    v_lshlrev_b32 v100, 16, v240
    v_and_b32 v101, s31, v240
    v_cvt_pk_bf16_f32 v240, v102, v103
    v_lshlrev_b32 v102, 16, v240
    v_and_b32 v103, s31, v240
    v_cvt_pk_bf16_f32 v240, v104, v105
    v_lshlrev_b32 v104, 16, v240
    v_and_b32 v105, s31, v240
    v_cvt_pk_bf16_f32 v240, v106, v107
    v_lshlrev_b32 v106, 16, v240
    v_and_b32 v107, s31, v240
    v_cvt_pk_bf16_f32 v240, v108, v109
    v_lshlrev_b32 v108, 16, v240
    v_and_b32 v109, s31, v240
    v_cvt_pk_bf16_f32 v240, v110, v111
    v_lshlrev_b32 v110, 16, v240
    v_and_b32 v111, s31, v240
    v_add_f32 v96, v96, v192
    v_add_f32 v97, v97, v193
    v_add_f32 v98, v98, v194
    v_add_f32 v99, v99, v195
    v_add_f32 v100, v100, v196
    v_add_f32 v101, v101, v197
    v_add_f32 v102, v102, v198
    v_add_f32 v103, v103, v199
    v_add_f32 v104, v104, v200
    v_add_f32 v105, v105, v201
    v_add_f32 v106, v106, v202
    v_add_f32 v107, v107, v203
    v_add_f32 v108, v108, v204
    v_add_f32 v109, v109, v205
    v_add_f32 v110, v110, v206
    v_add_f32 v111, v111, v207
    v_cvt_pk_bf16_f32 v240, v96, v97
    v_lshlrev_b32 v96, 16, v240
    v_and_b32 v97, s31, v240
    v_cvt_pk_bf16_f32 v240, v98, v99
    v_lshlrev_b32 v98, 16, v240
    v_and_b32 v99, s31, v240
    v_cvt_pk_bf16_f32 v240, v100, v101
    v_lshlrev_b32 v100, 16, v240
    v_and_b32 v101, s31, v240
    v_cvt_pk_bf16_f32 v240, v102, v103
    v_lshlrev_b32 v102, 16, v240
    v_and_b32 v103, s31, v240
    v_cvt_pk_bf16_f32 v240, v104, v105
    v_lshlrev_b32 v104, 16, v240
    v_and_b32 v105, s31, v240
    v_cvt_pk_bf16_f32 v240, v106, v107
    v_lshlrev_b32 v106, 16, v240
    v_and_b32 v107, s31, v240
    v_cvt_pk_bf16_f32 v240, v108, v109
    v_lshlrev_b32 v108, 16, v240
    v_and_b32 v109, s31, v240
    v_cvt_pk_bf16_f32 v240, v110, v111
    v_lshlrev_b32 v110, 16, v240
    v_and_b32 v111, s31, v240
    v_min_f32 v241, s45, v96
    v_mul_f32 v241, s44, v241
    v_exp_f32 v241, v241
    s_nop 0
    v_add_f32 v242, 2.0, v241
    v_mul_f32 v242, v242, v241
    v_add_f32 v243, 2.0, v242
    v_rcp_f32 v243, v243
    s_nop 0
    v_mul_f32 v242, v242, v243
    v_mul_f32 v96, v96, v242
    v_min_f32 v241, s45, v97
    v_mul_f32 v241, s44, v241
    v_exp_f32 v241, v241
    s_nop 0
    v_add_f32 v242, 2.0, v241
    v_mul_f32 v242, v242, v241
    v_add_f32 v243, 2.0, v242
    v_rcp_f32 v243, v243
    s_nop 0
    v_mul_f32 v242, v242, v243
    v_mul_f32 v97, v97, v242
    v_min_f32 v241, s45, v98
    v_mul_f32 v241, s44, v241
    v_exp_f32 v241, v241
    s_nop 0
    v_add_f32 v242, 2.0, v241
    v_mul_f32 v242, v242, v241
    v_add_f32 v243, 2.0, v242
    v_rcp_f32 v243, v243
    s_nop 0
    v_mul_f32 v242, v242, v243
    v_mul_f32 v98, v98, v242
    v_min_f32 v241, s45, v99
    v_mul_f32 v241, s44, v241
    v_exp_f32 v241, v241
    s_nop 0
    v_add_f32 v242, 2.0, v241
    v_mul_f32 v242, v242, v241
    v_add_f32 v243, 2.0, v242
    v_rcp_f32 v243, v243
    s_nop 0
    v_mul_f32 v242, v242, v243
    v_mul_f32 v99, v99, v242
    v_min_f32 v241, s45, v100
    v_mul_f32 v241, s44, v241
    v_exp_f32 v241, v241
    s_nop 0
    v_add_f32 v242, 2.0, v241
    v_mul_f32 v242, v242, v241
    v_add_f32 v243, 2.0, v242
    v_rcp_f32 v243, v243
    s_nop 0
    v_mul_f32 v242, v242, v243
    v_mul_f32 v100, v100, v242
    v_min_f32 v241, s45, v101
    v_mul_f32 v241, s44, v241
    v_exp_f32 v241, v241
    s_nop 0
    v_add_f32 v242, 2.0, v241
    v_mul_f32 v242, v242, v241
    v_add_f32 v243, 2.0, v242
    v_rcp_f32 v243, v243
    s_nop 0
    v_mul_f32 v242, v242, v243
    v_mul_f32 v101, v101, v242
    v_min_f32 v241, s45, v102
    v_mul_f32 v241, s44, v241
    v_exp_f32 v241, v241
    s_nop 0
    v_add_f32 v242, 2.0, v241
    v_mul_f32 v242, v242, v241
    v_add_f32 v243, 2.0, v242
    v_rcp_f32 v243, v243
    s_nop 0
    v_mul_f32 v242, v242, v243
    v_mul_f32 v102, v102, v242
    v_min_f32 v241, s45, v103
    v_mul_f32 v241, s44, v241
    v_exp_f32 v241, v241
    s_nop 0
    v_add_f32 v242, 2.0, v241
    v_mul_f32 v242, v242, v241
    v_add_f32 v243, 2.0, v242
    v_rcp_f32 v243, v243
    s_nop 0
    v_mul_f32 v242, v242, v243
    v_mul_f32 v103, v103, v242
    v_min_f32 v241, s45, v104
    v_mul_f32 v241, s44, v241
    v_exp_f32 v241, v241
    s_nop 0
    v_add_f32 v242, 2.0, v241
    v_mul_f32 v242, v242, v241
    v_add_f32 v243, 2.0, v242
    v_rcp_f32 v243, v243
    s_nop 0
    v_mul_f32 v242, v242, v243
    v_mul_f32 v104, v104, v242
    v_min_f32 v241, s45, v105
    v_mul_f32 v241, s44, v241
    v_exp_f32 v241, v241
    s_nop 0
    v_add_f32 v242, 2.0, v241
    v_mul_f32 v242, v242, v241
    v_add_f32 v243, 2.0, v242
    v_rcp_f32 v243, v243
    s_nop 0
    v_mul_f32 v242, v242, v243
    v_mul_f32 v105, v105, v242
    v_min_f32 v241, s45, v106
    v_mul_f32 v241, s44, v241
    v_exp_f32 v241, v241
    s_nop 0
    v_add_f32 v242, 2.0, v241
    v_mul_f32 v242, v242, v241
    v_add_f32 v243, 2.0, v242
    v_rcp_f32 v243, v243
    s_nop 0
    v_mul_f32 v242, v242, v243
    v_mul_f32 v106, v106, v242
    v_min_f32 v241, s45, v107
    v_mul_f32 v241, s44, v241
    v_exp_f32 v241, v241
    s_nop 0
    v_add_f32 v242, 2.0, v241
    v_mul_f32 v242, v242, v241
    v_add_f32 v243, 2.0, v242
    v_rcp_f32 v243, v243
    s_nop 0
    v_mul_f32 v242, v242, v243
    v_mul_f32 v107, v107, v242
    v_min_f32 v241, s45, v108
    v_mul_f32 v241, s44, v241
    v_exp_f32 v241, v241
    s_nop 0
    v_add_f32 v242, 2.0, v241
    v_mul_f32 v242, v242, v241
    v_add_f32 v243, 2.0, v242
    v_rcp_f32 v243, v243
    s_nop 0
    v_mul_f32 v242, v242, v243
    v_mul_f32 v108, v108, v242
    v_min_f32 v241, s45, v109
    v_mul_f32 v241, s44, v241
    v_exp_f32 v241, v241
    s_nop 0
    v_add_f32 v242, 2.0, v241
    v_mul_f32 v242, v242, v241
    v_add_f32 v243, 2.0, v242
    v_rcp_f32 v243, v243
    s_nop 0
    v_mul_f32 v242, v242, v243
    v_mul_f32 v109, v109, v242
    v_min_f32 v241, s45, v110
    v_mul_f32 v241, s44, v241
    v_exp_f32 v241, v241
    s_nop 0
    v_add_f32 v242, 2.0, v241
    v_mul_f32 v242, v242, v241
    v_add_f32 v243, 2.0, v242
    v_rcp_f32 v243, v243
    s_nop 0
    v_mul_f32 v242, v242, v243
    v_mul_f32 v110, v110, v242
    v_min_f32 v241, s45, v111
    v_mul_f32 v241, s44, v241
    v_exp_f32 v241, v241
    s_nop 0
    v_add_f32 v242, 2.0, v241
    v_mul_f32 v242, v242, v241
    v_add_f32 v243, 2.0, v242
    v_rcp_f32 v243, v243
    s_nop 0
    v_mul_f32 v242, v242, v243
    v_mul_f32 v111, v111, v242
    v_cvt_pk_bf16_f32 v16, v96, v97
    v_cvt_pk_bf16_f32 v17, v98, v99
    ds_write_b64 v3, v[16:17] offset:16896
    v_cvt_pk_bf16_f32 v18, v100, v101
    v_cvt_pk_bf16_f32 v19, v102, v103
    ds_write_b64 v3, v[18:19] offset:16912
    v_cvt_pk_bf16_f32 v16, v104, v105
    v_cvt_pk_bf16_f32 v17, v106, v107
    ds_write_b64 v3, v[16:17] offset:16928
    v_cvt_pk_bf16_f32 v18, v108, v109
    v_cvt_pk_bf16_f32 v19, v110, v111
    ds_write_b64 v3, v[18:19] offset:16944
    v_cvt_pk_bf16_f32 v240, v112, v113
    v_lshlrev_b32 v112, 16, v240
    v_and_b32 v113, s31, v240
    v_cvt_pk_bf16_f32 v240, v114, v115
    v_lshlrev_b32 v114, 16, v240
    v_and_b32 v115, s31, v240
    v_cvt_pk_bf16_f32 v240, v116, v117
    v_lshlrev_b32 v116, 16, v240
    v_and_b32 v117, s31, v240
    v_cvt_pk_bf16_f32 v240, v118, v119
    v_lshlrev_b32 v118, 16, v240
    v_and_b32 v119, s31, v240
    v_cvt_pk_bf16_f32 v240, v120, v121
    v_lshlrev_b32 v120, 16, v240
    v_and_b32 v121, s31, v240
    v_cvt_pk_bf16_f32 v240, v122, v123
    v_lshlrev_b32 v122, 16, v240
    v_and_b32 v123, s31, v240
    v_cvt_pk_bf16_f32 v240, v124, v125
    v_lshlrev_b32 v124, 16, v240
    v_and_b32 v125, s31, v240
    v_cvt_pk_bf16_f32 v240, v126, v127
    v_lshlrev_b32 v126, 16, v240
    v_and_b32 v127, s31, v240
    v_add_f32 v112, v112, v208
    v_add_f32 v113, v113, v209
    v_add_f32 v114, v114, v210
    v_add_f32 v115, v115, v211
    v_add_f32 v116, v116, v212
    v_add_f32 v117, v117, v213
    v_add_f32 v118, v118, v214
    v_add_f32 v119, v119, v215
    v_add_f32 v120, v120, v216
    v_add_f32 v121, v121, v217
    v_add_f32 v122, v122, v218
    v_add_f32 v123, v123, v219
    v_add_f32 v124, v124, v220
    v_add_f32 v125, v125, v221
    v_add_f32 v126, v126, v222
    v_add_f32 v127, v127, v223
    v_cvt_pk_bf16_f32 v240, v112, v113
    v_lshlrev_b32 v112, 16, v240
    v_and_b32 v113, s31, v240
    v_cvt_pk_bf16_f32 v240, v114, v115
    v_lshlrev_b32 v114, 16, v240
    v_and_b32 v115, s31, v240
    v_cvt_pk_bf16_f32 v240, v116, v117
    v_lshlrev_b32 v116, 16, v240
    v_and_b32 v117, s31, v240
    v_cvt_pk_bf16_f32 v240, v118, v119
    v_lshlrev_b32 v118, 16, v240
    v_and_b32 v119, s31, v240
    v_cvt_pk_bf16_f32 v240, v120, v121
    v_lshlrev_b32 v120, 16, v240
    v_and_b32 v121, s31, v240
    v_cvt_pk_bf16_f32 v240, v122, v123
    v_lshlrev_b32 v122, 16, v240
    v_and_b32 v123, s31, v240
    v_cvt_pk_bf16_f32 v240, v124, v125
    v_lshlrev_b32 v124, 16, v240
    v_and_b32 v125, s31, v240
    v_cvt_pk_bf16_f32 v240, v126, v127
    v_lshlrev_b32 v126, 16, v240
    v_and_b32 v127, s31, v240
    v_min_f32 v241, s45, v112
    v_mul_f32 v241, s44, v241
    v_exp_f32 v241, v241
    s_nop 0
    v_add_f32 v242, 2.0, v241
    v_mul_f32 v242, v242, v241
    v_add_f32 v243, 2.0, v242
    v_rcp_f32 v243, v243
    s_nop 0
    v_mul_f32 v242, v242, v243
    v_mul_f32 v112, v112, v242
    v_min_f32 v241, s45, v113
    v_mul_f32 v241, s44, v241
    v_exp_f32 v241, v241
    s_nop 0
    v_add_f32 v242, 2.0, v241
    v_mul_f32 v242, v242, v241
    v_add_f32 v243, 2.0, v242
    v_rcp_f32 v243, v243
    s_nop 0
    v_mul_f32 v242, v242, v243
    v_mul_f32 v113, v113, v242
    v_min_f32 v241, s45, v114
    v_mul_f32 v241, s44, v241
    v_exp_f32 v241, v241
    s_nop 0
    v_add_f32 v242, 2.0, v241
    v_mul_f32 v242, v242, v241
    v_add_f32 v243, 2.0, v242
    v_rcp_f32 v243, v243
    s_nop 0
    v_mul_f32 v242, v242, v243
    v_mul_f32 v114, v114, v242
    v_min_f32 v241, s45, v115
    v_mul_f32 v241, s44, v241
    v_exp_f32 v241, v241
    s_nop 0
    v_add_f32 v242, 2.0, v241
    v_mul_f32 v242, v242, v241
    v_add_f32 v243, 2.0, v242
    v_rcp_f32 v243, v243
    s_nop 0
    v_mul_f32 v242, v242, v243
    v_mul_f32 v115, v115, v242
    v_min_f32 v241, s45, v116
    v_mul_f32 v241, s44, v241
    v_exp_f32 v241, v241
    s_nop 0
    v_add_f32 v242, 2.0, v241
    v_mul_f32 v242, v242, v241
    v_add_f32 v243, 2.0, v242
    v_rcp_f32 v243, v243
    s_nop 0
    v_mul_f32 v242, v242, v243
    v_mul_f32 v116, v116, v242
    v_min_f32 v241, s45, v117
    v_mul_f32 v241, s44, v241
    v_exp_f32 v241, v241
    s_nop 0
    v_add_f32 v242, 2.0, v241
    v_mul_f32 v242, v242, v241
    v_add_f32 v243, 2.0, v242
    v_rcp_f32 v243, v243
    s_nop 0
    v_mul_f32 v242, v242, v243
    v_mul_f32 v117, v117, v242
    v_min_f32 v241, s45, v118
    v_mul_f32 v241, s44, v241
    v_exp_f32 v241, v241
    s_nop 0
    v_add_f32 v242, 2.0, v241
    v_mul_f32 v242, v242, v241
    v_add_f32 v243, 2.0, v242
    v_rcp_f32 v243, v243
    s_nop 0
    v_mul_f32 v242, v242, v243
    v_mul_f32 v118, v118, v242
    v_min_f32 v241, s45, v119
    v_mul_f32 v241, s44, v241
    v_exp_f32 v241, v241
    s_nop 0
    v_add_f32 v242, 2.0, v241
    v_mul_f32 v242, v242, v241
    v_add_f32 v243, 2.0, v242
    v_rcp_f32 v243, v243
    s_nop 0
    v_mul_f32 v242, v242, v243
    v_mul_f32 v119, v119, v242
    v_min_f32 v241, s45, v120
    v_mul_f32 v241, s44, v241
    v_exp_f32 v241, v241
    s_nop 0
    v_add_f32 v242, 2.0, v241
    v_mul_f32 v242, v242, v241
    v_add_f32 v243, 2.0, v242
    v_rcp_f32 v243, v243
    s_nop 0
    v_mul_f32 v242, v242, v243
    v_mul_f32 v120, v120, v242
    v_min_f32 v241, s45, v121
    v_mul_f32 v241, s44, v241
    v_exp_f32 v241, v241
    s_nop 0
    v_add_f32 v242, 2.0, v241
    v_mul_f32 v242, v242, v241
    v_add_f32 v243, 2.0, v242
    v_rcp_f32 v243, v243
    s_nop 0
    v_mul_f32 v242, v242, v243
    v_mul_f32 v121, v121, v242
    v_min_f32 v241, s45, v122
    v_mul_f32 v241, s44, v241
    v_exp_f32 v241, v241
    s_nop 0
    v_add_f32 v242, 2.0, v241
    v_mul_f32 v242, v242, v241
    v_add_f32 v243, 2.0, v242
    v_rcp_f32 v243, v243
    s_nop 0
    v_mul_f32 v242, v242, v243
    v_mul_f32 v122, v122, v242
    v_min_f32 v241, s45, v123
    v_mul_f32 v241, s44, v241
    v_exp_f32 v241, v241
    s_nop 0
    v_add_f32 v242, 2.0, v241
    v_mul_f32 v242, v242, v241
    v_add_f32 v243, 2.0, v242
    v_rcp_f32 v243, v243
    s_nop 0
    v_mul_f32 v242, v242, v243
    v_mul_f32 v123, v123, v242
    v_min_f32 v241, s45, v124
    v_mul_f32 v241, s44, v241
    v_exp_f32 v241, v241
    s_nop 0
    v_add_f32 v242, 2.0, v241
    v_mul_f32 v242, v242, v241
    v_add_f32 v243, 2.0, v242
    v_rcp_f32 v243, v243
    s_nop 0
    v_mul_f32 v242, v242, v243
    v_mul_f32 v124, v124, v242
    v_min_f32 v241, s45, v125
    v_mul_f32 v241, s44, v241
    v_exp_f32 v241, v241
    s_nop 0
    v_add_f32 v242, 2.0, v241
    v_mul_f32 v242, v242, v241
    v_add_f32 v243, 2.0, v242
    v_rcp_f32 v243, v243
    s_nop 0
    v_mul_f32 v242, v242, v243
    v_mul_f32 v125, v125, v242
    v_min_f32 v241, s45, v126
    v_mul_f32 v241, s44, v241
    v_exp_f32 v241, v241
    s_nop 0
    v_add_f32 v242, 2.0, v241
    v_mul_f32 v242, v242, v241
    v_add_f32 v243, 2.0, v242
    v_rcp_f32 v243, v243
    s_nop 0
    v_mul_f32 v242, v242, v243
    v_mul_f32 v126, v126, v242
    v_min_f32 v241, s45, v127
    v_mul_f32 v241, s44, v241
    v_exp_f32 v241, v241
    s_nop 0
    v_add_f32 v242, 2.0, v241
    v_mul_f32 v242, v242, v241
    v_add_f32 v243, 2.0, v242
    v_rcp_f32 v243, v243
    s_nop 0
    v_mul_f32 v242, v242, v243
    v_mul_f32 v127, v127, v242
    v_cvt_pk_bf16_f32 v16, v112, v113
    v_cvt_pk_bf16_f32 v17, v114, v115
    ds_write_b64 v3, v[16:17] offset:16960
    v_cvt_pk_bf16_f32 v18, v116, v117
    v_cvt_pk_bf16_f32 v19, v118, v119
    ds_write_b64 v3, v[18:19] offset:16976
    v_cvt_pk_bf16_f32 v16, v120, v121
    v_cvt_pk_bf16_f32 v17, v122, v123
    ds_write_b64 v3, v[16:17] offset:16992
    v_cvt_pk_bf16_f32 v18, v124, v125
    v_cvt_pk_bf16_f32 v19, v126, v127
    ds_write_b64 v3, v[18:19] offset:17008
    v_cvt_pk_bf16_f32 v240, v128, v129
    v_lshlrev_b32 v128, 16, v240
    v_and_b32 v129, s31, v240
    v_cvt_pk_bf16_f32 v240, v130, v131
    v_lshlrev_b32 v130, 16, v240
    v_and_b32 v131, s31, v240
    v_cvt_pk_bf16_f32 v240, v132, v133
    v_lshlrev_b32 v132, 16, v240
    v_and_b32 v133, s31, v240
    v_cvt_pk_bf16_f32 v240, v134, v135
    v_lshlrev_b32 v134, 16, v240
    v_and_b32 v135, s31, v240
    v_cvt_pk_bf16_f32 v240, v136, v137
    v_lshlrev_b32 v136, 16, v240
    v_and_b32 v137, s31, v240
    v_cvt_pk_bf16_f32 v240, v138, v139
    v_lshlrev_b32 v138, 16, v240
    v_and_b32 v139, s31, v240
    v_cvt_pk_bf16_f32 v240, v140, v141
    v_lshlrev_b32 v140, 16, v240
    v_and_b32 v141, s31, v240
    v_cvt_pk_bf16_f32 v240, v142, v143
    v_lshlrev_b32 v142, 16, v240
    v_and_b32 v143, s31, v240
    v_add_f32 v128, v128, v192
    v_add_f32 v129, v129, v193
    v_add_f32 v130, v130, v194
    v_add_f32 v131, v131, v195
    v_add_f32 v132, v132, v196
    v_add_f32 v133, v133, v197
    v_add_f32 v134, v134, v198
    v_add_f32 v135, v135, v199
    v_add_f32 v136, v136, v200
    v_add_f32 v137, v137, v201
    v_add_f32 v138, v138, v202
    v_add_f32 v139, v139, v203
    v_add_f32 v140, v140, v204
    v_add_f32 v141, v141, v205
    v_add_f32 v142, v142, v206
    v_add_f32 v143, v143, v207
    v_cvt_pk_bf16_f32 v240, v128, v129
    v_lshlrev_b32 v128, 16, v240
    v_and_b32 v129, s31, v240
    v_cvt_pk_bf16_f32 v240, v130, v131
    v_lshlrev_b32 v130, 16, v240
    v_and_b32 v131, s31, v240
    v_cvt_pk_bf16_f32 v240, v132, v133
    v_lshlrev_b32 v132, 16, v240
    v_and_b32 v133, s31, v240
    v_cvt_pk_bf16_f32 v240, v134, v135
    v_lshlrev_b32 v134, 16, v240
    v_and_b32 v135, s31, v240
    v_cvt_pk_bf16_f32 v240, v136, v137
    v_lshlrev_b32 v136, 16, v240
    v_and_b32 v137, s31, v240
    v_cvt_pk_bf16_f32 v240, v138, v139
    v_lshlrev_b32 v138, 16, v240
    v_and_b32 v139, s31, v240
    v_cvt_pk_bf16_f32 v240, v140, v141
    v_lshlrev_b32 v140, 16, v240
    v_and_b32 v141, s31, v240
    v_cvt_pk_bf16_f32 v240, v142, v143
    v_lshlrev_b32 v142, 16, v240
    v_and_b32 v143, s31, v240
    v_min_f32 v241, s45, v128
    v_mul_f32 v241, s44, v241
    v_exp_f32 v241, v241
    s_nop 0
    v_add_f32 v242, 2.0, v241
    v_mul_f32 v242, v242, v241
    v_add_f32 v243, 2.0, v242
    v_rcp_f32 v243, v243
    s_nop 0
    v_mul_f32 v242, v242, v243
    v_mul_f32 v128, v128, v242
    v_min_f32 v241, s45, v129
    v_mul_f32 v241, s44, v241
    v_exp_f32 v241, v241
    s_nop 0
    v_add_f32 v242, 2.0, v241
    v_mul_f32 v242, v242, v241
    v_add_f32 v243, 2.0, v242
    v_rcp_f32 v243, v243
    s_nop 0
    v_mul_f32 v242, v242, v243
    v_mul_f32 v129, v129, v242
    v_min_f32 v241, s45, v130
    v_mul_f32 v241, s44, v241
    v_exp_f32 v241, v241
    s_nop 0
    v_add_f32 v242, 2.0, v241
    v_mul_f32 v242, v242, v241
    v_add_f32 v243, 2.0, v242
    v_rcp_f32 v243, v243
    s_nop 0
    v_mul_f32 v242, v242, v243
    v_mul_f32 v130, v130, v242
    v_min_f32 v241, s45, v131
    v_mul_f32 v241, s44, v241
    v_exp_f32 v241, v241
    s_nop 0
    v_add_f32 v242, 2.0, v241
    v_mul_f32 v242, v242, v241
    v_add_f32 v243, 2.0, v242
    v_rcp_f32 v243, v243
    s_nop 0
    v_mul_f32 v242, v242, v243
    v_mul_f32 v131, v131, v242
    v_min_f32 v241, s45, v132
    v_mul_f32 v241, s44, v241
    v_exp_f32 v241, v241
    s_nop 0
    v_add_f32 v242, 2.0, v241
    v_mul_f32 v242, v242, v241
    v_add_f32 v243, 2.0, v242
    v_rcp_f32 v243, v243
    s_nop 0
    v_mul_f32 v242, v242, v243
    v_mul_f32 v132, v132, v242
    v_min_f32 v241, s45, v133
    v_mul_f32 v241, s44, v241
    v_exp_f32 v241, v241
    s_nop 0
    v_add_f32 v242, 2.0, v241
    v_mul_f32 v242, v242, v241
    v_add_f32 v243, 2.0, v242
    v_rcp_f32 v243, v243
    s_nop 0
    v_mul_f32 v242, v242, v243
    v_mul_f32 v133, v133, v242
    v_min_f32 v241, s45, v134
    v_mul_f32 v241, s44, v241
    v_exp_f32 v241, v241
    s_nop 0
    v_add_f32 v242, 2.0, v241
    v_mul_f32 v242, v242, v241
    v_add_f32 v243, 2.0, v242
    v_rcp_f32 v243, v243
    s_nop 0
    v_mul_f32 v242, v242, v243
    v_mul_f32 v134, v134, v242
    v_min_f32 v241, s45, v135
    v_mul_f32 v241, s44, v241
    v_exp_f32 v241, v241
    s_nop 0
    v_add_f32 v242, 2.0, v241
    v_mul_f32 v242, v242, v241
    v_add_f32 v243, 2.0, v242
    v_rcp_f32 v243, v243
    s_nop 0
    v_mul_f32 v242, v242, v243
    v_mul_f32 v135, v135, v242
    v_min_f32 v241, s45, v136
    v_mul_f32 v241, s44, v241
    v_exp_f32 v241, v241
    s_nop 0
    v_add_f32 v242, 2.0, v241
    v_mul_f32 v242, v242, v241
    v_add_f32 v243, 2.0, v242
    v_rcp_f32 v243, v243
    s_nop 0
    v_mul_f32 v242, v242, v243
    v_mul_f32 v136, v136, v242
    v_min_f32 v241, s45, v137
    v_mul_f32 v241, s44, v241
    v_exp_f32 v241, v241
    s_nop 0
    v_add_f32 v242, 2.0, v241
    v_mul_f32 v242, v242, v241
    v_add_f32 v243, 2.0, v242
    v_rcp_f32 v243, v243
    s_nop 0
    v_mul_f32 v242, v242, v243
    v_mul_f32 v137, v137, v242
    v_min_f32 v241, s45, v138
    v_mul_f32 v241, s44, v241
    v_exp_f32 v241, v241
    s_nop 0
    v_add_f32 v242, 2.0, v241
    v_mul_f32 v242, v242, v241
    v_add_f32 v243, 2.0, v242
    v_rcp_f32 v243, v243
    s_nop 0
    v_mul_f32 v242, v242, v243
    v_mul_f32 v138, v138, v242
    v_min_f32 v241, s45, v139
    v_mul_f32 v241, s44, v241
    v_exp_f32 v241, v241
    s_nop 0
    v_add_f32 v242, 2.0, v241
    v_mul_f32 v242, v242, v241
    v_add_f32 v243, 2.0, v242
    v_rcp_f32 v243, v243
    s_nop 0
    v_mul_f32 v242, v242, v243
    v_mul_f32 v139, v139, v242
    v_min_f32 v241, s45, v140
    v_mul_f32 v241, s44, v241
    v_exp_f32 v241, v241
    s_nop 0
    v_add_f32 v242, 2.0, v241
    v_mul_f32 v242, v242, v241
    v_add_f32 v243, 2.0, v242
    v_rcp_f32 v243, v243
    s_nop 0
    v_mul_f32 v242, v242, v243
    v_mul_f32 v140, v140, v242
    v_min_f32 v241, s45, v141
    v_mul_f32 v241, s44, v241
    v_exp_f32 v241, v241
    s_nop 0
    v_add_f32 v242, 2.0, v241
    v_mul_f32 v242, v242, v241
    v_add_f32 v243, 2.0, v242
    v_rcp_f32 v243, v243
    s_nop 0
    v_mul_f32 v242, v242, v243
    v_mul_f32 v141, v141, v242
    v_min_f32 v241, s45, v142
    v_mul_f32 v241, s44, v241
    v_exp_f32 v241, v241
    s_nop 0
    v_add_f32 v242, 2.0, v241
    v_mul_f32 v242, v242, v241
    v_add_f32 v243, 2.0, v242
    v_rcp_f32 v243, v243
    s_nop 0
    v_mul_f32 v242, v242, v243
    v_mul_f32 v142, v142, v242
    v_min_f32 v241, s45, v143
    v_mul_f32 v241, s44, v241
    v_exp_f32 v241, v241
    s_nop 0
    v_add_f32 v242, 2.0, v241
    v_mul_f32 v242, v242, v241
    v_add_f32 v243, 2.0, v242
    v_rcp_f32 v243, v243
    s_nop 0
    v_mul_f32 v242, v242, v243
    v_mul_f32 v143, v143, v242
    v_cvt_pk_bf16_f32 v16, v128, v129
    v_cvt_pk_bf16_f32 v17, v130, v131
    ds_write_b64 v3, v[16:17] offset:33792
    v_cvt_pk_bf16_f32 v18, v132, v133
    v_cvt_pk_bf16_f32 v19, v134, v135
    ds_write_b64 v3, v[18:19] offset:33808
    v_cvt_pk_bf16_f32 v16, v136, v137
    v_cvt_pk_bf16_f32 v17, v138, v139
    ds_write_b64 v3, v[16:17] offset:33824
    v_cvt_pk_bf16_f32 v18, v140, v141
    v_cvt_pk_bf16_f32 v19, v142, v143
    ds_write_b64 v3, v[18:19] offset:33840
    v_cvt_pk_bf16_f32 v240, v144, v145
    v_lshlrev_b32 v144, 16, v240
    v_and_b32 v145, s31, v240
    v_cvt_pk_bf16_f32 v240, v146, v147
    v_lshlrev_b32 v146, 16, v240
    v_and_b32 v147, s31, v240
    v_cvt_pk_bf16_f32 v240, v148, v149
    v_lshlrev_b32 v148, 16, v240
    v_and_b32 v149, s31, v240
    v_cvt_pk_bf16_f32 v240, v150, v151
    v_lshlrev_b32 v150, 16, v240
    v_and_b32 v151, s31, v240
    v_cvt_pk_bf16_f32 v240, v152, v153
    v_lshlrev_b32 v152, 16, v240
    v_and_b32 v153, s31, v240
    v_cvt_pk_bf16_f32 v240, v154, v155
    v_lshlrev_b32 v154, 16, v240
    v_and_b32 v155, s31, v240
    v_cvt_pk_bf16_f32 v240, v156, v157
    v_lshlrev_b32 v156, 16, v240
    v_and_b32 v157, s31, v240
    v_cvt_pk_bf16_f32 v240, v158, v159
    v_lshlrev_b32 v158, 16, v240
    v_and_b32 v159, s31, v240
    v_add_f32 v144, v144, v208
    v_add_f32 v145, v145, v209
    v_add_f32 v146, v146, v210
    v_add_f32 v147, v147, v211
    v_add_f32 v148, v148, v212
    v_add_f32 v149, v149, v213
    v_add_f32 v150, v150, v214
    v_add_f32 v151, v151, v215
    v_add_f32 v152, v152, v216
    v_add_f32 v153, v153, v217
    v_add_f32 v154, v154, v218
    v_add_f32 v155, v155, v219
    v_add_f32 v156, v156, v220
    v_add_f32 v157, v157, v221
    v_add_f32 v158, v158, v222
    v_add_f32 v159, v159, v223
    v_cvt_pk_bf16_f32 v240, v144, v145
    v_lshlrev_b32 v144, 16, v240
    v_and_b32 v145, s31, v240
    v_cvt_pk_bf16_f32 v240, v146, v147
    v_lshlrev_b32 v146, 16, v240
    v_and_b32 v147, s31, v240
    v_cvt_pk_bf16_f32 v240, v148, v149
    v_lshlrev_b32 v148, 16, v240
    v_and_b32 v149, s31, v240
    v_cvt_pk_bf16_f32 v240, v150, v151
    v_lshlrev_b32 v150, 16, v240
    v_and_b32 v151, s31, v240
    v_cvt_pk_bf16_f32 v240, v152, v153
    v_lshlrev_b32 v152, 16, v240
    v_and_b32 v153, s31, v240
    v_cvt_pk_bf16_f32 v240, v154, v155
    v_lshlrev_b32 v154, 16, v240
    v_and_b32 v155, s31, v240
    v_cvt_pk_bf16_f32 v240, v156, v157
    v_lshlrev_b32 v156, 16, v240
    v_and_b32 v157, s31, v240
    v_cvt_pk_bf16_f32 v240, v158, v159
    v_lshlrev_b32 v158, 16, v240
    v_and_b32 v159, s31, v240
    v_min_f32 v241, s45, v144
    v_mul_f32 v241, s44, v241
    v_exp_f32 v241, v241
    s_nop 0
    v_add_f32 v242, 2.0, v241
    v_mul_f32 v242, v242, v241
    v_add_f32 v243, 2.0, v242
    v_rcp_f32 v243, v243
    s_nop 0
    v_mul_f32 v242, v242, v243
    v_mul_f32 v144, v144, v242
    v_min_f32 v241, s45, v145
    v_mul_f32 v241, s44, v241
    v_exp_f32 v241, v241
    s_nop 0
    v_add_f32 v242, 2.0, v241
    v_mul_f32 v242, v242, v241
    v_add_f32 v243, 2.0, v242
    v_rcp_f32 v243, v243
    s_nop 0
    v_mul_f32 v242, v242, v243
    v_mul_f32 v145, v145, v242
    v_min_f32 v241, s45, v146
    v_mul_f32 v241, s44, v241
    v_exp_f32 v241, v241
    s_nop 0
    v_add_f32 v242, 2.0, v241
    v_mul_f32 v242, v242, v241
    v_add_f32 v243, 2.0, v242
    v_rcp_f32 v243, v243
    s_nop 0
    v_mul_f32 v242, v242, v243
    v_mul_f32 v146, v146, v242
    v_min_f32 v241, s45, v147
    v_mul_f32 v241, s44, v241
    v_exp_f32 v241, v241
    s_nop 0
    v_add_f32 v242, 2.0, v241
    v_mul_f32 v242, v242, v241
    v_add_f32 v243, 2.0, v242
    v_rcp_f32 v243, v243
    s_nop 0
    v_mul_f32 v242, v242, v243
    v_mul_f32 v147, v147, v242
    v_min_f32 v241, s45, v148
    v_mul_f32 v241, s44, v241
    v_exp_f32 v241, v241
    s_nop 0
    v_add_f32 v242, 2.0, v241
    v_mul_f32 v242, v242, v241
    v_add_f32 v243, 2.0, v242
    v_rcp_f32 v243, v243
    s_nop 0
    v_mul_f32 v242, v242, v243
    v_mul_f32 v148, v148, v242
    v_min_f32 v241, s45, v149
    v_mul_f32 v241, s44, v241
    v_exp_f32 v241, v241
    s_nop 0
    v_add_f32 v242, 2.0, v241
    v_mul_f32 v242, v242, v241
    v_add_f32 v243, 2.0, v242
    v_rcp_f32 v243, v243
    s_nop 0
    v_mul_f32 v242, v242, v243
    v_mul_f32 v149, v149, v242
    v_min_f32 v241, s45, v150
    v_mul_f32 v241, s44, v241
    v_exp_f32 v241, v241
    s_nop 0
    v_add_f32 v242, 2.0, v241
    v_mul_f32 v242, v242, v241
    v_add_f32 v243, 2.0, v242
    v_rcp_f32 v243, v243
    s_nop 0
    v_mul_f32 v242, v242, v243
    v_mul_f32 v150, v150, v242
    v_min_f32 v241, s45, v151
    v_mul_f32 v241, s44, v241
    v_exp_f32 v241, v241
    s_nop 0
    v_add_f32 v242, 2.0, v241
    v_mul_f32 v242, v242, v241
    v_add_f32 v243, 2.0, v242
    v_rcp_f32 v243, v243
    s_nop 0
    v_mul_f32 v242, v242, v243
    v_mul_f32 v151, v151, v242
    v_min_f32 v241, s45, v152
    v_mul_f32 v241, s44, v241
    v_exp_f32 v241, v241
    s_nop 0
    v_add_f32 v242, 2.0, v241
    v_mul_f32 v242, v242, v241
    v_add_f32 v243, 2.0, v242
    v_rcp_f32 v243, v243
    s_nop 0
    v_mul_f32 v242, v242, v243
    v_mul_f32 v152, v152, v242
    v_min_f32 v241, s45, v153
    v_mul_f32 v241, s44, v241
    v_exp_f32 v241, v241
    s_nop 0
    v_add_f32 v242, 2.0, v241
    v_mul_f32 v242, v242, v241
    v_add_f32 v243, 2.0, v242
    v_rcp_f32 v243, v243
    s_nop 0
    v_mul_f32 v242, v242, v243
    v_mul_f32 v153, v153, v242
    v_min_f32 v241, s45, v154
    v_mul_f32 v241, s44, v241
    v_exp_f32 v241, v241
    s_nop 0
    v_add_f32 v242, 2.0, v241
    v_mul_f32 v242, v242, v241
    v_add_f32 v243, 2.0, v242
    v_rcp_f32 v243, v243
    s_nop 0
    v_mul_f32 v242, v242, v243
    v_mul_f32 v154, v154, v242
    v_min_f32 v241, s45, v155
    v_mul_f32 v241, s44, v241
    v_exp_f32 v241, v241
    s_nop 0
    v_add_f32 v242, 2.0, v241
    v_mul_f32 v242, v242, v241
    v_add_f32 v243, 2.0, v242
    v_rcp_f32 v243, v243
    s_nop 0
    v_mul_f32 v242, v242, v243
    v_mul_f32 v155, v155, v242
    v_min_f32 v241, s45, v156
    v_mul_f32 v241, s44, v241
    v_exp_f32 v241, v241
    s_nop 0
    v_add_f32 v242, 2.0, v241
    v_mul_f32 v242, v242, v241
    v_add_f32 v243, 2.0, v242
    v_rcp_f32 v243, v243
    s_nop 0
    v_mul_f32 v242, v242, v243
    v_mul_f32 v156, v156, v242
    v_min_f32 v241, s45, v157
    v_mul_f32 v241, s44, v241
    v_exp_f32 v241, v241
    s_nop 0
    v_add_f32 v242, 2.0, v241
    v_mul_f32 v242, v242, v241
    v_add_f32 v243, 2.0, v242
    v_rcp_f32 v243, v243
    s_nop 0
    v_mul_f32 v242, v242, v243
    v_mul_f32 v157, v157, v242
    v_min_f32 v241, s45, v158
    v_mul_f32 v241, s44, v241
    v_exp_f32 v241, v241
    s_nop 0
    v_add_f32 v242, 2.0, v241
    v_mul_f32 v242, v242, v241
    v_add_f32 v243, 2.0, v242
    v_rcp_f32 v243, v243
    s_nop 0
    v_mul_f32 v242, v242, v243
    v_mul_f32 v158, v158, v242
    v_min_f32 v241, s45, v159
    v_mul_f32 v241, s44, v241
    v_exp_f32 v241, v241
    s_nop 0
    v_add_f32 v242, 2.0, v241
    v_mul_f32 v242, v242, v241
    v_add_f32 v243, 2.0, v242
    v_rcp_f32 v243, v243
    s_nop 0
    v_mul_f32 v242, v242, v243
    v_mul_f32 v159, v159, v242
    v_cvt_pk_bf16_f32 v16, v144, v145
    v_cvt_pk_bf16_f32 v17, v146, v147
    ds_write_b64 v3, v[16:17] offset:33856
    v_cvt_pk_bf16_f32 v18, v148, v149
    v_cvt_pk_bf16_f32 v19, v150, v151
    ds_write_b64 v3, v[18:19] offset:33872
    v_cvt_pk_bf16_f32 v16, v152, v153
    v_cvt_pk_bf16_f32 v17, v154, v155
    ds_write_b64 v3, v[16:17] offset:33888
    v_cvt_pk_bf16_f32 v18, v156, v157
    v_cvt_pk_bf16_f32 v19, v158, v159
    ds_write_b64 v3, v[18:19] offset:33904
    v_cvt_pk_bf16_f32 v240, v160, v161
    v_lshlrev_b32 v160, 16, v240
    v_and_b32 v161, s31, v240
    v_cvt_pk_bf16_f32 v240, v162, v163
    v_lshlrev_b32 v162, 16, v240
    v_and_b32 v163, s31, v240
    v_cvt_pk_bf16_f32 v240, v164, v165
    v_lshlrev_b32 v164, 16, v240
    v_and_b32 v165, s31, v240
    v_cvt_pk_bf16_f32 v240, v166, v167
    v_lshlrev_b32 v166, 16, v240
    v_and_b32 v167, s31, v240
    v_cvt_pk_bf16_f32 v240, v168, v169
    v_lshlrev_b32 v168, 16, v240
    v_and_b32 v169, s31, v240
    v_cvt_pk_bf16_f32 v240, v170, v171
    v_lshlrev_b32 v170, 16, v240
    v_and_b32 v171, s31, v240
    v_cvt_pk_bf16_f32 v240, v172, v173
    v_lshlrev_b32 v172, 16, v240
    v_and_b32 v173, s31, v240
    v_cvt_pk_bf16_f32 v240, v174, v175
    v_lshlrev_b32 v174, 16, v240
    v_and_b32 v175, s31, v240
    v_add_f32 v160, v160, v192
    v_add_f32 v161, v161, v193
    v_add_f32 v162, v162, v194
    v_add_f32 v163, v163, v195
    v_add_f32 v164, v164, v196
    v_add_f32 v165, v165, v197
    v_add_f32 v166, v166, v198
    v_add_f32 v167, v167, v199
    v_add_f32 v168, v168, v200
    v_add_f32 v169, v169, v201
    v_add_f32 v170, v170, v202
    v_add_f32 v171, v171, v203
    v_add_f32 v172, v172, v204
    v_add_f32 v173, v173, v205
    v_add_f32 v174, v174, v206
    v_add_f32 v175, v175, v207
    v_cvt_pk_bf16_f32 v240, v160, v161
    v_lshlrev_b32 v160, 16, v240
    v_and_b32 v161, s31, v240
    v_cvt_pk_bf16_f32 v240, v162, v163
    v_lshlrev_b32 v162, 16, v240
    v_and_b32 v163, s31, v240
    v_cvt_pk_bf16_f32 v240, v164, v165
    v_lshlrev_b32 v164, 16, v240
    v_and_b32 v165, s31, v240
    v_cvt_pk_bf16_f32 v240, v166, v167
    v_lshlrev_b32 v166, 16, v240
    v_and_b32 v167, s31, v240
    v_cvt_pk_bf16_f32 v240, v168, v169
    v_lshlrev_b32 v168, 16, v240
    v_and_b32 v169, s31, v240
    v_cvt_pk_bf16_f32 v240, v170, v171
    v_lshlrev_b32 v170, 16, v240
    v_and_b32 v171, s31, v240
    v_cvt_pk_bf16_f32 v240, v172, v173
    v_lshlrev_b32 v172, 16, v240
    v_and_b32 v173, s31, v240
    v_cvt_pk_bf16_f32 v240, v174, v175
    v_lshlrev_b32 v174, 16, v240
    v_and_b32 v175, s31, v240
    v_min_f32 v241, s45, v160
    v_mul_f32 v241, s44, v241
    v_exp_f32 v241, v241
    s_nop 0
    v_add_f32 v242, 2.0, v241
    v_mul_f32 v242, v242, v241
    v_add_f32 v243, 2.0, v242
    v_rcp_f32 v243, v243
    s_nop 0
    v_mul_f32 v242, v242, v243
    v_mul_f32 v160, v160, v242
    v_min_f32 v241, s45, v161
    v_mul_f32 v241, s44, v241
    v_exp_f32 v241, v241
    s_nop 0
    v_add_f32 v242, 2.0, v241
    v_mul_f32 v242, v242, v241
    v_add_f32 v243, 2.0, v242
    v_rcp_f32 v243, v243
    s_nop 0
    v_mul_f32 v242, v242, v243
    v_mul_f32 v161, v161, v242
    v_min_f32 v241, s45, v162
    v_mul_f32 v241, s44, v241
    v_exp_f32 v241, v241
    s_nop 0
    v_add_f32 v242, 2.0, v241
    v_mul_f32 v242, v242, v241
    v_add_f32 v243, 2.0, v242
    v_rcp_f32 v243, v243
    s_nop 0
    v_mul_f32 v242, v242, v243
    v_mul_f32 v162, v162, v242
    v_min_f32 v241, s45, v163
    v_mul_f32 v241, s44, v241
    v_exp_f32 v241, v241
    s_nop 0
    v_add_f32 v242, 2.0, v241
    v_mul_f32 v242, v242, v241
    v_add_f32 v243, 2.0, v242
    v_rcp_f32 v243, v243
    s_nop 0
    v_mul_f32 v242, v242, v243
    v_mul_f32 v163, v163, v242
    v_min_f32 v241, s45, v164
    v_mul_f32 v241, s44, v241
    v_exp_f32 v241, v241
    s_nop 0
    v_add_f32 v242, 2.0, v241
    v_mul_f32 v242, v242, v241
    v_add_f32 v243, 2.0, v242
    v_rcp_f32 v243, v243
    s_nop 0
    v_mul_f32 v242, v242, v243
    v_mul_f32 v164, v164, v242
    v_min_f32 v241, s45, v165
    v_mul_f32 v241, s44, v241
    v_exp_f32 v241, v241
    s_nop 0
    v_add_f32 v242, 2.0, v241
    v_mul_f32 v242, v242, v241
    v_add_f32 v243, 2.0, v242
    v_rcp_f32 v243, v243
    s_nop 0
    v_mul_f32 v242, v242, v243
    v_mul_f32 v165, v165, v242
    v_min_f32 v241, s45, v166
    v_mul_f32 v241, s44, v241
    v_exp_f32 v241, v241
    s_nop 0
    v_add_f32 v242, 2.0, v241
    v_mul_f32 v242, v242, v241
    v_add_f32 v243, 2.0, v242
    v_rcp_f32 v243, v243
    s_nop 0
    v_mul_f32 v242, v242, v243
    v_mul_f32 v166, v166, v242
    v_min_f32 v241, s45, v167
    v_mul_f32 v241, s44, v241
    v_exp_f32 v241, v241
    s_nop 0
    v_add_f32 v242, 2.0, v241
    v_mul_f32 v242, v242, v241
    v_add_f32 v243, 2.0, v242
    v_rcp_f32 v243, v243
    s_nop 0
    v_mul_f32 v242, v242, v243
    v_mul_f32 v167, v167, v242
    v_min_f32 v241, s45, v168
    v_mul_f32 v241, s44, v241
    v_exp_f32 v241, v241
    s_nop 0
    v_add_f32 v242, 2.0, v241
    v_mul_f32 v242, v242, v241
    v_add_f32 v243, 2.0, v242
    v_rcp_f32 v243, v243
    s_nop 0
    v_mul_f32 v242, v242, v243
    v_mul_f32 v168, v168, v242
    v_min_f32 v241, s45, v169
    v_mul_f32 v241, s44, v241
    v_exp_f32 v241, v241
    s_nop 0
    v_add_f32 v242, 2.0, v241
    v_mul_f32 v242, v242, v241
    v_add_f32 v243, 2.0, v242
    v_rcp_f32 v243, v243
    s_nop 0
    v_mul_f32 v242, v242, v243
    v_mul_f32 v169, v169, v242
    v_min_f32 v241, s45, v170
    v_mul_f32 v241, s44, v241
    v_exp_f32 v241, v241
    s_nop 0
    v_add_f32 v242, 2.0, v241
    v_mul_f32 v242, v242, v241
    v_add_f32 v243, 2.0, v242
    v_rcp_f32 v243, v243
    s_nop 0
    v_mul_f32 v242, v242, v243
    v_mul_f32 v170, v170, v242
    v_min_f32 v241, s45, v171
    v_mul_f32 v241, s44, v241
    v_exp_f32 v241, v241
    s_nop 0
    v_add_f32 v242, 2.0, v241
    v_mul_f32 v242, v242, v241
    v_add_f32 v243, 2.0, v242
    v_rcp_f32 v243, v243
    s_nop 0
    v_mul_f32 v242, v242, v243
    v_mul_f32 v171, v171, v242
    v_min_f32 v241, s45, v172
    v_mul_f32 v241, s44, v241
    v_exp_f32 v241, v241
    s_nop 0
    v_add_f32 v242, 2.0, v241
    v_mul_f32 v242, v242, v241
    v_add_f32 v243, 2.0, v242
    v_rcp_f32 v243, v243
    s_nop 0
    v_mul_f32 v242, v242, v243
    v_mul_f32 v172, v172, v242
    v_min_f32 v241, s45, v173
    v_mul_f32 v241, s44, v241
    v_exp_f32 v241, v241
    s_nop 0
    v_add_f32 v242, 2.0, v241
    v_mul_f32 v242, v242, v241
    v_add_f32 v243, 2.0, v242
    v_rcp_f32 v243, v243
    s_nop 0
    v_mul_f32 v242, v242, v243
    v_mul_f32 v173, v173, v242
    v_min_f32 v241, s45, v174
    v_mul_f32 v241, s44, v241
    v_exp_f32 v241, v241
    s_nop 0
    v_add_f32 v242, 2.0, v241
    v_mul_f32 v242, v242, v241
    v_add_f32 v243, 2.0, v242
    v_rcp_f32 v243, v243
    s_nop 0
    v_mul_f32 v242, v242, v243
    v_mul_f32 v174, v174, v242
    v_min_f32 v241, s45, v175
    v_mul_f32 v241, s44, v241
    v_exp_f32 v241, v241
    s_nop 0
    v_add_f32 v242, 2.0, v241
    v_mul_f32 v242, v242, v241
    v_add_f32 v243, 2.0, v242
    v_rcp_f32 v243, v243
    s_nop 0
    v_mul_f32 v242, v242, v243
    v_mul_f32 v175, v175, v242
    v_cvt_pk_bf16_f32 v16, v160, v161
    v_cvt_pk_bf16_f32 v17, v162, v163
    ds_write_b64 v3, v[16:17] offset:50688
    v_cvt_pk_bf16_f32 v18, v164, v165
    v_cvt_pk_bf16_f32 v19, v166, v167
    ds_write_b64 v3, v[18:19] offset:50704
    v_cvt_pk_bf16_f32 v16, v168, v169
    v_cvt_pk_bf16_f32 v17, v170, v171
    ds_write_b64 v3, v[16:17] offset:50720
    v_cvt_pk_bf16_f32 v18, v172, v173
    v_cvt_pk_bf16_f32 v19, v174, v175
    ds_write_b64 v3, v[18:19] offset:50736
    v_cvt_pk_bf16_f32 v240, v176, v177
    v_lshlrev_b32 v176, 16, v240
    v_and_b32 v177, s31, v240
    v_cvt_pk_bf16_f32 v240, v178, v179
    v_lshlrev_b32 v178, 16, v240
    v_and_b32 v179, s31, v240
    v_cvt_pk_bf16_f32 v240, v180, v181
    v_lshlrev_b32 v180, 16, v240
    v_and_b32 v181, s31, v240
    v_cvt_pk_bf16_f32 v240, v182, v183
    v_lshlrev_b32 v182, 16, v240
    v_and_b32 v183, s31, v240
    v_cvt_pk_bf16_f32 v240, v184, v185
    v_lshlrev_b32 v184, 16, v240
    v_and_b32 v185, s31, v240
    v_cvt_pk_bf16_f32 v240, v186, v187
    v_lshlrev_b32 v186, 16, v240
    v_and_b32 v187, s31, v240
    v_cvt_pk_bf16_f32 v240, v188, v189
    v_lshlrev_b32 v188, 16, v240
    v_and_b32 v189, s31, v240
    v_cvt_pk_bf16_f32 v240, v190, v191
    v_lshlrev_b32 v190, 16, v240
    v_and_b32 v191, s31, v240
    v_add_f32 v176, v176, v208
    v_add_f32 v177, v177, v209
    v_add_f32 v178, v178, v210
    v_add_f32 v179, v179, v211
    v_add_f32 v180, v180, v212
    v_add_f32 v181, v181, v213
    v_add_f32 v182, v182, v214
    v_add_f32 v183, v183, v215
    v_add_f32 v184, v184, v216
    v_add_f32 v185, v185, v217
    v_add_f32 v186, v186, v218
    v_add_f32 v187, v187, v219
    v_add_f32 v188, v188, v220
    v_add_f32 v189, v189, v221
    v_add_f32 v190, v190, v222
    v_add_f32 v191, v191, v223
    v_cvt_pk_bf16_f32 v240, v176, v177
    v_lshlrev_b32 v176, 16, v240
    v_and_b32 v177, s31, v240
    v_cvt_pk_bf16_f32 v240, v178, v179
    v_lshlrev_b32 v178, 16, v240
    v_and_b32 v179, s31, v240
    v_cvt_pk_bf16_f32 v240, v180, v181
    v_lshlrev_b32 v180, 16, v240
    v_and_b32 v181, s31, v240
    v_cvt_pk_bf16_f32 v240, v182, v183
    v_lshlrev_b32 v182, 16, v240
    v_and_b32 v183, s31, v240
    v_cvt_pk_bf16_f32 v240, v184, v185
    v_lshlrev_b32 v184, 16, v240
    v_and_b32 v185, s31, v240
    v_cvt_pk_bf16_f32 v240, v186, v187
    v_lshlrev_b32 v186, 16, v240
    v_and_b32 v187, s31, v240
    v_cvt_pk_bf16_f32 v240, v188, v189
    v_lshlrev_b32 v188, 16, v240
    v_and_b32 v189, s31, v240
    v_cvt_pk_bf16_f32 v240, v190, v191
    v_lshlrev_b32 v190, 16, v240
    v_and_b32 v191, s31, v240
    v_min_f32 v241, s45, v176
    v_mul_f32 v241, s44, v241
    v_exp_f32 v241, v241
    s_nop 0
    v_add_f32 v242, 2.0, v241
    v_mul_f32 v242, v242, v241
    v_add_f32 v243, 2.0, v242
    v_rcp_f32 v243, v243
    s_nop 0
    v_mul_f32 v242, v242, v243
    v_mul_f32 v176, v176, v242
    v_min_f32 v241, s45, v177
    v_mul_f32 v241, s44, v241
    v_exp_f32 v241, v241
    s_nop 0
    v_add_f32 v242, 2.0, v241
    v_mul_f32 v242, v242, v241
    v_add_f32 v243, 2.0, v242
    v_rcp_f32 v243, v243
    s_nop 0
    v_mul_f32 v242, v242, v243
    v_mul_f32 v177, v177, v242
    v_min_f32 v241, s45, v178
    v_mul_f32 v241, s44, v241
    v_exp_f32 v241, v241
    s_nop 0
    v_add_f32 v242, 2.0, v241
    v_mul_f32 v242, v242, v241
    v_add_f32 v243, 2.0, v242
    v_rcp_f32 v243, v243
    s_nop 0
    v_mul_f32 v242, v242, v243
    v_mul_f32 v178, v178, v242
    v_min_f32 v241, s45, v179
    v_mul_f32 v241, s44, v241
    v_exp_f32 v241, v241
    s_nop 0
    v_add_f32 v242, 2.0, v241
    v_mul_f32 v242, v242, v241
    v_add_f32 v243, 2.0, v242
    v_rcp_f32 v243, v243
    s_nop 0
    v_mul_f32 v242, v242, v243
    v_mul_f32 v179, v179, v242
    v_min_f32 v241, s45, v180
    v_mul_f32 v241, s44, v241
    v_exp_f32 v241, v241
    s_nop 0
    v_add_f32 v242, 2.0, v241
    v_mul_f32 v242, v242, v241
    v_add_f32 v243, 2.0, v242
    v_rcp_f32 v243, v243
    s_nop 0
    v_mul_f32 v242, v242, v243
    v_mul_f32 v180, v180, v242
    v_min_f32 v241, s45, v181
    v_mul_f32 v241, s44, v241
    v_exp_f32 v241, v241
    s_nop 0
    v_add_f32 v242, 2.0, v241
    v_mul_f32 v242, v242, v241
    v_add_f32 v243, 2.0, v242
    v_rcp_f32 v243, v243
    s_nop 0
    v_mul_f32 v242, v242, v243
    v_mul_f32 v181, v181, v242
    v_min_f32 v241, s45, v182
    v_mul_f32 v241, s44, v241
    v_exp_f32 v241, v241
    s_nop 0
    v_add_f32 v242, 2.0, v241
    v_mul_f32 v242, v242, v241
    v_add_f32 v243, 2.0, v242
    v_rcp_f32 v243, v243
    s_nop 0
    v_mul_f32 v242, v242, v243
    v_mul_f32 v182, v182, v242
    v_min_f32 v241, s45, v183
    v_mul_f32 v241, s44, v241
    v_exp_f32 v241, v241
    s_nop 0
    v_add_f32 v242, 2.0, v241
    v_mul_f32 v242, v242, v241
    v_add_f32 v243, 2.0, v242
    v_rcp_f32 v243, v243
    s_nop 0
    v_mul_f32 v242, v242, v243
    v_mul_f32 v183, v183, v242
    v_min_f32 v241, s45, v184
    v_mul_f32 v241, s44, v241
    v_exp_f32 v241, v241
    s_nop 0
    v_add_f32 v242, 2.0, v241
    v_mul_f32 v242, v242, v241
    v_add_f32 v243, 2.0, v242
    v_rcp_f32 v243, v243
    s_nop 0
    v_mul_f32 v242, v242, v243
    v_mul_f32 v184, v184, v242
    v_min_f32 v241, s45, v185
    v_mul_f32 v241, s44, v241
    v_exp_f32 v241, v241
    s_nop 0
    v_add_f32 v242, 2.0, v241
    v_mul_f32 v242, v242, v241
    v_add_f32 v243, 2.0, v242
    v_rcp_f32 v243, v243
    s_nop 0
    v_mul_f32 v242, v242, v243
    v_mul_f32 v185, v185, v242
    v_min_f32 v241, s45, v186
    v_mul_f32 v241, s44, v241
    v_exp_f32 v241, v241
    s_nop 0
    v_add_f32 v242, 2.0, v241
    v_mul_f32 v242, v242, v241
    v_add_f32 v243, 2.0, v242
    v_rcp_f32 v243, v243
    s_nop 0
    v_mul_f32 v242, v242, v243
    v_mul_f32 v186, v186, v242
    v_min_f32 v241, s45, v187
    v_mul_f32 v241, s44, v241
    v_exp_f32 v241, v241
    s_nop 0
    v_add_f32 v242, 2.0, v241
    v_mul_f32 v242, v242, v241
    v_add_f32 v243, 2.0, v242
    v_rcp_f32 v243, v243
    s_nop 0
    v_mul_f32 v242, v242, v243
    v_mul_f32 v187, v187, v242
    v_min_f32 v241, s45, v188
    v_mul_f32 v241, s44, v241
    v_exp_f32 v241, v241
    s_nop 0
    v_add_f32 v242, 2.0, v241
    v_mul_f32 v242, v242, v241
    v_add_f32 v243, 2.0, v242
    v_rcp_f32 v243, v243
    s_nop 0
    v_mul_f32 v242, v242, v243
    v_mul_f32 v188, v188, v242
    v_min_f32 v241, s45, v189
    v_mul_f32 v241, s44, v241
    v_exp_f32 v241, v241
    s_nop 0
    v_add_f32 v242, 2.0, v241
    v_mul_f32 v242, v242, v241
    v_add_f32 v243, 2.0, v242
    v_rcp_f32 v243, v243
    s_nop 0
    v_mul_f32 v242, v242, v243
    v_mul_f32 v189, v189, v242
    v_min_f32 v241, s45, v190
    v_mul_f32 v241, s44, v241
    v_exp_f32 v241, v241
    s_nop 0
    v_add_f32 v242, 2.0, v241
    v_mul_f32 v242, v242, v241
    v_add_f32 v243, 2.0, v242
    v_rcp_f32 v243, v243
    s_nop 0
    v_mul_f32 v242, v242, v243
    v_mul_f32 v190, v190, v242
    v_min_f32 v241, s45, v191
    v_mul_f32 v241, s44, v241
    v_exp_f32 v241, v241
    s_nop 0
    v_add_f32 v242, 2.0, v241
    v_mul_f32 v242, v242, v241
    v_add_f32 v243, 2.0, v242
    v_rcp_f32 v243, v243
    s_nop 0
    v_mul_f32 v242, v242, v243
    v_mul_f32 v191, v191, v242
    v_cvt_pk_bf16_f32 v16, v176, v177
    v_cvt_pk_bf16_f32 v17, v178, v179
    ds_write_b64 v3, v[16:17] offset:50752
    v_cvt_pk_bf16_f32 v18, v180, v181
    v_cvt_pk_bf16_f32 v19, v182, v183
    ds_write_b64 v3, v[18:19] offset:50768
    v_cvt_pk_bf16_f32 v16, v184, v185
    v_cvt_pk_bf16_f32 v17, v186, v187
    ds_write_b64 v3, v[16:17] offset:50784
    v_cvt_pk_bf16_f32 v18, v188, v189
    v_cvt_pk_bf16_f32 v19, v190, v191
    ds_write_b64 v3, v[18:19] offset:50800
    s_waitcnt lgkmcnt(0)
    s_barrier
    v_lshrrev_b32 v3, 5, v2
    s_lshl_b32 s30, s25, 5
    v_add_u32 v3, s30, v3
    v_and_b32 v14, 31, v2
    v_mul_u32_u24 v15, 528, v3
    v_lshl_add_u32 v15, v14, 4, v15
    v_add_u32 v3, s26, v3
    s_mov_b32 s31, 3584
    v_mul_lo_u32 v3, v3, s31
    v_lshl_add_u32 v3, v14, 4, v3
    s_lshl_b32 s30, s27, 1
    v_add_u32 v3, s30, v3
    ds_read_b128 v[20:23], v15 offset:0
    ds_read_b128 v[24:27], v15 offset:1056
    ds_read_b128 v[28:31], v15 offset:2112
    ds_read_b128 v[32:35], v15 offset:3168
    s_waitcnt lgkmcnt(3)
    s_mov_b32 s30, 0
    buffer_store_dwordx4 v[20:23], v3, s[16:19], s30 offen
    s_waitcnt lgkmcnt(2)
    s_mov_b32 s30, 7168
    buffer_store_dwordx4 v[24:27], v3, s[16:19], s30 offen
    s_waitcnt lgkmcnt(1)
    s_mov_b32 s30, 14336
    buffer_store_dwordx4 v[28:31], v3, s[16:19], s30 offen
    s_waitcnt lgkmcnt(0)
    s_mov_b32 s30, 21504
    buffer_store_dwordx4 v[32:35], v3, s[16:19], s30 offen
    s_nop 1
    ds_read_b128 v[20:23], v15 offset:4224
    ds_read_b128 v[24:27], v15 offset:5280
    ds_read_b128 v[28:31], v15 offset:6336
    ds_read_b128 v[32:35], v15 offset:7392
    s_waitcnt lgkmcnt(3)
    s_mov_b32 s30, 28672
    buffer_store_dwordx4 v[20:23], v3, s[16:19], s30 offen
    s_waitcnt lgkmcnt(2)
    s_mov_b32 s30, 35840
    buffer_store_dwordx4 v[24:27], v3, s[16:19], s30 offen
    s_waitcnt lgkmcnt(1)
    s_mov_b32 s30, 43008
    buffer_store_dwordx4 v[28:31], v3, s[16:19], s30 offen
    s_waitcnt lgkmcnt(0)
    s_mov_b32 s30, 50176
    buffer_store_dwordx4 v[32:35], v3, s[16:19], s30 offen
    s_nop 1
    ds_read_b128 v[20:23], v15 offset:8448
    ds_read_b128 v[24:27], v15 offset:9504
    ds_read_b128 v[28:31], v15 offset:10560
    ds_read_b128 v[32:35], v15 offset:11616
    s_waitcnt lgkmcnt(3)
    s_mov_b32 s30, 57344
    buffer_store_dwordx4 v[20:23], v3, s[16:19], s30 offen
    s_waitcnt lgkmcnt(2)
    s_mov_b32 s30, 64512
    buffer_store_dwordx4 v[24:27], v3, s[16:19], s30 offen
    s_waitcnt lgkmcnt(1)
    s_mov_b32 s30, 71680
    buffer_store_dwordx4 v[28:31], v3, s[16:19], s30 offen
    s_waitcnt lgkmcnt(0)
    s_mov_b32 s30, 78848
    buffer_store_dwordx4 v[32:35], v3, s[16:19], s30 offen
    s_nop 1
    ds_read_b128 v[20:23], v15 offset:12672
    ds_read_b128 v[24:27], v15 offset:13728
    ds_read_b128 v[28:31], v15 offset:14784
    ds_read_b128 v[32:35], v15 offset:15840
    s_waitcnt lgkmcnt(3)
    s_mov_b32 s30, 86016
    buffer_store_dwordx4 v[20:23], v3, s[16:19], s30 offen
    s_waitcnt lgkmcnt(2)
    s_mov_b32 s30, 93184
    buffer_store_dwordx4 v[24:27], v3, s[16:19], s30 offen
    s_waitcnt lgkmcnt(1)
    s_mov_b32 s30, 100352
    buffer_store_dwordx4 v[28:31], v3, s[16:19], s30 offen
    s_waitcnt lgkmcnt(0)
    s_mov_b32 s30, 107520
    buffer_store_dwordx4 v[32:35], v3, s[16:19], s30 offen
    s_nop 1
k2_end:
    s_endpgm
.p2align 8
k3_kernel:
    s_load_dwordx2 s[4:5], s[0:1], 96
    v_lshrrev_b32 v1, 6, v0
    v_and_b32 v2, 63, v0
    s_nop 0
    v_readfirstlane_b32 s25, v1
    s_cmp_ge_u32 s2, 256
    s_cbranch_scc1 k3_end
    s_and_b32 s30, s2, 7
    s_lshl_b32 s30, s30, 1
    s_bfe_u32 s31, s2, 0x10003
    s_add_u32 s44, s30, s31
    s_lshr_b32 s45, s2, 4
    s_add_u32 s46, s45, 1
    s_sub_u32 s47, 32, s45
    s_and_b32 s28, s25, 1
    s_lshr_b32 s29, s25, 1
    s_waitcnt lgkmcnt(0)
    s_add_u32 s8, s4, 20971520
    s_addc_u32 s9, s5, 0
    s_mov_b32 s10, 16777216
    s_mov_b32 s11, 0x00020000
    s_add_u32 s12, s4, 37748736
    s_addc_u32 s13, s5, 0
    s_mov_b32 s14, 16777216
    s_mov_b32 s15, 0x00020000
    s_add_u32 s16, s4, 62914560
    s_addc_u32 s17, s5, 0
    s_mov_b32 s18, 16777216
    s_mov_b32 s19, 0x00020000
    s_add_u32 s60, s4, 4194304
    s_addc_u32 s61, s5, 0
    s_mov_b32 s62, 16777216
    s_mov_b32 s63, 0x00020000
    s_mov_b32 s56, 1035512379
    v_lshrrev_b32 v3, 5, v2
    v_and_b32 v14, 31, v2
    v_xor_b32 v14, v14, v3
    s_lshl_b32 s30, s25, 4
    v_add_u32 v3, s30, v3
    v_lshlrev_b32 v3, 13, v3
    v_lshl_add_u32 v3, v14, 4, v3
    s_lshl_b32 s30, s44, 9
    v_add_u32 v3, s30, v3
    v_xor_b32 v32, 0, v3
    v_xor_b32 v33, 32, v3
    v_xor_b32 v34, 64, v3
    v_xor_b32 v35, 96, v3
    v_xor_b32 v36, 128, v3
    v_xor_b32 v37, 160, v3
    v_xor_b32 v38, 192, v3
    v_xor_b32 v39, 224, v3
    v_lshrrev_b32 v3, 3, v2
    s_lshl_b32 s30, s25, 6
    s_lshl_b32 s31, s44, 8
    s_add_u32 s30, s30, s31
    v_add_u32 v3, s30, v3
    v_lshlrev_b32 v3, 12, v3
    v_and_b32 v14, 7, v2
    v_lshrrev_b32 v15, 4, v2
    v_xor_b32 v16, v14, v15
    v_lshl_add_u32 v40, v16, 4, v3
    v_add_u32 v15, 4, v15
    v_xor_b32 v16, v14, v15
    v_lshl_add_u32 v41, v16, 4, v3
    v_and_b32 v3, 31, v2
    v_lshrrev_b32 v14, 5, v2
    v_and_b32 v15, 15, v2
    v_xor_b32 v14, v14, v15
    s_lshl_b32 s30, s29, 5
    v_add_u32 v3, s30, v3
    v_lshlrev_b32 v3, 9, v3
    v_lshl_add_u32 v3, v14, 4, v3
    v_xor_b32 v42, 0, v3
    v_xor_b32 v43, 32, v3
    v_xor_b32 v44, 64, v3
    v_xor_b32 v45, 96, v3
    v_xor_b32 v46, 128, v3
    v_xor_b32 v47, 160, v3
    v_xor_b32 v48, 192, v3
    v_xor_b32 v49, 224, v3
    v_xor_b32 v50, 256, v3
    v_xor_b32 v51, 288, v3
    v_xor_b32 v52, 320, v3
    v_xor_b32 v53, 352, v3
    v_xor_b32 v54, 384, v3
    v_xor_b32 v55, 416, v3
    v_xor_b32 v56, 448, v3
    v_xor_b32 v57, 480, v3
    v_and_b32 v3, 31, v2
    v_lshrrev_b32 v14, 5, v2
    s_lshl_b32 s30, s29, 2
    v_add_u32 v14, s30, v14
    v_bfe_u32 v15, v2, 1, 3
    v_xor_b32 v14, v14, v15
    v_lshlrev_b32 v3, 7, v3
    v_lshl_add_u32 v3, v14, 4, v3
    v_add_u32 v3, 0x10000, v3
    v_xor_b32 v58, 0, v3
    v_xor_b32 v59, 32, v3
    v_and_b32 v3, 31, v2
    v_lshrrev_b32 v14, 5, v2
    v_lshlrev_b32 v14, 2, v14
    v_sub_u32 v3, v3, v14
    s_sub_u32 s30, s28, s29
    s_lshl_b32 s30, s30, 5
    v_add_u32 v22, s30, v3
    v_mov_b32 v23, 0xff800000
    v_and_b32 v3, 31, v2
    s_lshl_b32 s30, s28, 5
    v_add_u32 v3, s30, v3
    v_lshlrev_b32 v3, 13, v3
    s_lshl_b32 s30, s44, 9
    v_add_u32 v3, s30, v3
    v_lshrrev_b32 v14, 5, v2
    v_lshl_add_u32 v31, v14, 3, v3
    v_and_b32 v60, 31, v2
    v_mul_u32_u24 v60, 144, v60
    v_lshl_add_u32 v60, v14, 3, v60
    s_mul_i32 s30, s28, 4608
    s_add_u32 s30, s30, 148480
    v_add_u32 v60, s30, v60
    v_lshrrev_b32 v61, 3, v2
    v_lshl_add_u32 v62, s28, 5, v61
    v_lshlrev_b32 v62, 13, v62
    v_mul_u32_u24 v61, 144, v61
    v_and_b32 v63, 7, v2
    v_lshl_add_u32 v61, v63, 4, v61
    v_add_u32 v61, s30, v61
    v_lshl_add_u32 v62, v63, 4, v62
    s_lshl_b32 s30, s44, 9
    v_add_u32 v62, s30, v62
    v_lshl_add_u32 v3, v14, 4, v3
    s_lshl_b32 s57, s45, 19
    s_sub_u32 s58, 31, s45
    s_lshl_b32 s58, s58, 19
    s_lshl_b32 s52, s25, 13
    s_add_u32 s53, s52, 0x10000
    s_mov_b32 s50, 0
    s_mov_b32 s51, 0
    s_lshl_b32 s54, s50, 19
    s_lshl_b32 s55, s51, 7
    s_add_u32 m0, s52, 0
    s_add_u32 s23, s54, 0
    buffer_load_dwordx4 v32, s[8:11], s23 offen lds
    s_add_u32 m0, s52, 1024
    s_add_u32 s23, s54, 16384
    buffer_load_dwordx4 v33, s[8:11], s23 offen lds
    s_add_u32 m0, s52, 2048
    s_add_u32 s23, s54, 32768
    buffer_load_dwordx4 v34, s[8:11], s23 offen lds
    s_add_u32 m0, s52, 3072
    s_add_u32 s23, s54, 49152
    buffer_load_dwordx4 v35, s[8:11], s23 offen lds
    s_add_u32 m0, s52, 4096
    s_add_u32 s23, s54, 65536
    buffer_load_dwordx4 v36, s[8:11], s23 offen lds
    s_add_u32 m0, s52, 5120
    s_add_u32 s23, s54, 81920
    buffer_load_dwordx4 v37, s[8:11], s23 offen lds
    s_add_u32 m0, s52, 6144
    s_add_u32 s23, s54, 98304
    buffer_load_dwordx4 v38, s[8:11], s23 offen lds
    s_add_u32 m0, s52, 7168
    s_add_u32 s23, s54, 114688
    buffer_load_dwordx4 v39, s[8:11], s23 offen lds
    s_add_u32 m0, s53, 0
    s_add_u32 s23, s55, 0
    buffer_load_dwordx4 v40, s[12:15], s23 offen lds
    s_add_u32 m0, s53, 1024
    s_add_u32 s23, s55, 32768
    buffer_load_dwordx4 v41, s[12:15], s23 offen lds
    s_add_u32 m0, s53, 2048
    s_add_u32 s23, s55, 65536
    buffer_load_dwordx4 v40, s[12:15], s23 offen lds
    s_add_u32 m0, s53, 3072
    s_add_u32 s23, s55, 98304
    buffer_load_dwordx4 v41, s[12:15], s23 offen lds
    s_add_u32 m0, s53, 4096
    s_add_u32 s23, s55, 131072
    buffer_load_dwordx4 v40, s[12:15], s23 offen lds
    s_add_u32 m0, s53, 5120
    s_add_u32 s23, s55, 163840
    buffer_load_dwordx4 v41, s[12:15], s23 offen lds
    s_add_u32 m0, s53, 6144
    s_add_u32 s23, s55, 196608
    buffer_load_dwordx4 v40, s[12:15], s23 offen lds
    s_add_u32 m0, s53, 7168
    s_add_u32 s23, s55, 229376
    buffer_load_dwordx4 v41, s[12:15], s23 offen lds
    s_xor_b32 s52, s52, 0x8000
    s_mov_b32 s48, 1
    s_sub_u32 s50, 1, s46
    s_cmp_lt_u32 s48, s46
    s_cselect_b32 s50, s48, s50
    s_lshl_b32 s54, s50, 19
    s_lshl_b32 s55, s51, 7
    s_add_u32 m0, s52, 0
    s_add_u32 s23, s54, 0
    buffer_load_dwordx4 v32, s[8:11], s23 offen lds
    s_add_u32 m0, s52, 1024
    s_add_u32 s23, s54, 16384
    buffer_load_dwordx4 v33, s[8:11], s23 offen lds
    s_add_u32 m0, s52, 2048
    s_add_u32 s23, s54, 32768
    buffer_load_dwordx4 v34, s[8:11], s23 offen lds
    s_add_u32 m0, s52, 3072
    s_add_u32 s23, s54, 49152
    buffer_load_dwordx4 v35, s[8:11], s23 offen lds
    s_add_u32 m0, s52, 4096
    s_add_u32 s23, s54, 65536
    buffer_load_dwordx4 v36, s[8:11], s23 offen lds
    s_add_u32 m0, s52, 5120
    s_add_u32 s23, s54, 81920
    buffer_load_dwordx4 v37, s[8:11], s23 offen lds
    s_add_u32 m0, s52, 6144
    s_add_u32 s23, s54, 98304
    buffer_load_dwordx4 v38, s[8:11], s23 offen lds
    s_add_u32 m0, s52, 7168
    s_add_u32 s23, s54, 114688
    buffer_load_dwordx4 v39, s[8:11], s23 offen lds
    s_xor_b32 s52, s52, 0x8000
    s_xor_b32 s53, s53, 0x8000
    s_mov_b32 s49, 0
    buffer_load_dwordx4 a[0:3], v3, s[60:63], s57 offen offset:0
    buffer_load_dwordx4 a[4:7], v3, s[60:63], s57 offen offset:32
    buffer_load_dwordx4 a[8:11], v3, s[60:63], s57 offen offset:64
    buffer_load_dwordx4 a[12:15], v3, s[60:63], s57 offen offset:96
    buffer_load_dwordx4 a[16:19], v3, s[60:63], s57 offen offset:128
    buffer_load_dwordx4 a[20:23], v3, s[60:63], s57 offen offset:160
    buffer_load_dwordx4 a[24:27], v3, s[60:63], s57 offen offset:192
    buffer_load_dwordx4 a[28:31], v3, s[60:63], s57 offen offset:224
    buffer_load_dwordx4 a[32:35], v3, s[60:63], s57 offen offset:256
    buffer_load_dwordx4 a[36:39], v3, s[60:63], s57 offen offset:288
    buffer_load_dwordx4 a[40:43], v3, s[60:63], s57 offen offset:320
    buffer_load_dwordx4 a[44:47], v3, s[60:63], s57 offen offset:352
    buffer_load_dwordx4 a[48:51], v3, s[60:63], s57 offen offset:384
    buffer_load_dwordx4 a[52:55], v3, s[60:63], s57 offen offset:416
    buffer_load_dwordx4 a[56:59], v3, s[60:63], s57 offen offset:448
    buffer_load_dwordx4 a[60:63], v3, s[60:63], s57 offen offset:480
    buffer_load_dwordx4 a[64:67], v3, s[60:63], s58 offen offset:0
    buffer_load_dwordx4 a[68:71], v3, s[60:63], s58 offen offset:32
    buffer_load_dwordx4 a[72:75], v3, s[60:63], s58 offen offset:64
    buffer_load_dwordx4 a[76:79], v3, s[60:63], s58 offen offset:96
    buffer_load_dwordx4 a[80:83], v3, s[60:63], s58 offen offset:128
    buffer_load_dwordx4 a[84:87], v3, s[60:63], s58 offen offset:160
    buffer_load_dwordx4 a[88:91], v3, s[60:63], s58 offen offset:192
    buffer_load_dwordx4 a[92:95], v3, s[60:63], s58 offen offset:224
    buffer_load_dwordx4 a[96:99], v3, s[60:63], s58 offen offset:256
    buffer_load_dwordx4 a[100:103], v3, s[60:63], s58 offen offset:288
    buffer_load_dwordx4 a[104:107], v3, s[60:63], s58 offen offset:320
    buffer_load_dwordx4 a[108:111], v3, s[60:63], s58 offen offset:352
    buffer_load_dwordx4 a[112:115], v3, s[60:63], s58 offen offset:384
    buffer_load_dwordx4 a[116:119], v3, s[60:63], s58 offen offset:416
    buffer_load_dwordx4 a[120:123], v3, s[60:63], s58 offen offset:448
    buffer_load_dwordx4 a[124:127], v3, s[60:63], s58 offen offset:480
    v_mov_b32 v20, 0xf149f2ca
    v_mov_b32 v21, 0
    v_mov_b32 v128, 0
    v_mov_b32 v129, 0
    v_mov_b32 v130, 0
    v_mov_b32 v131, 0
    v_mov_b32 v132, 0
    v_mov_b32 v133, 0
    v_mov_b32 v134, 0
    v_mov_b32 v135, 0
    v_mov_b32 v136, 0
    v_mov_b32 v137, 0
    v_mov_b32 v138, 0
    v_mov_b32 v139, 0
    v_mov_b32 v140, 0
    v_mov_b32 v141, 0
    v_mov_b32 v142, 0
    v_mov_b32 v143, 0
    v_mov_b32 v144, 0
    v_mov_b32 v145, 0
    v_mov_b32 v146, 0
    v_mov_b32 v147, 0
    v_mov_b32 v148, 0
    v_mov_b32 v149, 0
    v_mov_b32 v150, 0
    v_mov_b32 v151, 0
    v_mov_b32 v152, 0
    v_mov_b32 v153, 0
    v_mov_b32 v154, 0
    v_mov_b32 v155, 0
    v_mov_b32 v156, 0
    v_mov_b32 v157, 0
    v_mov_b32 v158, 0
    v_mov_b32 v159, 0
    v_mov_b32 v160, 0
    v_mov_b32 v161, 0
    v_mov_b32 v162, 0
    v_mov_b32 v163, 0
    v_mov_b32 v164, 0
    v_mov_b32 v165, 0
    v_mov_b32 v166, 0
    v_mov_b32 v167, 0
    v_mov_b32 v168, 0
    v_mov_b32 v169, 0
    v_mov_b32 v170, 0
    v_mov_b32 v171, 0
    v_mov_b32 v172, 0
    v_mov_b32 v173, 0
    v_mov_b32 v174, 0
    v_mov_b32 v175, 0
    v_mov_b32 v176, 0
    v_mov_b32 v177, 0
    v_mov_b32 v178, 0
    v_mov_b32 v179, 0
    v_mov_b32 v180, 0
    v_mov_b32 v181, 0
    v_mov_b32 v182, 0
    v_mov_b32 v183, 0
    v_mov_b32 v184, 0
    v_mov_b32 v185, 0
    v_mov_b32 v186, 0
    v_mov_b32 v187, 0
    v_mov_b32 v188, 0
    v_mov_b32 v189, 0
    v_mov_b32 v190, 0
    v_mov_b32 v191, 0
    v_mov_b32 v192, 0
    v_mov_b32 v193, 0
    v_mov_b32 v194, 0
    v_mov_b32 v195, 0
    v_mov_b32 v196, 0
    v_mov_b32 v197, 0
    v_mov_b32 v198, 0
    v_mov_b32 v199, 0
    v_mov_b32 v200, 0
    v_mov_b32 v201, 0
    v_mov_b32 v202, 0
    v_mov_b32 v203, 0
    v_mov_b32 v204, 0
    v_mov_b32 v205, 0
    v_mov_b32 v206, 0
    v_mov_b32 v207, 0
    v_mov_b32 v208, 0
    v_mov_b32 v209, 0
    v_mov_b32 v210, 0
    v_mov_b32 v211, 0
    v_mov_b32 v212, 0
    v_mov_b32 v213, 0
    v_mov_b32 v214, 0
    v_mov_b32 v215, 0
    v_mov_b32 v216, 0
    v_mov_b32 v217, 0
    v_mov_b32 v218, 0
    v_mov_b32 v219, 0
    v_mov_b32 v220, 0
    v_mov_b32 v221, 0
    v_mov_b32 v222, 0
    v_mov_b32 v223, 0
    v_mov_b32 v224, 0
    v_mov_b32 v225, 0
    v_mov_b32 v226, 0
    v_mov_b32 v227, 0
    v_mov_b32 v228, 0
    v_mov_b32 v229, 0
    v_mov_b32 v230, 0
    v_mov_b32 v231, 0
    v_mov_b32 v232, 0
    v_mov_b32 v233, 0
    v_mov_b32 v234, 0
    v_mov_b32 v235, 0
    v_mov_b32 v236, 0
    v_mov_b32 v237, 0
    v_mov_b32 v238, 0
    v_mov_b32 v239, 0
    v_mov_b32 v240, 0
    v_mov_b32 v241, 0
    v_mov_b32 v242, 0
    v_mov_b32 v243, 0
    v_mov_b32 v244, 0
    v_mov_b32 v245, 0
    v_mov_b32 v246, 0
    v_mov_b32 v247, 0
    v_mov_b32 v248, 0
    v_mov_b32 v249, 0
    v_mov_b32 v250, 0
    v_mov_b32 v251, 0
    v_mov_b32 v252, 0
    v_mov_b32 v253, 0
    v_mov_b32 v254, 0
    v_mov_b32 v255, 0
    s_waitcnt vmcnt(0)
    s_barrier
    ds_read_b128 v[64:67], v42
    s_waitcnt lgkmcnt(0)
    v_mfma_f32_32x32x16_bf16 v[96:111], v[64:67], a[0:3], 0
    ds_read_b128 v[68:71], v43
    s_waitcnt lgkmcnt(0)
    v_mfma_f32_32x32x16_bf16 v[96:111], v[68:71], a[4:7], v[96:111]
    ds_read_b128 v[72:75], v44
    s_waitcnt lgkmcnt(0)
    v_mfma_f32_32x32x16_bf16 v[96:111], v[72:75], a[8:11], v[96:111]
    ds_read_b128 v[76:79], v45
    s_waitcnt lgkmcnt(0)
    v_mfma_f32_32x32x16_bf16 v[96:111], v[76:79], a[12:15], v[96:111]
    ds_read_b128 v[64:67], v46
    s_waitcnt lgkmcnt(0)
    v_mfma_f32_32x32x16_bf16 v[96:111], v[64:67], a[16:19], v[96:111]
    ds_read_b128 v[68:71], v47
    s_waitcnt lgkmcnt(0)
    v_mfma_f32_32x32x16_bf16 v[96:111], v[68:71], a[20:23], v[96:111]
    ds_read_b128 v[72:75], v48
    s_waitcnt lgkmcnt(0)
    v_mfma_f32_32x32x16_bf16 v[96:111], v[72:75], a[24:27], v[96:111]
    ds_read_b128 v[76:79], v49
    s_waitcnt lgkmcnt(0)
    v_mfma_f32_32x32x16_bf16 v[96:111], v[76:79], a[28:31], v[96:111]
    ds_read_b128 v[64:67], v50
    s_waitcnt lgkmcnt(0)
    v_mfma_f32_32x32x16_bf16 v[96:111], v[64:67], a[32:35], v[96:111]
    ds_read_b128 v[68:71], v51
    s_waitcnt lgkmcnt(0)
    v_mfma_f32_32x32x16_bf16 v[96:111], v[68:71], a[36:39], v[96:111]
    ds_read_b128 v[72:75], v52
    s_waitcnt lgkmcnt(0)
    v_mfma_f32_32x32x16_bf16 v[96:111], v[72:75], a[40:43], v[96:111]
    ds_read_b128 v[76:79], v53
    s_waitcnt lgkmcnt(0)
    v_mfma_f32_32x32x16_bf16 v[96:111], v[76:79], a[44:47], v[96:111]
    ds_read_b128 v[64:67], v54
    s_waitcnt lgkmcnt(0)
    v_mfma_f32_32x32x16_bf16 v[96:111], v[64:67], a[48:51], v[96:111]
    ds_read_b128 v[68:71], v55
    s_waitcnt lgkmcnt(0)
    v_mfma_f32_32x32x16_bf16 v[96:111], v[68:71], a[52:55], v[96:111]
    ds_read_b128 v[72:75], v56
    s_waitcnt lgkmcnt(0)
    v_mfma_f32_32x32x16_bf16 v[96:111], v[72:75], a[56:59], v[96:111]
    ds_read_b128 v[76:79], v57
    s_waitcnt lgkmcnt(0)
    v_mfma_f32_32x32x16_bf16 v[96:111], v[76:79], a[60:63], v[96:111]
    v_xor_b32 v42, 0x8000, v42
    v_xor_b32 v43, 0x8000, v43
    v_xor_b32 v44, 0x8000, v44
    v_xor_b32 v45, 0x8000, v45
    v_xor_b32 v46, 0x8000, v46
    v_xor_b32 v47, 0x8000, v47
    v_xor_b32 v48, 0x8000, v48
    v_xor_b32 v49, 0x8000, v49
    v_xor_b32 v50, 0x8000, v50
    v_xor_b32 v51, 0x8000, v51
    v_xor_b32 v52, 0x8000, v52
    v_xor_b32 v53, 0x8000, v53
    v_xor_b32 v54, 0x8000, v54
    v_xor_b32 v55, 0x8000, v55
    v_xor_b32 v56, 0x8000, v56
    v_xor_b32 v57, 0x8000, v57
    s_nop 15
    s_mov_b32 s59, 1
k3_la:
    s_cmp_ge_u32 s59, s46
    s_cbranch_scc1 k3_la_end
    s_waitcnt vmcnt(0)
    s_barrier
    s_add_u32 s48, s48, 1
    s_min_u32 s48, s48, 32
    s_sub_u32 s50, s48, s46
    s_cmp_lt_u32 s48, s46
    s_cselect_b32 s50, s48, s50
    s_add_u32 s49, s49, 1
    s_min_u32 s49, s49, 32
    s_sub_u32 s51, s49, s46
    s_cmp_lt_u32 s49, s46
    s_cselect_b32 s51, s49, s51
    s_lshl_b32 s54, s50, 19
    s_lshl_b32 s55, s51, 7
    ds_read_b128 v[64:67], v42
    ds_read_b128 v[68:71], v43
    ds_read_b128 v[72:75], v44
    ds_read_b128 v[76:79], v45
    ds_read_b128 v[80:83], v46
    ds_read_b128 v[84:87], v47
    ds_read_b128 v[88:91], v48
    ds_read_b128 v[92:95], v49
    s_waitcnt lgkmcnt(7)
    v_mfma_f32_32x32x16_bf16 v[112:127], v[64:67], a[0:3], 0
    v_max3_f32 v24, v96, v97, v98
    v_max3_f32 v25, v99, v100, v101
    v_max3_f32 v26, v102, v103, v104
    v_max3_f32 v27, v105, v106, v107
    v_max3_f32 v24, v24, v108, v109
    v_max3_f32 v25, v25, v110, v111
    s_add_u32 m0, s52, 0
    s_add_u32 s23, s54, 0
    buffer_load_dwordx4 v32, s[8:11], s23 offen lds
    ds_read_b128 v[64:67], v50
    s_waitcnt lgkmcnt(7)
    v_mfma_f32_32x32x16_bf16 v[112:127], v[68:71], a[4:7], v[112:127]
    v_max3_f32 v24, v24, v25, v26
    v_max_f32 v24, v24, v27
    v_mov_b32 v25, v24
    s_nop 1
    v_permlane32_swap_b32 v24, v25
    v_max_f32 v24, v24, v25
    s_add_u32 m0, s52, 1024
    s_add_u32 s23, s54, 16384
    buffer_load_dwordx4 v33, s[8:11], s23 offen lds
    ds_read_b128 v[68:71], v51
    s_waitcnt lgkmcnt(7)
    v_mfma_f32_32x32x16_bf16 v[112:127], v[72:75], a[8:11], v[112:127]
    v_mul_f32 v24, s56, v24
    v_add_f32 v25, 0x41000000, v20
    v_cmp_gt_f32 vcc, v24, v25
    s_cbranch_vccz nors_9
    v_max_f32 v24, v24, v20
    v_sub_f32 v25, v20, v24
    v_exp_f32 v25, v25
    v_mov_b32 v20, v24
    v_mul_f32 v21, v21, v25
    v_mul_f32 v128, v25, v128
    v_mul_f32 v129, v25, v129
    v_mul_f32 v130, v25, v130
    v_mul_f32 v131, v25, v131
    v_mul_f32 v132, v25, v132
    v_mul_f32 v133, v25, v133
    v_mul_f32 v134, v25, v134
    v_mul_f32 v135, v25, v135
    v_mul_f32 v136, v25, v136
    v_mul_f32 v137, v25, v137
    v_mul_f32 v138, v25, v138
    v_mul_f32 v139, v25, v139
    v_mul_f32 v140, v25, v140
    v_mul_f32 v141, v25, v141
    v_mul_f32 v142, v25, v142
    v_mul_f32 v143, v25, v143
    v_mul_f32 v144, v25, v144
    v_mul_f32 v145, v25, v145
    v_mul_f32 v146, v25, v146
    v_mul_f32 v147, v25, v147
    v_mul_f32 v148, v25, v148
    v_mul_f32 v149, v25, v149
    v_mul_f32 v150, v25, v150
    v_mul_f32 v151, v25, v151
    v_mul_f32 v152, v25, v152
    v_mul_f32 v153, v25, v153
    v_mul_f32 v154, v25, v154
    v_mul_f32 v155, v25, v155
    v_mul_f32 v156, v25, v156
    v_mul_f32 v157, v25, v157
    v_mul_f32 v158, v25, v158
    v_mul_f32 v159, v25, v159
    v_mul_f32 v160, v25, v160
    v_mul_f32 v161, v25, v161
    v_mul_f32 v162, v25, v162
    v_mul_f32 v163, v25, v163
    v_mul_f32 v164, v25, v164
    v_mul_f32 v165, v25, v165
    v_mul_f32 v166, v25, v166
    v_mul_f32 v167, v25, v167
    v_mul_f32 v168, v25, v168
    v_mul_f32 v169, v25, v169
    v_mul_f32 v170, v25, v170
    v_mul_f32 v171, v25, v171
    v_mul_f32 v172, v25, v172
    v_mul_f32 v173, v25, v173
    v_mul_f32 v174, v25, v174
    v_mul_f32 v175, v25, v175
    v_mul_f32 v176, v25, v176
    v_mul_f32 v177, v25, v177
    v_mul_f32 v178, v25, v178
    v_mul_f32 v179, v25, v179
    v_mul_f32 v180, v25, v180
    v_mul_f32 v181, v25, v181
    v_mul_f32 v182, v25, v182
    v_mul_f32 v183, v25, v183
    v_mul_f32 v184, v25, v184
    v_mul_f32 v185, v25, v185
    v_mul_f32 v186, v25, v186
    v_mul_f32 v187, v25, v187
    v_mul_f32 v188, v25, v188
    v_mul_f32 v189, v25, v189
    v_mul_f32 v190, v25, v190
    v_mul_f32 v191, v25, v191
    v_mul_f32 v192, v25, v192
    v_mul_f32 v193, v25, v193
    v_mul_f32 v194, v25, v194
    v_mul_f32 v195, v25, v195
    v_mul_f32 v196, v25, v196
    v_mul_f32 v197, v25, v197
    v_mul_f32 v198, v25, v198
    v_mul_f32 v199, v25, v199
    v_mul_f32 v200, v25, v200
    v_mul_f32 v201, v25, v201
    v_mul_f32 v202, v25, v202
    v_mul_f32 v203, v25, v203
    v_mul_f32 v204, v25, v204
    v_mul_f32 v205, v25, v205
    v_mul_f32 v206, v25, v206
    v_mul_f32 v207, v25, v207
    v_mul_f32 v208, v25, v208
    v_mul_f32 v209, v25, v209
    v_mul_f32 v210, v25, v210
    v_mul_f32 v211, v25, v211
    v_mul_f32 v212, v25, v212
    v_mul_f32 v213, v25, v213
    v_mul_f32 v214, v25, v214
    v_mul_f32 v215, v25, v215
    v_mul_f32 v216, v25, v216
    v_mul_f32 v217, v25, v217
    v_mul_f32 v218, v25, v218
    v_mul_f32 v219, v25, v219
    v_mul_f32 v220, v25, v220
    v_mul_f32 v221, v25, v221
    v_mul_f32 v222, v25, v222
    v_mul_f32 v223, v25, v223
    v_mul_f32 v224, v25, v224
    v_mul_f32 v225, v25, v225
    v_mul_f32 v226, v25, v226
    v_mul_f32 v227, v25, v227
    v_mul_f32 v228, v25, v228
    v_mul_f32 v229, v25, v229
    v_mul_f32 v230, v25, v230
    v_mul_f32 v231, v25, v231
    v_mul_f32 v232, v25, v232
    v_mul_f32 v233, v25, v233
    v_mul_f32 v234, v25, v234
    v_mul_f32 v235, v25, v235
    v_mul_f32 v236, v25, v236
    v_mul_f32 v237, v25, v237
    v_mul_f32 v238, v25, v238
    v_mul_f32 v239, v25, v239
    v_mul_f32 v240, v25, v240
    v_mul_f32 v241, v25, v241
    v_mul_f32 v242, v25, v242
    v_mul_f32 v243, v25, v243
    v_mul_f32 v244, v25, v244
    v_mul_f32 v245, v25, v245
    v_mul_f32 v246, v25, v246
    v_mul_f32 v247, v25, v247
    v_mul_f32 v248, v25, v248
    v_mul_f32 v249, v25, v249
    v_mul_f32 v250, v25, v250
    v_mul_f32 v251, v25, v251
    v_mul_f32 v252, v25, v252
    v_mul_f32 v253, v25, v253
    v_mul_f32 v254, v25, v254
    v_mul_f32 v255, v25, v255
nors_9:
    v_fma_f32 v96, v96, s56, -v20
    v_exp_f32 v96, v96
    s_add_u32 m0, s52, 2048
    s_add_u32 s23, s54, 32768
    buffer_load_dwordx4 v34, s[8:11], s23 offen lds
    ds_read_b128 v[72:75], v52
    s_waitcnt lgkmcnt(7)
    v_mfma_f32_32x32x16_bf16 v[112:127], v[76:79], a[12:15], v[112:127]
    v_fma_f32 v97, v97, s56, -v20
    v_exp_f32 v97, v97
    v_fma_f32 v98, v98, s56, -v20
    v_exp_f32 v98, v98
    v_fma_f32 v99, v99, s56, -v20
    v_exp_f32 v99, v99
    s_add_u32 m0, s52, 3072
    s_add_u32 s23, s54, 49152
    buffer_load_dwordx4 v35, s[8:11], s23 offen lds
    ds_read_b128 v[76:79], v53
    s_waitcnt lgkmcnt(7)
    v_mfma_f32_32x32x16_bf16 v[112:127], v[80:83], a[16:19], v[112:127]
    v_fma_f32 v100, v100, s56, -v20
    v_exp_f32 v100, v100
    v_fma_f32 v101, v101, s56, -v20
    v_exp_f32 v101, v101
    v_fma_f32 v102, v102, s56, -v20
    v_exp_f32 v102, v102
    s_add_u32 m0, s52, 4096
    s_add_u32 s23, s54, 65536
    buffer_load_dwordx4 v36, s[8:11], s23 offen lds
    ds_read_b128 v[80:83], v54
    s_waitcnt lgkmcnt(7)
    v_mfma_f32_32x32x16_bf16 v[112:127], v[84:87], a[20:23], v[112:127]
    v_fma_f32 v103, v103, s56, -v20
    v_exp_f32 v103, v103
    v_fma_f32 v104, v104, s56, -v20
    v_exp_f32 v104, v104
    v_fma_f32 v105, v105, s56, -v20
    v_exp_f32 v105, v105
    s_add_u32 m0, s52, 5120
    s_add_u32 s23, s54, 81920
    buffer_load_dwordx4 v37, s[8:11], s23 offen lds
    ds_read_b128 v[84:87], v55
    s_waitcnt lgkmcnt(7)
    v_mfma_f32_32x32x16_bf16 v[112:127], v[88:91], a[24:27], v[112:127]
    v_fma_f32 v106, v106, s56, -v20
    v_exp_f32 v106, v106
    v_fma_f32 v107, v107, s56, -v20
    v_exp_f32 v107, v107
    v_fma_f32 v108, v108, s56, -v20
    v_exp_f32 v108, v108
    s_add_u32 m0, s52, 6144
    s_add_u32 s23, s54, 98304
    buffer_load_dwordx4 v38, s[8:11], s23 offen lds
    ds_read_b128 v[88:91], v56
    s_waitcnt lgkmcnt(7)
    v_mfma_f32_32x32x16_bf16 v[112:127], v[92:95], a[28:31], v[112:127]
    v_fma_f32 v109, v109, s56, -v20
    v_exp_f32 v109, v109
    v_fma_f32 v110, v110, s56, -v20
    v_exp_f32 v110, v110
    v_fma_f32 v111, v111, s56, -v20
    v_exp_f32 v111, v111
    s_add_u32 m0, s52, 7168
    s_add_u32 s23, s54, 114688
    buffer_load_dwordx4 v39, s[8:11], s23 offen lds
    ds_read_b128 v[92:95], v57
    s_waitcnt lgkmcnt(7)
    v_mfma_f32_32x32x16_bf16 v[112:127], v[64:67], a[32:35], v[112:127]
    v_add_f32 v21, v21, v96
    v_add_f32 v21, v21, v97
    v_add_f32 v21, v21, v98
    v_add_f32 v21, v21, v99
    v_add_f32 v21, v21, v100
    v_add_f32 v21, v21, v101
    s_add_u32 m0, s53, 0
    s_add_u32 s23, s55, 0
    buffer_load_dwordx4 v40, s[12:15], s23 offen lds
    s_waitcnt lgkmcnt(6)
    v_mfma_f32_32x32x16_bf16 v[112:127], v[68:71], a[36:39], v[112:127]
    v_add_f32 v21, v21, v102
    v_add_f32 v21, v21, v103
    v_add_f32 v21, v21, v104
    v_add_f32 v21, v21, v105
    v_add_f32 v21, v21, v106
    v_add_f32 v21, v21, v107
    s_add_u32 m0, s53, 1024
    s_add_u32 s23, s55, 32768
    buffer_load_dwordx4 v41, s[12:15], s23 offen lds
    s_waitcnt lgkmcnt(5)
    v_mfma_f32_32x32x16_bf16 v[112:127], v[72:75], a[40:43], v[112:127]
    v_add_f32 v21, v21, v108
    v_add_f32 v21, v21, v109
    v_add_f32 v21, v21, v110
    v_add_f32 v21, v21, v111
    v_cvt_pk_bf16_f32 v96, v96, v97
    v_cvt_pk_bf16_f32 v97, v98, v99
    s_add_u32 m0, s53, 2048
    s_add_u32 s23, s55, 65536
    buffer_load_dwordx4 v40, s[12:15], s23 offen lds
    s_waitcnt lgkmcnt(4)
    v_mfma_f32_32x32x16_bf16 v[112:127], v[76:79], a[44:47], v[112:127]
    v_cvt_pk_bf16_f32 v98, v100, v101
    v_cvt_pk_bf16_f32 v99, v102, v103
    v_cvt_pk_bf16_f32 v100, v104, v105
    v_cvt_pk_bf16_f32 v101, v106, v107
    v_cvt_pk_bf16_f32 v102, v108, v109
    v_cvt_pk_bf16_f32 v103, v110, v111
    s_add_u32 m0, s53, 3072
    s_add_u32 s23, s55, 98304
    buffer_load_dwordx4 v41, s[12:15], s23 offen lds
    s_waitcnt lgkmcnt(3)
    v_mfma_f32_32x32x16_bf16 v[112:127], v[80:83], a[48:51], v[112:127]
    s_add_u32 m0, s53, 4096
    s_add_u32 s23, s55, 131072
    buffer_load_dwordx4 v40, s[12:15], s23 offen lds
    s_waitcnt lgkmcnt(2)
    v_mfma_f32_32x32x16_bf16 v[112:127], v[84:87], a[52:55], v[112:127]
    s_add_u32 m0, s53, 5120
    s_add_u32 s23, s55, 163840
    buffer_load_dwordx4 v41, s[12:15], s23 offen lds
    s_waitcnt lgkmcnt(1)
    v_mfma_f32_32x32x16_bf16 v[112:127], v[88:91], a[56:59], v[112:127]
    s_add_u32 m0, s53, 6144
    s_add_u32 s23, s55, 196608
    buffer_load_dwordx4 v40, s[12:15], s23 offen lds
    s_waitcnt lgkmcnt(0)
    v_mfma_f32_32x32x16_bf16 v[112:127], v[92:95], a[60:63], v[112:127]
    s_add_u32 m0, s53, 7168
    s_add_u32 s23, s55, 229376
    buffer_load_dwordx4 v41, s[12:15], s23 offen lds
    ds_read_b128 v[64:67], v58 offset:0
    ds_read_b128 v[68:71], v59 offset:0
    ds_read_b128 v[72:75], v58 offset:4096
    ds_read_b128 v[76:79], v59 offset:4096
    ds_read_b128 v[80:83], v58 offset:8192
    ds_read_b128 v[84:87], v59 offset:8192
    ds_read_b128 v[88:91], v58 offset:12288
    ds_read_b128 v[92:95], v59 offset:12288
    s_waitcnt lgkmcnt(7)
    v_mfma_f32_32x32x16_bf16 v[128:143], v[64:67], v[96:99], v[128:143]
    ds_read_b128 v[64:67], v58 offset:16384
    s_waitcnt lgkmcnt(7)
    v_mfma_f32_32x32x16_bf16 v[128:143], v[68:71], v[100:103], v[128:143]
    ds_read_b128 v[68:71], v59 offset:16384
    s_waitcnt lgkmcnt(7)
    v_mfma_f32_32x32x16_bf16 v[144:159], v[72:75], v[96:99], v[144:159]
    ds_read_b128 v[72:75], v58 offset:20480
    s_waitcnt lgkmcnt(7)
    v_mfma_f32_32x32x16_bf16 v[144:159], v[76:79], v[100:103], v[144:159]
    ds_read_b128 v[76:79], v59 offset:20480
    s_waitcnt lgkmcnt(7)
    v_mfma_f32_32x32x16_bf16 v[160:175], v[80:83], v[96:99], v[160:175]
    ds_read_b128 v[80:83], v58 offset:24576
    s_waitcnt lgkmcnt(7)
    v_mfma_f32_32x32x16_bf16 v[160:175], v[84:87], v[100:103], v[160:175]
    ds_read_b128 v[84:87], v59 offset:24576
    s_waitcnt lgkmcnt(7)
    v_mfma_f32_32x32x16_bf16 v[176:191], v[88:91], v[96:99], v[176:191]
    ds_read_b128 v[88:91], v58 offset:28672
    s_waitcnt lgkmcnt(7)
    v_mfma_f32_32x32x16_bf16 v[176:191], v[92:95], v[100:103], v[176:191]
    ds_read_b128 v[92:95], v59 offset:28672
    s_waitcnt lgkmcnt(7)
    v_mfma_f32_32x32x16_bf16 v[192:207], v[64:67], v[96:99], v[192:207]
    s_waitcnt lgkmcnt(6)
    v_mfma_f32_32x32x16_bf16 v[192:207], v[68:71], v[100:103], v[192:207]
    s_waitcnt lgkmcnt(5)
    v_mfma_f32_32x32x16_bf16 v[208:223], v[72:75], v[96:99], v[208:223]
    s_waitcnt lgkmcnt(4)
    v_mfma_f32_32x32x16_bf16 v[208:223], v[76:79], v[100:103], v[208:223]
    s_waitcnt lgkmcnt(3)
    v_mfma_f32_32x32x16_bf16 v[224:239], v[80:83], v[96:99], v[224:239]
    s_waitcnt lgkmcnt(2)
    v_mfma_f32_32x32x16_bf16 v[224:239], v[84:87], v[100:103], v[224:239]
    s_waitcnt lgkmcnt(1)
    v_mfma_f32_32x32x16_bf16 v[240:255], v[88:91], v[96:99], v[240:255]
    s_waitcnt lgkmcnt(0)
    v_mfma_f32_32x32x16_bf16 v[240:255], v[92:95], v[100:103], v[240:255]
    v_xor_b32 v42, 0x8000, v42
    v_xor_b32 v43, 0x8000, v43
    v_xor_b32 v44, 0x8000, v44
    v_xor_b32 v45, 0x8000, v45
    v_xor_b32 v46, 0x8000, v46
    v_xor_b32 v47, 0x8000, v47
    v_xor_b32 v48, 0x8000, v48
    v_xor_b32 v49, 0x8000, v49
    v_xor_b32 v50, 0x8000, v50
    v_xor_b32 v51, 0x8000, v51
    v_xor_b32 v52, 0x8000, v52
    v_xor_b32 v53, 0x8000, v53
    v_xor_b32 v54, 0x8000, v54
    v_xor_b32 v55, 0x8000, v55
    v_xor_b32 v56, 0x8000, v56
    v_xor_b32 v57, 0x8000, v57
    v_xor_b32 v58, 0x8000, v58
    v_xor_b32 v59, 0x8000, v59
    s_xor_b32 s52, s52, 0x8000
    s_xor_b32 s53, s53, 0x8000
    v_mov_b32 v96, v112
    v_mov_b32 v97, v113
    v_mov_b32 v98, v114
    v_mov_b32 v99, v115
    v_mov_b32 v100, v116
    v_mov_b32 v101, v117
    v_mov_b32 v102, v118
    v_mov_b32 v103, v119
    v_mov_b32 v104, v120
    v_mov_b32 v105, v121
    v_mov_b32 v106, v122
    v_mov_b32 v107, v123
    v_mov_b32 v108, v124
    v_mov_b32 v109, v125
    v_mov_b32 v110, v126
    v_mov_b32 v111, v127
    s_add_u32 s59, s59, 1
    s_branch k3_la
k3_la_end:
    s_waitcnt vmcnt(0)
    s_barrier
    s_add_u32 s48, s48, 1
    s_min_u32 s48, s48, 32
    s_sub_u32 s50, s48, s46
    s_cmp_lt_u32 s48, s46
    s_cselect_b32 s50, s48, s50
    s_add_u32 s49, s49, 1
    s_min_u32 s49, s49, 32
    s_sub_u32 s51, s49, s46
    s_cmp_lt_u32 s49, s46
    s_cselect_b32 s51, s49, s51
    s_lshl_b32 s54, s50, 19
    s_lshl_b32 s55, s51, 7
    ds_read_b128 v[64:67], v42
    ds_read_b128 v[68:71], v43
    ds_read_b128 v[72:75], v44
    ds_read_b128 v[76:79], v45
    ds_read_b128 v[80:83], v46
    ds_read_b128 v[84:87], v47
    ds_read_b128 v[88:91], v48
    ds_read_b128 v[92:95], v49
    s_waitcnt lgkmcnt(7)
    v_mfma_f32_32x32x16_bf16 v[112:127], v[64:67], a[64:67], 0
    v_cmp_le_i32 vcc, 0, v22
    v_cndmask_b32 v96, v23, v96, vcc
    v_cmp_le_i32 vcc, 1, v22
    v_cndmask_b32 v97, v23, v97, vcc
    v_cmp_le_i32 vcc, 2, v22
    v_cndmask_b32 v98, v23, v98, vcc
    s_add_u32 m0, s52, 0
    s_add_u32 s23, s54, 0
    buffer_load_dwordx4 v32, s[8:11], s23 offen lds
    ds_read_b128 v[64:67], v50
    s_waitcnt lgkmcnt(7)
    v_mfma_f32_32x32x16_bf16 v[112:127], v[68:71], a[68:71], v[112:127]
    v_cmp_le_i32 vcc, 3, v22
    v_cndmask_b32 v99, v23, v99, vcc
    v_cmp_le_i32 vcc, 8, v22
    v_cndmask_b32 v100, v23, v100, vcc
    v_cmp_le_i32 vcc, 9, v22
    v_cndmask_b32 v101, v23, v101, vcc
    s_add_u32 m0, s52, 1024
    s_add_u32 s23, s54, 16384
    buffer_load_dwordx4 v33, s[8:11], s23 offen lds
    ds_read_b128 v[68:71], v51
    s_waitcnt lgkmcnt(7)
    v_mfma_f32_32x32x16_bf16 v[112:127], v[72:75], a[72:75], v[112:127]
    v_cmp_le_i32 vcc, 10, v22
    v_cndmask_b32 v102, v23, v102, vcc
    v_cmp_le_i32 vcc, 11, v22
    v_cndmask_b32 v103, v23, v103, vcc
    v_cmp_le_i32 vcc, 16, v22
    v_cndmask_b32 v104, v23, v104, vcc
    s_add_u32 m0, s52, 2048
    s_add_u32 s23, s54, 32768
    buffer_load_dwordx4 v34, s[8:11], s23 offen lds
    ds_read_b128 v[72:75], v52
    s_waitcnt lgkmcnt(7)
    v_mfma_f32_32x32x16_bf16 v[112:127], v[76:79], a[76:79], v[112:127]
    v_cmp_le_i32 vcc, 17, v22
    v_cndmask_b32 v105, v23, v105, vcc
    v_cmp_le_i32 vcc, 18, v22
    v_cndmask_b32 v106, v23, v106, vcc
    v_cmp_le_i32 vcc, 19, v22
    v_cndmask_b32 v107, v23, v107, vcc
    s_add_u32 m0, s52, 3072
    s_add_u32 s23, s54, 49152
    buffer_load_dwordx4 v35, s[8:11], s23 offen lds
    ds_read_b128 v[76:79], v53
    s_waitcnt lgkmcnt(7)
    v_mfma_f32_32x32x16_bf16 v[112:127], v[80:83], a[80:83], v[112:127]
    v_cmp_le_i32 vcc, 24, v22
    v_cndmask_b32 v108, v23, v108, vcc
    v_cmp_le_i32 vcc, 25, v22
    v_cndmask_b32 v109, v23, v109, vcc
    v_cmp_le_i32 vcc, 26, v22
    v_cndmask_b32 v110, v23, v110, vcc
    s_add_u32 m0, s52, 4096
    s_add_u32 s23, s54, 65536
    buffer_load_dwordx4 v36, s[8:11], s23 offen lds
    ds_read_b128 v[80:83], v54
    s_waitcnt lgkmcnt(7)
    v_mfma_f32_32x32x16_bf16 v[112:127], v[84:87], a[84:87], v[112:127]
    v_cmp_le_i32 vcc, 27, v22
    v_cndmask_b32 v111, v23, v111, vcc
    v_max3_f32 v24, v96, v97, v98
    v_max3_f32 v25, v99, v100, v101
    v_max3_f32 v26, v102, v103, v104
    v_max3_f32 v27, v105, v106, v107
    s_add_u32 m0, s52, 5120
    s_add_u32 s23, s54, 81920
    buffer_load_dwordx4 v37, s[8:11], s23 offen lds
    ds_read_b128 v[84:87], v55
    s_waitcnt lgkmcnt(7)
    v_mfma_f32_32x32x16_bf16 v[112:127], v[88:91], a[88:91], v[112:127]
    v_max3_f32 v24, v24, v108, v109
    v_max3_f32 v25, v25, v110, v111
    v_max3_f32 v24, v24, v25, v26
    v_max_f32 v24, v24, v27
    v_mov_b32 v25, v24
    s_nop 1
    s_add_u32 m0, s52, 6144
    s_add_u32 s23, s54, 98304
    buffer_load_dwordx4 v38, s[8:11], s23 offen lds
    ds_read_b128 v[88:91], v56
    s_waitcnt lgkmcnt(7)
    v_mfma_f32_32x32x16_bf16 v[112:127], v[92:95], a[92:95], v[112:127]
    v_permlane32_swap_b32 v24, v25
    v_max_f32 v24, v24, v25
    v_mul_f32 v24, s56, v24
    v_add_f32 v25, 0x41000000, v20
    v_cmp_gt_f32 vcc, v24, v25
    s_cbranch_vccz nors_10
    v_max_f32 v24, v24, v20
    v_sub_f32 v25, v20, v24
    v_exp_f32 v25, v25
    v_mov_b32 v20, v24
    v_mul_f32 v21, v21, v25
    v_mul_f32 v128, v25, v128
    v_mul_f32 v129, v25, v129
    v_mul_f32 v130, v25, v130
    v_mul_f32 v131, v25, v131
    v_mul_f32 v132, v25, v132
    v_mul_f32 v133, v25, v133
    v_mul_f32 v134, v25, v134
    v_mul_f32 v135, v25, v135
    v_mul_f32 v136, v25, v136
    v_mul_f32 v137, v25, v137
    v_mul_f32 v138, v25, v138
    v_mul_f32 v139, v25, v139
    v_mul_f32 v140, v25, v140
    v_mul_f32 v141, v25, v141
    v_mul_f32 v142, v25, v142
    v_mul_f32 v143, v25, v143
    v_mul_f32 v144, v25, v144
    v_mul_f32 v145, v25, v145
    v_mul_f32 v146, v25, v146
    v_mul_f32 v147, v25, v147
    v_mul_f32 v148, v25, v148
    v_mul_f32 v149, v25, v149
    v_mul_f32 v150, v25, v150
    v_mul_f32 v151, v25, v151
    v_mul_f32 v152, v25, v152
    v_mul_f32 v153, v25, v153
    v_mul_f32 v154, v25, v154
    v_mul_f32 v155, v25, v155
    v_mul_f32 v156, v25, v156
    v_mul_f32 v157, v25, v157
    v_mul_f32 v158, v25, v158
    v_mul_f32 v159, v25, v159
    v_mul_f32 v160, v25, v160
    v_mul_f32 v161, v25, v161
    v_mul_f32 v162, v25, v162
    v_mul_f32 v163, v25, v163
    v_mul_f32 v164, v25, v164
    v_mul_f32 v165, v25, v165
    v_mul_f32 v166, v25, v166
    v_mul_f32 v167, v25, v167
    v_mul_f32 v168, v25, v168
    v_mul_f32 v169, v25, v169
    v_mul_f32 v170, v25, v170
    v_mul_f32 v171, v25, v171
    v_mul_f32 v172, v25, v172
    v_mul_f32 v173, v25, v173
    v_mul_f32 v174, v25, v174
    v_mul_f32 v175, v25, v175
    v_mul_f32 v176, v25, v176
    v_mul_f32 v177, v25, v177
    v_mul_f32 v178, v25, v178
    v_mul_f32 v179, v25, v179
    v_mul_f32 v180, v25, v180
    v_mul_f32 v181, v25, v181
    v_mul_f32 v182, v25, v182
    v_mul_f32 v183, v25, v183
    v_mul_f32 v184, v25, v184
    v_mul_f32 v185, v25, v185
    v_mul_f32 v186, v25, v186
    v_mul_f32 v187, v25, v187
    v_mul_f32 v188, v25, v188
    v_mul_f32 v189, v25, v189
    v_mul_f32 v190, v25, v190
    v_mul_f32 v191, v25, v191
    v_mul_f32 v192, v25, v192
    v_mul_f32 v193, v25, v193
    v_mul_f32 v194, v25, v194
    v_mul_f32 v195, v25, v195
    v_mul_f32 v196, v25, v196
    v_mul_f32 v197, v25, v197
    v_mul_f32 v198, v25, v198
    v_mul_f32 v199, v25, v199
    v_mul_f32 v200, v25, v200
    v_mul_f32 v201, v25, v201
    v_mul_f32 v202, v25, v202
    v_mul_f32 v203, v25, v203
    v_mul_f32 v204, v25, v204
    v_mul_f32 v205, v25, v205
    v_mul_f32 v206, v25, v206
    v_mul_f32 v207, v25, v207
    v_mul_f32 v208, v25, v208
    v_mul_f32 v209, v25, v209
    v_mul_f32 v210, v25, v210
    v_mul_f32 v211, v25, v211
    v_mul_f32 v212, v25, v212
    v_mul_f32 v213, v25, v213
    v_mul_f32 v214, v25, v214
    v_mul_f32 v215, v25, v215
    v_mul_f32 v216, v25, v216
    v_mul_f32 v217, v25, v217
    v_mul_f32 v218, v25, v218
    v_mul_f32 v219, v25, v219
    v_mul_f32 v220, v25, v220
    v_mul_f32 v221, v25, v221
    v_mul_f32 v222, v25, v222
    v_mul_f32 v223, v25, v223
    v_mul_f32 v224, v25, v224
    v_mul_f32 v225, v25, v225
    v_mul_f32 v226, v25, v226
    v_mul_f32 v227, v25, v227
    v_mul_f32 v228, v25, v228
    v_mul_f32 v229, v25, v229
    v_mul_f32 v230, v25, v230
    v_mul_f32 v231, v25, v231
    v_mul_f32 v232, v25, v232
    v_mul_f32 v233, v25, v233
    v_mul_f32 v234, v25, v234
    v_mul_f32 v235, v25, v235
    v_mul_f32 v236, v25, v236
    v_mul_f32 v237, v25, v237
    v_mul_f32 v238, v25, v238
    v_mul_f32 v239, v25, v239
    v_mul_f32 v240, v25, v240
    v_mul_f32 v241, v25, v241
    v_mul_f32 v242, v25, v242
    v_mul_f32 v243, v25, v243
    v_mul_f32 v244, v25, v244
    v_mul_f32 v245, v25, v245
    v_mul_f32 v246, v25, v246
    v_mul_f32 v247, v25, v247
    v_mul_f32 v248, v25, v248
    v_mul_f32 v249, v25, v249
    v_mul_f32 v250, v25, v250
    v_mul_f32 v251, v25, v251
    v_mul_f32 v252, v25, v252
    v_mul_f32 v253, v25, v253
    v_mul_f32 v254, v25, v254
    v_mul_f32 v255, v25, v255
nors_10:
    s_add_u32 m0, s52, 7168
    s_add_u32 s23, s54, 114688
    buffer_load_dwordx4 v39, s[8:11], s23 offen lds
    ds_read_b128 v[92:95], v57
    s_waitcnt lgkmcnt(7)
    v_mfma_f32_32x32x16_bf16 v[112:127], v[64:67], a[96:99], v[112:127]
    v_fma_f32 v96, v96, s56, -v20
    v_exp_f32 v96, v96
    v_fma_f32 v97, v97, s56, -v20
    v_exp_f32 v97, v97
    v_fma_f32 v98, v98, s56, -v20
    v_exp_f32 v98, v98
    s_add_u32 m0, s53, 0
    s_add_u32 s23, s55, 0
    buffer_load_dwordx4 v40, s[12:15], s23 offen lds
    s_waitcnt lgkmcnt(6)
    v_mfma_f32_32x32x16_bf16 v[112:127], v[68:71], a[100:103], v[112:127]
    v_fma_f32 v99, v99, s56, -v20
    v_exp_f32 v99, v99
    v_fma_f32 v100, v100, s56, -v20
    v_exp_f32 v100, v100
    v_fma_f32 v101, v101, s56, -v20
    v_exp_f32 v101, v101
    s_add_u32 m0, s53, 1024
    s_add_u32 s23, s55, 32768
    buffer_load_dwordx4 v41, s[12:15], s23 offen lds
    s_waitcnt lgkmcnt(5)
    v_mfma_f32_32x32x16_bf16 v[112:127], v[72:75], a[104:107], v[112:127]
    v_fma_f32 v102, v102, s56, -v20
    v_exp_f32 v102, v102
    v_fma_f32 v103, v103, s56, -v20
    v_exp_f32 v103, v103
    v_fma_f32 v104, v104, s56, -v20
    v_exp_f32 v104, v104
    s_add_u32 m0, s53, 2048
    s_add_u32 s23, s55, 65536
    buffer_load_dwordx4 v40, s[12:15], s23 offen lds
    s_waitcnt lgkmcnt(4)
    v_mfma_f32_32x32x16_bf16 v[112:127], v[76:79], a[108:111], v[112:127]
    v_fma_f32 v105, v105, s56, -v20
    v_exp_f32 v105, v105
    v_fma_f32 v106, v106, s56, -v20
    v_exp_f32 v106, v106
    v_fma_f32 v107, v107, s56, -v20
    v_exp_f32 v107, v107
    s_add_u32 m0, s53, 3072
    s_add_u32 s23, s55, 98304
    buffer_load_dwordx4 v41, s[12:15], s23 offen lds
    s_waitcnt lgkmcnt(3)
    v_mfma_f32_32x32x16_bf16 v[112:127], v[80:83], a[112:115], v[112:127]
    v_fma_f32 v108, v108, s56, -v20
    v_exp_f32 v108, v108
    v_fma_f32 v109, v109, s56, -v20
    v_exp_f32 v109, v109
    v_fma_f32 v110, v110, s56, -v20
    v_exp_f32 v110, v110
    s_add_u32 m0, s53, 4096
    s_add_u32 s23, s55, 131072
    buffer_load_dwordx4 v40, s[12:15], s23 offen lds
    s_waitcnt lgkmcnt(2)
    v_mfma_f32_32x32x16_bf16 v[112:127], v[84:87], a[116:119], v[112:127]
    v_fma_f32 v111, v111, s56, -v20
    v_exp_f32 v111, v111
    v_add_f32 v21, v21, v96
    v_add_f32 v21, v21, v97
    v_add_f32 v21, v21, v98
    v_add_f32 v21, v21, v99
    s_add_u32 m0, s53, 5120
    s_add_u32 s23, s55, 163840
    buffer_load_dwordx4 v41, s[12:15], s23 offen lds
    s_waitcnt lgkmcnt(1)
    v_mfma_f32_32x32x16_bf16 v[112:127], v[88:91], a[120:123], v[112:127]
    v_add_f32 v21, v21, v100
    v_add_f32 v21, v21, v101
    v_add_f32 v21, v21, v102
    v_add_f32 v21, v21, v103
    v_add_f32 v21, v21, v104
    v_add_f32 v21, v21, v105
    s_add_u32 m0, s53, 6144
    s_add_u32 s23, s55, 196608
    buffer_load_dwordx4 v40, s[12:15], s23 offen lds
    s_waitcnt lgkmcnt(0)
    v_mfma_f32_32x32x16_bf16 v[112:127], v[92:95], a[124:127], v[112:127]
    v_add_f32 v21, v21, v106
    v_add_f32 v21, v21, v107
    v_add_f32 v21, v21, v108
    v_add_f32 v21, v21, v109
    v_add_f32 v21, v21, v110
    v_add_f32 v21, v21, v111
    s_add_u32 m0, s53, 7168
    s_add_u32 s23, s55, 229376
    buffer_load_dwordx4 v41, s[12:15], s23 offen lds
    v_cvt_pk_bf16_f32 v96, v96, v97
    v_cvt_pk_bf16_f32 v97, v98, v99
    v_cvt_pk_bf16_f32 v98, v100, v101
    v_cvt_pk_bf16_f32 v99, v102, v103
    v_cvt_pk_bf16_f32 v100, v104, v105
    v_cvt_pk_bf16_f32 v101, v106, v107
    v_cvt_pk_bf16_f32 v102, v108, v109
    v_cvt_pk_bf16_f32 v103, v110, v111
    ds_read_b128 v[64:67], v58 offset:0
    ds_read_b128 v[68:71], v59 offset:0
    ds_read_b128 v[72:75], v58 offset:4096
    ds_read_b128 v[76:79], v59 offset:4096
    ds_read_b128 v[80:83], v58 offset:8192
    ds_read_b128 v[84:87], v59 offset:8192
    ds_read_b128 v[88:91], v58 offset:12288
    ds_read_b128 v[92:95], v59 offset:12288
    s_waitcnt lgkmcnt(7)
    v_mfma_f32_32x32x16_bf16 v[128:143], v[64:67], v[96:99], v[128:143]
    ds_read_b128 v[64:67], v58 offset:16384
    s_waitcnt lgkmcnt(7)
    v_mfma_f32_32x32x16_bf16 v[128:143], v[68:71], v[100:103], v[128:143]
    ds_read_b128 v[68:71], v59 offset:16384
    s_waitcnt lgkmcnt(7)
    v_mfma_f32_32x32x16_bf16 v[144:159], v[72:75], v[96:99], v[144:159]
    ds_read_b128 v[72:75], v58 offset:20480
    s_waitcnt lgkmcnt(7)
    v_mfma_f32_32x32x16_bf16 v[144:159], v[76:79], v[100:103], v[144:159]
    ds_read_b128 v[76:79], v59 offset:20480
    s_waitcnt lgkmcnt(7)
    v_mfma_f32_32x32x16_bf16 v[160:175], v[80:83], v[96:99], v[160:175]
    ds_read_b128 v[80:83], v58 offset:24576
    s_waitcnt lgkmcnt(7)
    v_mfma_f32_32x32x16_bf16 v[160:175], v[84:87], v[100:103], v[160:175]
    ds_read_b128 v[84:87], v59 offset:24576
    s_waitcnt lgkmcnt(7)
    v_mfma_f32_32x32x16_bf16 v[176:191], v[88:91], v[96:99], v[176:191]
    ds_read_b128 v[88:91], v58 offset:28672
    s_waitcnt lgkmcnt(7)
    v_mfma_f32_32x32x16_bf16 v[176:191], v[92:95], v[100:103], v[176:191]
    ds_read_b128 v[92:95], v59 offset:28672
    s_waitcnt lgkmcnt(7)
    v_mfma_f32_32x32x16_bf16 v[192:207], v[64:67], v[96:99], v[192:207]
    s_waitcnt lgkmcnt(6)
    v_mfma_f32_32x32x16_bf16 v[192:207], v[68:71], v[100:103], v[192:207]
    s_waitcnt lgkmcnt(5)
    v_mfma_f32_32x32x16_bf16 v[208:223], v[72:75], v[96:99], v[208:223]
    s_waitcnt lgkmcnt(4)
    v_mfma_f32_32x32x16_bf16 v[208:223], v[76:79], v[100:103], v[208:223]
    s_waitcnt lgkmcnt(3)
    v_mfma_f32_32x32x16_bf16 v[224:239], v[80:83], v[96:99], v[224:239]
    s_waitcnt lgkmcnt(2)
    v_mfma_f32_32x32x16_bf16 v[224:239], v[84:87], v[100:103], v[224:239]
    s_waitcnt lgkmcnt(1)
    v_mfma_f32_32x32x16_bf16 v[240:255], v[88:91], v[96:99], v[240:255]
    s_waitcnt lgkmcnt(0)
    v_mfma_f32_32x32x16_bf16 v[240:255], v[92:95], v[100:103], v[240:255]
    v_xor_b32 v42, 0x8000, v42
    v_xor_b32 v43, 0x8000, v43
    v_xor_b32 v44, 0x8000, v44
    v_xor_b32 v45, 0x8000, v45
    v_xor_b32 v46, 0x8000, v46
    v_xor_b32 v47, 0x8000, v47
    v_xor_b32 v48, 0x8000, v48
    v_xor_b32 v49, 0x8000, v49
    v_xor_b32 v50, 0x8000, v50
    v_xor_b32 v51, 0x8000, v51
    v_xor_b32 v52, 0x8000, v52
    v_xor_b32 v53, 0x8000, v53
    v_xor_b32 v54, 0x8000, v54
    v_xor_b32 v55, 0x8000, v55
    v_xor_b32 v56, 0x8000, v56
    v_xor_b32 v57, 0x8000, v57
    v_xor_b32 v58, 0x8000, v58
    v_xor_b32 v59, 0x8000, v59
    s_xor_b32 s52, s52, 0x8000
    s_xor_b32 s53, s53, 0x8000
    v_mov_b32 v96, v112
    v_mov_b32 v97, v113
    v_mov_b32 v98, v114
    v_mov_b32 v99, v115
    v_mov_b32 v100, v116
    v_mov_b32 v101, v117
    v_mov_b32 v102, v118
    v_mov_b32 v103, v119
    v_mov_b32 v104, v120
    v_mov_b32 v105, v121
    v_mov_b32 v106, v122
    v_mov_b32 v107, v123
    v_mov_b32 v108, v124
    v_mov_b32 v109, v125
    v_mov_b32 v110, v126
    v_mov_b32 v111, v127
    s_nop 15
    v_mov_b32 v24, v21
    v_mov_b32 v25, v21
    s_nop 1
    v_permlane32_swap_b32 v24, v25
    v_add_f32 v21, v24, v25
    v_lshlrev_b32 v26, 4, v2
    s_lshl_b32 s30, s28, 13
    v_add_u32 v26, s30, v26
    v_add_u32 v26, 131072, v26
    v_lshlrev_b32 v27, 3, v2
    s_lshl_b32 s30, s28, 9
    v_add_u32 v27, s30, v27
    v_add_u32 v27, 147456, v27
    s_cmp_eq_u32 s29, 0
    s_cbranch_scc1 fw_11_0
    ds_write_b64 v27, v[20:21]
    ds_write_b128 v26, v[128:131] offset:0
    ds_write_b128 v26, v[132:135] offset:1024
    ds_write_b128 v26, v[136:139] offset:2048
    ds_write_b128 v26, v[140:143] offset:3072
    ds_write_b128 v26, v[144:147] offset:4096
    ds_write_b128 v26, v[148:151] offset:5120
    ds_write_b128 v26, v[152:155] offset:6144
    ds_write_b128 v26, v[156:159] offset:7168
    s_waitcnt lgkmcnt(0)
    s_barrier
    s_barrier
    s_branch fe_12_0
fw_11_0:
    s_barrier
    ds_read_b64 v[28:29], v27
    ds_read_b128 v[64:67], v26 offset:0
    ds_read_b128 v[68:71], v26 offset:1024
    ds_read_b128 v[72:75], v26 offset:2048
    ds_read_b128 v[76:79], v26 offset:3072
    ds_read_b128 v[80:83], v26 offset:4096
    ds_read_b128 v[84:87], v26 offset:5120
    ds_read_b128 v[88:91], v26 offset:6144
    ds_read_b128 v[92:95], v26 offset:7168
    s_waitcnt lgkmcnt(0)
    s_barrier
    v_max_f32 v30, v20, v28
    v_sub_f32 v24, v20, v30
    v_sub_f32 v25, v28, v30
    v_exp_f32 v24, v24
    v_exp_f32 v25, v25
    s_nop 0
    v_mul_f32 v30, v21, v24
    v_fmac_f32 v30, v29, v25
    v_rcp_f32 v30, v30
    s_nop 0
    v_mul_f32 v24, v24, v30
    v_mul_f32 v25, v25, v30
    v_mul_f32 v128, v24, v128
    v_fmac_f32 v128, v25, v64
    v_mul_f32 v129, v24, v129
    v_fmac_f32 v129, v25, v65
    v_mul_f32 v130, v24, v130
    v_fmac_f32 v130, v25, v66
    v_mul_f32 v131, v24, v131
    v_fmac_f32 v131, v25, v67
    v_mul_f32 v132, v24, v132
    v_fmac_f32 v132, v25, v68
    v_mul_f32 v133, v24, v133
    v_fmac_f32 v133, v25, v69
    v_mul_f32 v134, v24, v134
    v_fmac_f32 v134, v25, v70
    v_mul_f32 v135, v24, v135
    v_fmac_f32 v135, v25, v71
    v_mul_f32 v136, v24, v136
    v_fmac_f32 v136, v25, v72
    v_mul_f32 v137, v24, v137
    v_fmac_f32 v137, v25, v73
    v_mul_f32 v138, v24, v138
    v_fmac_f32 v138, v25, v74
    v_mul_f32 v139, v24, v139
    v_fmac_f32 v139, v25, v75
    v_mul_f32 v140, v24, v140
    v_fmac_f32 v140, v25, v76
    v_mul_f32 v141, v24, v141
    v_fmac_f32 v141, v25, v77
    v_mul_f32 v142, v24, v142
    v_fmac_f32 v142, v25, v78
    v_mul_f32 v143, v24, v143
    v_fmac_f32 v143, v25, v79
    v_mul_f32 v144, v24, v144
    v_fmac_f32 v144, v25, v80
    v_mul_f32 v145, v24, v145
    v_fmac_f32 v145, v25, v81
    v_mul_f32 v146, v24, v146
    v_fmac_f32 v146, v25, v82
    v_mul_f32 v147, v24, v147
    v_fmac_f32 v147, v25, v83
    v_mul_f32 v148, v24, v148
    v_fmac_f32 v148, v25, v84
    v_mul_f32 v149, v24, v149
    v_fmac_f32 v149, v25, v85
    v_mul_f32 v150, v24, v150
    v_fmac_f32 v150, v25, v86
    v_mul_f32 v151, v24, v151
    v_fmac_f32 v151, v25, v87
    v_mul_f32 v152, v24, v152
    v_fmac_f32 v152, v25, v88
    v_mul_f32 v153, v24, v153
    v_fmac_f32 v153, v25, v89
    v_mul_f32 v154, v24, v154
    v_fmac_f32 v154, v25, v90
    v_mul_f32 v155, v24, v155
    v_fmac_f32 v155, v25, v91
    v_mul_f32 v156, v24, v156
    v_fmac_f32 v156, v25, v92
    v_mul_f32 v157, v24, v157
    v_fmac_f32 v157, v25, v93
    v_mul_f32 v158, v24, v158
    v_fmac_f32 v158, v25, v94
    v_mul_f32 v159, v24, v159
    v_fmac_f32 v159, v25, v95
    v_cvt_pk_bf16_f32 v128, v128, v129
    v_cvt_pk_bf16_f32 v129, v130, v131
    ds_write_b64 v60, v[128:129] offset:0
    v_cvt_pk_bf16_f32 v132, v132, v133
    v_cvt_pk_bf16_f32 v133, v134, v135
    ds_write_b64 v60, v[132:133] offset:16
    v_cvt_pk_bf16_f32 v136, v136, v137
    v_cvt_pk_bf16_f32 v137, v138, v139
    ds_write_b64 v60, v[136:137] offset:32
    v_cvt_pk_bf16_f32 v140, v140, v141
    v_cvt_pk_bf16_f32 v141, v142, v143
    ds_write_b64 v60, v[140:141] offset:48
    v_cvt_pk_bf16_f32 v144, v144, v145
    v_cvt_pk_bf16_f32 v145, v146, v147
    ds_write_b64 v60, v[144:145] offset:64
    v_cvt_pk_bf16_f32 v148, v148, v149
    v_cvt_pk_bf16_f32 v149, v150, v151
    ds_write_b64 v60, v[148:149] offset:80
    v_cvt_pk_bf16_f32 v152, v152, v153
    v_cvt_pk_bf16_f32 v153, v154, v155
    ds_write_b64 v60, v[152:153] offset:96
    v_cvt_pk_bf16_f32 v156, v156, v157
    v_cvt_pk_bf16_f32 v157, v158, v159
    ds_write_b64 v60, v[156:157] offset:112
    s_waitcnt lgkmcnt(0)
    ds_read_b128 v[64:67], v61 offset:0
    ds_read_b128 v[68:71], v61 offset:1152
    ds_read_b128 v[72:75], v61 offset:2304
    ds_read_b128 v[76:79], v61 offset:3456
    s_waitcnt lgkmcnt(3)
    s_add_u32 s30, s57, 0
    buffer_store_dwordx4 v[64:67], v62, s[16:19], s30 offen offset:0
    s_waitcnt lgkmcnt(2)
    s_add_u32 s30, s57, 65536
    buffer_store_dwordx4 v[68:71], v62, s[16:19], s30 offen offset:0
    s_waitcnt lgkmcnt(1)
    s_add_u32 s30, s57, 131072
    buffer_store_dwordx4 v[72:75], v62, s[16:19], s30 offen offset:0
    s_waitcnt lgkmcnt(0)
    s_add_u32 s30, s57, 196608
    buffer_store_dwordx4 v[76:79], v62, s[16:19], s30 offen offset:0
fe_12_0:
    s_cmp_eq_u32 s29, 0
    s_cbranch_scc1 fw_11_1
    ds_write_b128 v26, v[160:163] offset:0
    ds_write_b128 v26, v[164:167] offset:1024
    ds_write_b128 v26, v[168:171] offset:2048
    ds_write_b128 v26, v[172:175] offset:3072
    ds_write_b128 v26, v[176:179] offset:4096
    ds_write_b128 v26, v[180:183] offset:5120
    ds_write_b128 v26, v[184:187] offset:6144
    ds_write_b128 v26, v[188:191] offset:7168
    s_waitcnt lgkmcnt(0)
    s_barrier
    s_barrier
    s_branch fe_12_1
fw_11_1:
    s_barrier
    ds_read_b128 v[64:67], v26 offset:0
    ds_read_b128 v[68:71], v26 offset:1024
    ds_read_b128 v[72:75], v26 offset:2048
    ds_read_b128 v[76:79], v26 offset:3072
    ds_read_b128 v[80:83], v26 offset:4096
    ds_read_b128 v[84:87], v26 offset:5120
    ds_read_b128 v[88:91], v26 offset:6144
    ds_read_b128 v[92:95], v26 offset:7168
    s_waitcnt lgkmcnt(0)
    s_barrier
    v_mul_f32 v160, v24, v160
    v_fmac_f32 v160, v25, v64
    v_mul_f32 v161, v24, v161
    v_fmac_f32 v161, v25, v65
    v_mul_f32 v162, v24, v162
    v_fmac_f32 v162, v25, v66
    v_mul_f32 v163, v24, v163
    v_fmac_f32 v163, v25, v67
    v_mul_f32 v164, v24, v164
    v_fmac_f32 v164, v25, v68
    v_mul_f32 v165, v24, v165
    v_fmac_f32 v165, v25, v69
    v_mul_f32 v166, v24, v166
    v_fmac_f32 v166, v25, v70
    v_mul_f32 v167, v24, v167
    v_fmac_f32 v167, v25, v71
    v_mul_f32 v168, v24, v168
    v_fmac_f32 v168, v25, v72
    v_mul_f32 v169, v24, v169
    v_fmac_f32 v169, v25, v73
    v_mul_f32 v170, v24, v170
    v_fmac_f32 v170, v25, v74
    v_mul_f32 v171, v24, v171
    v_fmac_f32 v171, v25, v75
    v_mul_f32 v172, v24, v172
    v_fmac_f32 v172, v25, v76
    v_mul_f32 v173, v24, v173
    v_fmac_f32 v173, v25, v77
    v_mul_f32 v174, v24, v174
    v_fmac_f32 v174, v25, v78
    v_mul_f32 v175, v24, v175
    v_fmac_f32 v175, v25, v79
    v_mul_f32 v176, v24, v176
    v_fmac_f32 v176, v25, v80
    v_mul_f32 v177, v24, v177
    v_fmac_f32 v177, v25, v81
    v_mul_f32 v178, v24, v178
    v_fmac_f32 v178, v25, v82
    v_mul_f32 v179, v24, v179
    v_fmac_f32 v179, v25, v83
    v_mul_f32 v180, v24, v180
    v_fmac_f32 v180, v25, v84
    v_mul_f32 v181, v24, v181
    v_fmac_f32 v181, v25, v85
    v_mul_f32 v182, v24, v182
    v_fmac_f32 v182, v25, v86
    v_mul_f32 v183, v24, v183
    v_fmac_f32 v183, v25, v87
    v_mul_f32 v184, v24, v184
    v_fmac_f32 v184, v25, v88
    v_mul_f32 v185, v24, v185
    v_fmac_f32 v185, v25, v89
    v_mul_f32 v186, v24, v186
    v_fmac_f32 v186, v25, v90
    v_mul_f32 v187, v24, v187
    v_fmac_f32 v187, v25, v91
    v_mul_f32 v188, v24, v188
    v_fmac_f32 v188, v25, v92
    v_mul_f32 v189, v24, v189
    v_fmac_f32 v189, v25, v93
    v_mul_f32 v190, v24, v190
    v_fmac_f32 v190, v25, v94
    v_mul_f32 v191, v24, v191
    v_fmac_f32 v191, v25, v95
    v_cvt_pk_bf16_f32 v160, v160, v161
    v_cvt_pk_bf16_f32 v161, v162, v163
    ds_write_b64 v60, v[160:161] offset:0
    v_cvt_pk_bf16_f32 v164, v164, v165
    v_cvt_pk_bf16_f32 v165, v166, v167
    ds_write_b64 v60, v[164:165] offset:16
    v_cvt_pk_bf16_f32 v168, v168, v169
    v_cvt_pk_bf16_f32 v169, v170, v171
    ds_write_b64 v60, v[168:169] offset:32
    v_cvt_pk_bf16_f32 v172, v172, v173
    v_cvt_pk_bf16_f32 v173, v174, v175
    ds_write_b64 v60, v[172:173] offset:48
    v_cvt_pk_bf16_f32 v176, v176, v177
    v_cvt_pk_bf16_f32 v177, v178, v179
    ds_write_b64 v60, v[176:177] offset:64
    v_cvt_pk_bf16_f32 v180, v180, v181
    v_cvt_pk_bf16_f32 v181, v182, v183
    ds_write_b64 v60, v[180:181] offset:80
    v_cvt_pk_bf16_f32 v184, v184, v185
    v_cvt_pk_bf16_f32 v185, v186, v187
    ds_write_b64 v60, v[184:185] offset:96
    v_cvt_pk_bf16_f32 v188, v188, v189
    v_cvt_pk_bf16_f32 v189, v190, v191
    ds_write_b64 v60, v[188:189] offset:112
    s_waitcnt lgkmcnt(0)
    ds_read_b128 v[64:67], v61 offset:0
    ds_read_b128 v[68:71], v61 offset:1152
    ds_read_b128 v[72:75], v61 offset:2304
    ds_read_b128 v[76:79], v61 offset:3456
    s_waitcnt lgkmcnt(3)
    s_add_u32 s30, s57, 0
    buffer_store_dwordx4 v[64:67], v62, s[16:19], s30 offen offset:128
    s_waitcnt lgkmcnt(2)
    s_add_u32 s30, s57, 65536
    buffer_store_dwordx4 v[68:71], v62, s[16:19], s30 offen offset:128
    s_waitcnt lgkmcnt(1)
    s_add_u32 s30, s57, 131072
    buffer_store_dwordx4 v[72:75], v62, s[16:19], s30 offen offset:128
    s_waitcnt lgkmcnt(0)
    s_add_u32 s30, s57, 196608
    buffer_store_dwordx4 v[76:79], v62, s[16:19], s30 offen offset:128
fe_12_1:
    s_cmp_eq_u32 s29, 0
    s_cbranch_scc1 fw_11_2
    ds_write_b128 v26, v[192:195] offset:0
    ds_write_b128 v26, v[196:199] offset:1024
    ds_write_b128 v26, v[200:203] offset:2048
    ds_write_b128 v26, v[204:207] offset:3072
    ds_write_b128 v26, v[208:211] offset:4096
    ds_write_b128 v26, v[212:215] offset:5120
    ds_write_b128 v26, v[216:219] offset:6144
    ds_write_b128 v26, v[220:223] offset:7168
    s_waitcnt lgkmcnt(0)
    s_barrier
    s_barrier
    s_branch fe_12_2
fw_11_2:
    s_barrier
    ds_read_b128 v[64:67], v26 offset:0
    ds_read_b128 v[68:71], v26 offset:1024
    ds_read_b128 v[72:75], v26 offset:2048
    ds_read_b128 v[76:79], v26 offset:3072
    ds_read_b128 v[80:83], v26 offset:4096
    ds_read_b128 v[84:87], v26 offset:5120
    ds_read_b128 v[88:91], v26 offset:6144
    ds_read_b128 v[92:95], v26 offset:7168
    s_waitcnt lgkmcnt(0)
    s_barrier
    v_mul_f32 v192, v24, v192
    v_fmac_f32 v192, v25, v64
    v_mul_f32 v193, v24, v193
    v_fmac_f32 v193, v25, v65
    v_mul_f32 v194, v24, v194
    v_fmac_f32 v194, v25, v66
    v_mul_f32 v195, v24, v195
    v_fmac_f32 v195, v25, v67
    v_mul_f32 v196, v24, v196
    v_fmac_f32 v196, v25, v68
    v_mul_f32 v197, v24, v197
    v_fmac_f32 v197, v25, v69
    v_mul_f32 v198, v24, v198
    v_fmac_f32 v198, v25, v70
    v_mul_f32 v199, v24, v199
    v_fmac_f32 v199, v25, v71
    v_mul_f32 v200, v24, v200
    v_fmac_f32 v200, v25, v72
    v_mul_f32 v201, v24, v201
    v_fmac_f32 v201, v25, v73
    v_mul_f32 v202, v24, v202
    v_fmac_f32 v202, v25, v74
    v_mul_f32 v203, v24, v203
    v_fmac_f32 v203, v25, v75
    v_mul_f32 v204, v24, v204
    v_fmac_f32 v204, v25, v76
    v_mul_f32 v205, v24, v205
    v_fmac_f32 v205, v25, v77
    v_mul_f32 v206, v24, v206
    v_fmac_f32 v206, v25, v78
    v_mul_f32 v207, v24, v207
    v_fmac_f32 v207, v25, v79
    v_mul_f32 v208, v24, v208
    v_fmac_f32 v208, v25, v80
    v_mul_f32 v209, v24, v209
    v_fmac_f32 v209, v25, v81
    v_mul_f32 v210, v24, v210
    v_fmac_f32 v210, v25, v82
    v_mul_f32 v211, v24, v211
    v_fmac_f32 v211, v25, v83
    v_mul_f32 v212, v24, v212
    v_fmac_f32 v212, v25, v84
    v_mul_f32 v213, v24, v213
    v_fmac_f32 v213, v25, v85
    v_mul_f32 v214, v24, v214
    v_fmac_f32 v214, v25, v86
    v_mul_f32 v215, v24, v215
    v_fmac_f32 v215, v25, v87
    v_mul_f32 v216, v24, v216
    v_fmac_f32 v216, v25, v88
    v_mul_f32 v217, v24, v217
    v_fmac_f32 v217, v25, v89
    v_mul_f32 v218, v24, v218
    v_fmac_f32 v218, v25, v90
    v_mul_f32 v219, v24, v219
    v_fmac_f32 v219, v25, v91
    v_mul_f32 v220, v24, v220
    v_fmac_f32 v220, v25, v92
    v_mul_f32 v221, v24, v221
    v_fmac_f32 v221, v25, v93
    v_mul_f32 v222, v24, v222
    v_fmac_f32 v222, v25, v94
    v_mul_f32 v223, v24, v223
    v_fmac_f32 v223, v25, v95
    v_cvt_pk_bf16_f32 v192, v192, v193
    v_cvt_pk_bf16_f32 v193, v194, v195
    ds_write_b64 v60, v[192:193] offset:0
    v_cvt_pk_bf16_f32 v196, v196, v197
    v_cvt_pk_bf16_f32 v197, v198, v199
    ds_write_b64 v60, v[196:197] offset:16
    v_cvt_pk_bf16_f32 v200, v200, v201
    v_cvt_pk_bf16_f32 v201, v202, v203
    ds_write_b64 v60, v[200:201] offset:32
    v_cvt_pk_bf16_f32 v204, v204, v205
    v_cvt_pk_bf16_f32 v205, v206, v207
    ds_write_b64 v60, v[204:205] offset:48
    v_cvt_pk_bf16_f32 v208, v208, v209
    v_cvt_pk_bf16_f32 v209, v210, v211
    ds_write_b64 v60, v[208:209] offset:64
    v_cvt_pk_bf16_f32 v212, v212, v213
    v_cvt_pk_bf16_f32 v213, v214, v215
    ds_write_b64 v60, v[212:213] offset:80
    v_cvt_pk_bf16_f32 v216, v216, v217
    v_cvt_pk_bf16_f32 v217, v218, v219
    ds_write_b64 v60, v[216:217] offset:96
    v_cvt_pk_bf16_f32 v220, v220, v221
    v_cvt_pk_bf16_f32 v221, v222, v223
    ds_write_b64 v60, v[220:221] offset:112
    s_waitcnt lgkmcnt(0)
    ds_read_b128 v[64:67], v61 offset:0
    ds_read_b128 v[68:71], v61 offset:1152
    ds_read_b128 v[72:75], v61 offset:2304
    ds_read_b128 v[76:79], v61 offset:3456
    s_waitcnt lgkmcnt(3)
    s_add_u32 s30, s57, 0
    buffer_store_dwordx4 v[64:67], v62, s[16:19], s30 offen offset:256
    s_waitcnt lgkmcnt(2)
    s_add_u32 s30, s57, 65536
    buffer_store_dwordx4 v[68:71], v62, s[16:19], s30 offen offset:256
    s_waitcnt lgkmcnt(1)
    s_add_u32 s30, s57, 131072
    buffer_store_dwordx4 v[72:75], v62, s[16:19], s30 offen offset:256
    s_waitcnt lgkmcnt(0)
    s_add_u32 s30, s57, 196608
    buffer_store_dwordx4 v[76:79], v62, s[16:19], s30 offen offset:256
fe_12_2:
    s_cmp_eq_u32 s29, 0
    s_cbranch_scc1 fw_11_3
    ds_write_b128 v26, v[224:227] offset:0
    ds_write_b128 v26, v[228:231] offset:1024
    ds_write_b128 v26, v[232:235] offset:2048
    ds_write_b128 v26, v[236:239] offset:3072
    ds_write_b128 v26, v[240:243] offset:4096
    ds_write_b128 v26, v[244:247] offset:5120
    ds_write_b128 v26, v[248:251] offset:6144
    ds_write_b128 v26, v[252:255] offset:7168
    s_waitcnt lgkmcnt(0)
    s_barrier
    s_barrier
    s_branch fe_12_3
fw_11_3:
    s_barrier
    ds_read_b128 v[64:67], v26 offset:0
    ds_read_b128 v[68:71], v26 offset:1024
    ds_read_b128 v[72:75], v26 offset:2048
    ds_read_b128 v[76:79], v26 offset:3072
    ds_read_b128 v[80:83], v26 offset:4096
    ds_read_b128 v[84:87], v26 offset:5120
    ds_read_b128 v[88:91], v26 offset:6144
    ds_read_b128 v[92:95], v26 offset:7168
    s_waitcnt lgkmcnt(0)
    s_barrier
    v_mul_f32 v224, v24, v224
    v_fmac_f32 v224, v25, v64
    v_mul_f32 v225, v24, v225
    v_fmac_f32 v225, v25, v65
    v_mul_f32 v226, v24, v226
    v_fmac_f32 v226, v25, v66
    v_mul_f32 v227, v24, v227
    v_fmac_f32 v227, v25, v67
    v_mul_f32 v228, v24, v228
    v_fmac_f32 v228, v25, v68
    v_mul_f32 v229, v24, v229
    v_fmac_f32 v229, v25, v69
    v_mul_f32 v230, v24, v230
    v_fmac_f32 v230, v25, v70
    v_mul_f32 v231, v24, v231
    v_fmac_f32 v231, v25, v71
    v_mul_f32 v232, v24, v232
    v_fmac_f32 v232, v25, v72
    v_mul_f32 v233, v24, v233
    v_fmac_f32 v233, v25, v73
    v_mul_f32 v234, v24, v234
    v_fmac_f32 v234, v25, v74
    v_mul_f32 v235, v24, v235
    v_fmac_f32 v235, v25, v75
    v_mul_f32 v236, v24, v236
    v_fmac_f32 v236, v25, v76
    v_mul_f32 v237, v24, v237
    v_fmac_f32 v237, v25, v77
    v_mul_f32 v238, v24, v238
    v_fmac_f32 v238, v25, v78
    v_mul_f32 v239, v24, v239
    v_fmac_f32 v239, v25, v79
    v_mul_f32 v240, v24, v240
    v_fmac_f32 v240, v25, v80
    v_mul_f32 v241, v24, v241
    v_fmac_f32 v241, v25, v81
    v_mul_f32 v242, v24, v242
    v_fmac_f32 v242, v25, v82
    v_mul_f32 v243, v24, v243
    v_fmac_f32 v243, v25, v83
    v_mul_f32 v244, v24, v244
    v_fmac_f32 v244, v25, v84
    v_mul_f32 v245, v24, v245
    v_fmac_f32 v245, v25, v85
    v_mul_f32 v246, v24, v246
    v_fmac_f32 v246, v25, v86
    v_mul_f32 v247, v24, v247
    v_fmac_f32 v247, v25, v87
    v_mul_f32 v248, v24, v248
    v_fmac_f32 v248, v25, v88
    v_mul_f32 v249, v24, v249
    v_fmac_f32 v249, v25, v89
    v_mul_f32 v250, v24, v250
    v_fmac_f32 v250, v25, v90
    v_mul_f32 v251, v24, v251
    v_fmac_f32 v251, v25, v91
    v_mul_f32 v252, v24, v252
    v_fmac_f32 v252, v25, v92
    v_mul_f32 v253, v24, v253
    v_fmac_f32 v253, v25, v93
    v_mul_f32 v254, v24, v254
    v_fmac_f32 v254, v25, v94
    v_mul_f32 v255, v24, v255
    v_fmac_f32 v255, v25, v95
    v_cvt_pk_bf16_f32 v224, v224, v225
    v_cvt_pk_bf16_f32 v225, v226, v227
    ds_write_b64 v60, v[224:225] offset:0
    v_cvt_pk_bf16_f32 v228, v228, v229
    v_cvt_pk_bf16_f32 v229, v230, v231
    ds_write_b64 v60, v[228:229] offset:16
    v_cvt_pk_bf16_f32 v232, v232, v233
    v_cvt_pk_bf16_f32 v233, v234, v235
    ds_write_b64 v60, v[232:233] offset:32
    v_cvt_pk_bf16_f32 v236, v236, v237
    v_cvt_pk_bf16_f32 v237, v238, v239
    ds_write_b64 v60, v[236:237] offset:48
    v_cvt_pk_bf16_f32 v240, v240, v241
    v_cvt_pk_bf16_f32 v241, v242, v243
    ds_write_b64 v60, v[240:241] offset:64
    v_cvt_pk_bf16_f32 v244, v244, v245
    v_cvt_pk_bf16_f32 v245, v246, v247
    ds_write_b64 v60, v[244:245] offset:80
    v_cvt_pk_bf16_f32 v248, v248, v249
    v_cvt_pk_bf16_f32 v249, v250, v251
    ds_write_b64 v60, v[248:249] offset:96
    v_cvt_pk_bf16_f32 v252, v252, v253
    v_cvt_pk_bf16_f32 v253, v254, v255
    ds_write_b64 v60, v[252:253] offset:112
    s_waitcnt lgkmcnt(0)
    ds_read_b128 v[64:67], v61 offset:0
    ds_read_b128 v[68:71], v61 offset:1152
    ds_read_b128 v[72:75], v61 offset:2304
    ds_read_b128 v[76:79], v61 offset:3456
    s_waitcnt lgkmcnt(3)
    s_add_u32 s30, s57, 0
    buffer_store_dwordx4 v[64:67], v62, s[16:19], s30 offen offset:384
    s_waitcnt lgkmcnt(2)
    s_add_u32 s30, s57, 65536
    buffer_store_dwordx4 v[68:71], v62, s[16:19], s30 offen offset:384
    s_waitcnt lgkmcnt(1)
    s_add_u32 s30, s57, 131072
    buffer_store_dwordx4 v[72:75], v62, s[16:19], s30 offen offset:384
    s_waitcnt lgkmcnt(0)
    s_add_u32 s30, s57, 196608
    buffer_store_dwordx4 v[76:79], v62, s[16:19], s30 offen offset:384
fe_12_3:
    s_nop 4
    v_mov_b32 v20, 0xf149f2ca
    v_mov_b32 v21, 0
    v_mov_b32 v128, 0
    v_mov_b32 v129, 0
    v_mov_b32 v130, 0
    v_mov_b32 v131, 0
    v_mov_b32 v132, 0
    v_mov_b32 v133, 0
    v_mov_b32 v134, 0
    v_mov_b32 v135, 0
    v_mov_b32 v136, 0
    v_mov_b32 v137, 0
    v_mov_b32 v138, 0
    v_mov_b32 v139, 0
    v_mov_b32 v140, 0
    v_mov_b32 v141, 0
    v_mov_b32 v142, 0
    v_mov_b32 v143, 0
    v_mov_b32 v144, 0
    v_mov_b32 v145, 0
    v_mov_b32 v146, 0
    v_mov_b32 v147, 0
    v_mov_b32 v148, 0
    v_mov_b32 v149, 0
    v_mov_b32 v150, 0
    v_mov_b32 v151, 0
    v_mov_b32 v152, 0
    v_mov_b32 v153, 0
    v_mov_b32 v154, 0
    v_mov_b32 v155, 0
    v_mov_b32 v156, 0
    v_mov_b32 v157, 0
    v_mov_b32 v158, 0
    v_mov_b32 v159, 0
    v_mov_b32 v160, 0
    v_mov_b32 v161, 0
    v_mov_b32 v162, 0
    v_mov_b32 v163, 0
    v_mov_b32 v164, 0
    v_mov_b32 v165, 0
    v_mov_b32 v166, 0
    v_mov_b32 v167, 0
    v_mov_b32 v168, 0
    v_mov_b32 v169, 0
    v_mov_b32 v170, 0
    v_mov_b32 v171, 0
    v_mov_b32 v172, 0
    v_mov_b32 v173, 0
    v_mov_b32 v174, 0
    v_mov_b32 v175, 0
    v_mov_b32 v176, 0
    v_mov_b32 v177, 0
    v_mov_b32 v178, 0
    v_mov_b32 v179, 0
    v_mov_b32 v180, 0
    v_mov_b32 v181, 0
    v_mov_b32 v182, 0
    v_mov_b32 v183, 0
    v_mov_b32 v184, 0
    v_mov_b32 v185, 0
    v_mov_b32 v186, 0
    v_mov_b32 v187, 0
    v_mov_b32 v188, 0
    v_mov_b32 v189, 0
    v_mov_b32 v190, 0
    v_mov_b32 v191, 0
    v_mov_b32 v192, 0
    v_mov_b32 v193, 0
    v_mov_b32 v194, 0
    v_mov_b32 v195, 0
    v_mov_b32 v196, 0
    v_mov_b32 v197, 0
    v_mov_b32 v198, 0
    v_mov_b32 v199, 0
    v_mov_b32 v200, 0
    v_mov_b32 v201, 0
    v_mov_b32 v202, 0
    v_mov_b32 v203, 0
    v_mov_b32 v204, 0
    v_mov_b32 v205, 0
    v_mov_b32 v206, 0
    v_mov_b32 v207, 0
    v_mov_b32 v208, 0
    v_mov_b32 v209, 0
    v_mov_b32 v210, 0
    v_mov_b32 v211, 0
    v_mov_b32 v212, 0
    v_mov_b32 v213, 0
    v_mov_b32 v214, 0
    v_mov_b32 v215, 0
    v_mov_b32 v216, 0
    v_mov_b32 v217, 0
    v_mov_b32 v218, 0
    v_mov_b32 v219, 0
    v_mov_b32 v220, 0
    v_mov_b32 v221, 0
    v_mov_b32 v222, 0
    v_mov_b32 v223, 0
    v_mov_b32 v224, 0
    v_mov_b32 v225, 0
    v_mov_b32 v226, 0
    v_mov_b32 v227, 0
    v_mov_b32 v228, 0
    v_mov_b32 v229, 0
    v_mov_b32 v230, 0
    v_mov_b32 v231, 0
    v_mov_b32 v232, 0
    v_mov_b32 v233, 0
    v_mov_b32 v234, 0
    v_mov_b32 v235, 0
    v_mov_b32 v236, 0
    v_mov_b32 v237, 0
    v_mov_b32 v238, 0
    v_mov_b32 v239, 0
    v_mov_b32 v240, 0
    v_mov_b32 v241, 0
    v_mov_b32 v242, 0
    v_mov_b32 v243, 0
    v_mov_b32 v244, 0
    v_mov_b32 v245, 0
    v_mov_b32 v246, 0
    v_mov_b32 v247, 0
    v_mov_b32 v248, 0
    v_mov_b32 v249, 0
    v_mov_b32 v250, 0
    v_mov_b32 v251, 0
    v_mov_b32 v252, 0
    v_mov_b32 v253, 0
    v_mov_b32 v254, 0
    v_mov_b32 v255, 0
    s_mov_b32 s59, 1
k3_lb:
    s_cmp_ge_u32 s59, s47
    s_cbranch_scc1 k3_lb_end
    s_waitcnt vmcnt(0)
    s_barrier
    s_add_u32 s48, s48, 1
    s_min_u32 s48, s48, 32
    s_sub_u32 s50, s48, s46
    s_cmp_lt_u32 s48, s46
    s_cselect_b32 s50, s48, s50
    s_add_u32 s49, s49, 1
    s_min_u32 s49, s49, 32
    s_sub_u32 s51, s49, s46
    s_cmp_lt_u32 s49, s46
    s_cselect_b32 s51, s49, s51
    s_lshl_b32 s54, s50, 19
    s_lshl_b32 s55, s51, 7
    ds_read_b128 v[64:67], v42
    ds_read_b128 v[68:71], v43
    ds_read_b128 v[72:75], v44
    ds_read_b128 v[76:79], v45
    ds_read_b128 v[80:83], v46
    ds_read_b128 v[84:87], v47
    ds_read_b128 v[88:91], v48
    ds_read_b128 v[92:95], v49
    s_waitcnt lgkmcnt(7)
    v_mfma_f32_32x32x16_bf16 v[112:127], v[64:67], a[64:67], 0
    v_max3_f32 v24, v96, v97, v98
    v_max3_f32 v25, v99, v100, v101
    v_max3_f32 v26, v102, v103, v104
    v_max3_f32 v27, v105, v106, v107
    v_max3_f32 v24, v24, v108, v109
    v_max3_f32 v25, v25, v110, v111
    s_add_u32 m0, s52, 0
    s_add_u32 s23, s54, 0
    buffer_load_dwordx4 v32, s[8:11], s23 offen lds
    ds_read_b128 v[64:67], v50
    s_waitcnt lgkmcnt(7)
    v_mfma_f32_32x32x16_bf16 v[112:127], v[68:71], a[68:71], v[112:127]
    v_max3_f32 v24, v24, v25, v26
    v_max_f32 v24, v24, v27
    v_mov_b32 v25, v24
    s_nop 1
    v_permlane32_swap_b32 v24, v25
    v_max_f32 v24, v24, v25
    s_add_u32 m0, s52, 1024
    s_add_u32 s23, s54, 16384
    buffer_load_dwordx4 v33, s[8:11], s23 offen lds
    ds_read_b128 v[68:71], v51
    s_waitcnt lgkmcnt(7)
    v_mfma_f32_32x32x16_bf16 v[112:127], v[72:75], a[72:75], v[112:127]
    v_mul_f32 v24, s56, v24
    v_add_f32 v25, 0x41000000, v20
    v_cmp_gt_f32 vcc, v24, v25
    s_cbranch_vccz nors_13
    v_max_f32 v24, v24, v20
    v_sub_f32 v25, v20, v24
    v_exp_f32 v25, v25
    v_mov_b32 v20, v24
    v_mul_f32 v21, v21, v25
    v_mul_f32 v128, v25, v128
    v_mul_f32 v129, v25, v129
    v_mul_f32 v130, v25, v130
    v_mul_f32 v131, v25, v131
    v_mul_f32 v132, v25, v132
    v_mul_f32 v133, v25, v133
    v_mul_f32 v134, v25, v134
    v_mul_f32 v135, v25, v135
    v_mul_f32 v136, v25, v136
    v_mul_f32 v137, v25, v137
    v_mul_f32 v138, v25, v138
    v_mul_f32 v139, v25, v139
    v_mul_f32 v140, v25, v140
    v_mul_f32 v141, v25, v141
    v_mul_f32 v142, v25, v142
    v_mul_f32 v143, v25, v143
    v_mul_f32 v144, v25, v144
    v_mul_f32 v145, v25, v145
    v_mul_f32 v146, v25, v146
    v_mul_f32 v147, v25, v147
    v_mul_f32 v148, v25, v148
    v_mul_f32 v149, v25, v149
    v_mul_f32 v150, v25, v150
    v_mul_f32 v151, v25, v151
    v_mul_f32 v152, v25, v152
    v_mul_f32 v153, v25, v153
    v_mul_f32 v154, v25, v154
    v_mul_f32 v155, v25, v155
    v_mul_f32 v156, v25, v156
    v_mul_f32 v157, v25, v157
    v_mul_f32 v158, v25, v158
    v_mul_f32 v159, v25, v159
    v_mul_f32 v160, v25, v160
    v_mul_f32 v161, v25, v161
    v_mul_f32 v162, v25, v162
    v_mul_f32 v163, v25, v163
    v_mul_f32 v164, v25, v164
    v_mul_f32 v165, v25, v165
    v_mul_f32 v166, v25, v166
    v_mul_f32 v167, v25, v167
    v_mul_f32 v168, v25, v168
    v_mul_f32 v169, v25, v169
    v_mul_f32 v170, v25, v170
    v_mul_f32 v171, v25, v171
    v_mul_f32 v172, v25, v172
    v_mul_f32 v173, v25, v173
    v_mul_f32 v174, v25, v174
    v_mul_f32 v175, v25, v175
    v_mul_f32 v176, v25, v176
    v_mul_f32 v177, v25, v177
    v_mul_f32 v178, v25, v178
    v_mul_f32 v179, v25, v179
    v_mul_f32 v180, v25, v180
    v_mul_f32 v181, v25, v181
    v_mul_f32 v182, v25, v182
    v_mul_f32 v183, v25, v183
    v_mul_f32 v184, v25, v184
    v_mul_f32 v185, v25, v185
    v_mul_f32 v186, v25, v186
    v_mul_f32 v187, v25, v187
    v_mul_f32 v188, v25, v188
    v_mul_f32 v189, v25, v189
    v_mul_f32 v190, v25, v190
    v_mul_f32 v191, v25, v191
    v_mul_f32 v192, v25, v192
    v_mul_f32 v193, v25, v193
    v_mul_f32 v194, v25, v194
    v_mul_f32 v195, v25, v195
    v_mul_f32 v196, v25, v196
    v_mul_f32 v197, v25, v197
    v_mul_f32 v198, v25, v198
    v_mul_f32 v199, v25, v199
    v_mul_f32 v200, v25, v200
    v_mul_f32 v201, v25, v201
    v_mul_f32 v202, v25, v202
    v_mul_f32 v203, v25, v203
    v_mul_f32 v204, v25, v204
    v_mul_f32 v205, v25, v205
    v_mul_f32 v206, v25, v206
    v_mul_f32 v207, v25, v207
    v_mul_f32 v208, v25, v208
    v_mul_f32 v209, v25, v209
    v_mul_f32 v210, v25, v210
    v_mul_f32 v211, v25, v211
    v_mul_f32 v212, v25, v212
    v_mul_f32 v213, v25, v213
    v_mul_f32 v214, v25, v214
    v_mul_f32 v215, v25, v215
    v_mul_f32 v216, v25, v216
    v_mul_f32 v217, v25, v217
    v_mul_f32 v218, v25, v218
    v_mul_f32 v219, v25, v219
    v_mul_f32 v220, v25, v220
    v_mul_f32 v221, v25, v221
    v_mul_f32 v222, v25, v222
    v_mul_f32 v223, v25, v223
    v_mul_f32 v224, v25, v224
    v_mul_f32 v225, v25, v225
    v_mul_f32 v226, v25, v226
    v_mul_f32 v227, v25, v227
    v_mul_f32 v228, v25, v228
    v_mul_f32 v229, v25, v229
    v_mul_f32 v230, v25, v230
    v_mul_f32 v231, v25, v231
    v_mul_f32 v232, v25, v232
    v_mul_f32 v233, v25, v233
    v_mul_f32 v234, v25, v234
    v_mul_f32 v235, v25, v235
    v_mul_f32 v236, v25, v236
    v_mul_f32 v237, v25, v237
    v_mul_f32 v238, v25, v238
    v_mul_f32 v239, v25, v239
    v_mul_f32 v240, v25, v240
    v_mul_f32 v241, v25, v241
    v_mul_f32 v242, v25, v242
    v_mul_f32 v243, v25, v243
    v_mul_f32 v244, v25, v244
    v_mul_f32 v245, v25, v245
    v_mul_f32 v246, v25, v246
    v_mul_f32 v247, v25, v247
    v_mul_f32 v248, v25, v248
    v_mul_f32 v249, v25, v249
    v_mul_f32 v250, v25, v250
    v_mul_f32 v251, v25, v251
    v_mul_f32 v252, v25, v252
    v_mul_f32 v253, v25, v253
    v_mul_f32 v254, v25, v254
    v_mul_f32 v255, v25, v255
nors_13:
    v_fma_f32 v96, v96, s56, -v20
    v_exp_f32 v96, v96
    s_add_u32 m0, s52, 2048
    s_add_u32 s23, s54, 32768
    buffer_load_dwordx4 v34, s[8:11], s23 offen lds
    ds_read_b128 v[72:75], v52
    s_waitcnt lgkmcnt(7)
    v_mfma_f32_32x32x16_bf16 v[112:127], v[76:79], a[76:79], v[112:127]
    v_fma_f32 v97, v97, s56, -v20
    v_exp_f32 v97, v97
    v_fma_f32 v98, v98, s56, -v20
    v_exp_f32 v98, v98
    v_fma_f32 v99, v99, s56, -v20
    v_exp_f32 v99, v99
    s_add_u32 m0, s52, 3072
    s_add_u32 s23, s54, 49152
    buffer_load_dwordx4 v35, s[8:11], s23 offen lds
    ds_read_b128 v[76:79], v53
    s_waitcnt lgkmcnt(7)
    v_mfma_f32_32x32x16_bf16 v[112:127], v[80:83], a[80:83], v[112:127]
    v_fma_f32 v100, v100, s56, -v20
    v_exp_f32 v100, v100
    v_fma_f32 v101, v101, s56, -v20
    v_exp_f32 v101, v101
    v_fma_f32 v102, v102, s56, -v20
    v_exp_f32 v102, v102
    s_add_u32 m0, s52, 4096
    s_add_u32 s23, s54, 65536
    buffer_load_dwordx4 v36, s[8:11], s23 offen lds
    ds_read_b128 v[80:83], v54
    s_waitcnt lgkmcnt(7)
    v_mfma_f32_32x32x16_bf16 v[112:127], v[84:87], a[84:87], v[112:127]
    v_fma_f32 v103, v103, s56, -v20
    v_exp_f32 v103, v103
    v_fma_f32 v104, v104, s56, -v20
    v_exp_f32 v104, v104
    v_fma_f32 v105, v105, s56, -v20
    v_exp_f32 v105, v105
    s_add_u32 m0, s52, 5120
    s_add_u32 s23, s54, 81920
    buffer_load_dwordx4 v37, s[8:11], s23 offen lds
    ds_read_b128 v[84:87], v55
    s_waitcnt lgkmcnt(7)
    v_mfma_f32_32x32x16_bf16 v[112:127], v[88:91], a[88:91], v[112:127]
    v_fma_f32 v106, v106, s56, -v20
    v_exp_f32 v106, v106
    v_fma_f32 v107, v107, s56, -v20
    v_exp_f32 v107, v107
    v_fma_f32 v108, v108, s56, -v20
    v_exp_f32 v108, v108
    s_add_u32 m0, s52, 6144
    s_add_u32 s23, s54, 98304
    buffer_load_dwordx4 v38, s[8:11], s23 offen lds
    ds_read_b128 v[88:91], v56
    s_waitcnt lgkmcnt(7)
    v_mfma_f32_32x32x16_bf16 v[112:127], v[92:95], a[92:95], v[112:127]
    v_fma_f32 v109, v109, s56, -v20
    v_exp_f32 v109, v109
    v_fma_f32 v110, v110, s56, -v20
    v_exp_f32 v110, v110
    v_fma_f32 v111, v111, s56, -v20
    v_exp_f32 v111, v111
    s_add_u32 m0, s52, 7168
    s_add_u32 s23, s54, 114688
    buffer_load_dwordx4 v39, s[8:11], s23 offen lds
    ds_read_b128 v[92:95], v57
    s_waitcnt lgkmcnt(7)
    v_mfma_f32_32x32x16_bf16 v[112:127], v[64:67], a[96:99], v[112:127]
    v_add_f32 v21, v21, v96
    v_add_f32 v21, v21, v97
    v_add_f32 v21, v21, v98
    v_add_f32 v21, v21, v99
    v_add_f32 v21, v21, v100
    v_add_f32 v21, v21, v101
    s_add_u32 m0, s53, 0
    s_add_u32 s23, s55, 0
    buffer_load_dwordx4 v40, s[12:15], s23 offen lds
    s_waitcnt lgkmcnt(6)
    v_mfma_f32_32x32x16_bf16 v[112:127], v[68:71], a[100:103], v[112:127]
    v_add_f32 v21, v21, v102
    v_add_f32 v21, v21, v103
    v_add_f32 v21, v21, v104
    v_add_f32 v21, v21, v105
    v_add_f32 v21, v21, v106
    v_add_f32 v21, v21, v107
    s_add_u32 m0, s53, 1024
    s_add_u32 s23, s55, 32768
    buffer_load_dwordx4 v41, s[12:15], s23 offen lds
    s_waitcnt lgkmcnt(5)
    v_mfma_f32_32x32x16_bf16 v[112:127], v[72:75], a[104:107], v[112:127]
    v_add_f32 v21, v21, v108
    v_add_f32 v21, v21, v109
    v_add_f32 v21, v21, v110
    v_add_f32 v21, v21, v111
    v_cvt_pk_bf16_f32 v96, v96, v97
    v_cvt_pk_bf16_f32 v97, v98, v99
    s_add_u32 m0, s53, 2048
    s_add_u32 s23, s55, 65536
    buffer_load_dwordx4 v40, s[12:15], s23 offen lds
    s_waitcnt lgkmcnt(4)
    v_mfma_f32_32x32x16_bf16 v[112:127], v[76:79], a[108:111], v[112:127]
    v_cvt_pk_bf16_f32 v98, v100, v101
    v_cvt_pk_bf16_f32 v99, v102, v103
    v_cvt_pk_bf16_f32 v100, v104, v105
    v_cvt_pk_bf16_f32 v101, v106, v107
    v_cvt_pk_bf16_f32 v102, v108, v109
    v_cvt_pk_bf16_f32 v103, v110, v111
    s_add_u32 m0, s53, 3072
    s_add_u32 s23, s55, 98304
    buffer_load_dwordx4 v41, s[12:15], s23 offen lds
    s_waitcnt lgkmcnt(3)
    v_mfma_f32_32x32x16_bf16 v[112:127], v[80:83], a[112:115], v[112:127]
    s_add_u32 m0, s53, 4096
    s_add_u32 s23, s55, 131072
    buffer_load_dwordx4 v40, s[12:15], s23 offen lds
    s_waitcnt lgkmcnt(2)
    v_mfma_f32_32x32x16_bf16 v[112:127], v[84:87], a[116:119], v[112:127]
    s_add_u32 m0, s53, 5120
    s_add_u32 s23, s55, 163840
    buffer_load_dwordx4 v41, s[12:15], s23 offen lds
    s_waitcnt lgkmcnt(1)
    v_mfma_f32_32x32x16_bf16 v[112:127], v[88:91], a[120:123], v[112:127]
    s_add_u32 m0, s53, 6144
    s_add_u32 s23, s55, 196608
    buffer_load_dwordx4 v40, s[12:15], s23 offen lds
    s_waitcnt lgkmcnt(0)
    v_mfma_f32_32x32x16_bf16 v[112:127], v[92:95], a[124:127], v[112:127]
    s_add_u32 m0, s53, 7168
    s_add_u32 s23, s55, 229376
    buffer_load_dwordx4 v41, s[12:15], s23 offen lds
    ds_read_b128 v[64:67], v58 offset:0
    ds_read_b128 v[68:71], v59 offset:0
    ds_read_b128 v[72:75], v58 offset:4096
    ds_read_b128 v[76:79], v59 offset:4096
    ds_read_b128 v[80:83], v58 offset:8192
    ds_read_b128 v[84:87], v59 offset:8192
    ds_read_b128 v[88:91], v58 offset:12288
    ds_read_b128 v[92:95], v59 offset:12288
    s_waitcnt lgkmcnt(7)
    v_mfma_f32_32x32x16_bf16 v[128:143], v[64:67], v[96:99], v[128:143]
    ds_read_b128 v[64:67], v58 offset:16384
    s_waitcnt lgkmcnt(7)
    v_mfma_f32_32x32x16_bf16 v[128:143], v[68:71], v[100:103], v[128:143]
    ds_read_b128 v[68:71], v59 offset:16384
    s_waitcnt lgkmcnt(7)
    v_mfma_f32_32x32x16_bf16 v[144:159], v[72:75], v[96:99], v[144:159]
    ds_read_b128 v[72:75], v58 offset:20480
    s_waitcnt lgkmcnt(7)
    v_mfma_f32_32x32x16_bf16 v[144:159], v[76:79], v[100:103], v[144:159]
    ds_read_b128 v[76:79], v59 offset:20480
    s_waitcnt lgkmcnt(7)
    v_mfma_f32_32x32x16_bf16 v[160:175], v[80:83], v[96:99], v[160:175]
    ds_read_b128 v[80:83], v58 offset:24576
    s_waitcnt lgkmcnt(7)
    v_mfma_f32_32x32x16_bf16 v[160:175], v[84:87], v[100:103], v[160:175]
    ds_read_b128 v[84:87], v59 offset:24576
    s_waitcnt lgkmcnt(7)
    v_mfma_f32_32x32x16_bf16 v[176:191], v[88:91], v[96:99], v[176:191]
    ds_read_b128 v[88:91], v58 offset:28672
    s_waitcnt lgkmcnt(7)
    v_mfma_f32_32x32x16_bf16 v[176:191], v[92:95], v[100:103], v[176:191]
    ds_read_b128 v[92:95], v59 offset:28672
    s_waitcnt lgkmcnt(7)
    v_mfma_f32_32x32x16_bf16 v[192:207], v[64:67], v[96:99], v[192:207]
    s_waitcnt lgkmcnt(6)
    v_mfma_f32_32x32x16_bf16 v[192:207], v[68:71], v[100:103], v[192:207]
    s_waitcnt lgkmcnt(5)
    v_mfma_f32_32x32x16_bf16 v[208:223], v[72:75], v[96:99], v[208:223]
    s_waitcnt lgkmcnt(4)
    v_mfma_f32_32x32x16_bf16 v[208:223], v[76:79], v[100:103], v[208:223]
    s_waitcnt lgkmcnt(3)
    v_mfma_f32_32x32x16_bf16 v[224:239], v[80:83], v[96:99], v[224:239]
    s_waitcnt lgkmcnt(2)
    v_mfma_f32_32x32x16_bf16 v[224:239], v[84:87], v[100:103], v[224:239]
    s_waitcnt lgkmcnt(1)
    v_mfma_f32_32x32x16_bf16 v[240:255], v[88:91], v[96:99], v[240:255]
    s_waitcnt lgkmcnt(0)
    v_mfma_f32_32x32x16_bf16 v[240:255], v[92:95], v[100:103], v[240:255]
    v_xor_b32 v42, 0x8000, v42
    v_xor_b32 v43, 0x8000, v43
    v_xor_b32 v44, 0x8000, v44
    v_xor_b32 v45, 0x8000, v45
    v_xor_b32 v46, 0x8000, v46
    v_xor_b32 v47, 0x8000, v47
    v_xor_b32 v48, 0x8000, v48
    v_xor_b32 v49, 0x8000, v49
    v_xor_b32 v50, 0x8000, v50
    v_xor_b32 v51, 0x8000, v51
    v_xor_b32 v52, 0x8000, v52
    v_xor_b32 v53, 0x8000, v53
    v_xor_b32 v54, 0x8000, v54
    v_xor_b32 v55, 0x8000, v55
    v_xor_b32 v56, 0x8000, v56
    v_xor_b32 v57, 0x8000, v57
    v_xor_b32 v58, 0x8000, v58
    v_xor_b32 v59, 0x8000, v59
    s_xor_b32 s52, s52, 0x8000
    s_xor_b32 s53, s53, 0x8000
    v_mov_b32 v96, v112
    v_mov_b32 v97, v113
    v_mov_b32 v98, v114
    v_mov_b32 v99, v115
    v_mov_b32 v100, v116
    v_mov_b32 v101, v117
    v_mov_b32 v102, v118
    v_mov_b32 v103, v119
    v_mov_b32 v104, v120
    v_mov_b32 v105, v121
    v_mov_b32 v106, v122
    v_mov_b32 v107, v123
    v_mov_b32 v108, v124
    v_mov_b32 v109, v125
    v_mov_b32 v110, v126
    v_mov_b32 v111, v127
    s_add_u32 s59, s59, 1
    s_branch k3_lb
k3_lb_end:
    s_waitcnt vmcnt(0)
    s_barrier
    s_add_u32 s48, s48, 1
    s_min_u32 s48, s48, 32
    s_sub_u32 s50, s48, s46
    s_cmp_lt_u32 s48, s46
    s_cselect_b32 s50, s48, s50
    s_add_u32 s49, s49, 1
    s_min_u32 s49, s49, 32
    s_sub_u32 s51, s49, s46
    s_cmp_lt_u32 s49, s46
    s_cselect_b32 s51, s49, s51
    s_lshl_b32 s54, s50, 19
    s_lshl_b32 s55, s51, 7
    v_cmp_le_i32 vcc, 0, v22
    v_cndmask_b32 v96, v23, v96, vcc
    v_cmp_le_i32 vcc, 1, v22
    v_cndmask_b32 v97, v23, v97, vcc
    v_cmp_le_i32 vcc, 2, v22
    v_cndmask_b32 v98, v23, v98, vcc
    v_cmp_le_i32 vcc, 3, v22
    v_cndmask_b32 v99, v23, v99, vcc
    v_cmp_le_i32 vcc, 8, v22
    v_cndmask_b32 v100, v23, v100, vcc
    v_cmp_le_i32 vcc, 9, v22
    v_cndmask_b32 v101, v23, v101, vcc
    v_cmp_le_i32 vcc, 10, v22
    v_cndmask_b32 v102, v23, v102, vcc
    v_cmp_le_i32 vcc, 11, v22
    v_cndmask_b32 v103, v23, v103, vcc
    v_cmp_le_i32 vcc, 16, v22
    v_cndmask_b32 v104, v23, v104, vcc
    v_cmp_le_i32 vcc, 17, v22
    v_cndmask_b32 v105, v23, v105, vcc
    v_cmp_le_i32 vcc, 18, v22
    v_cndmask_b32 v106, v23, v106, vcc
    v_cmp_le_i32 vcc, 19, v22
    v_cndmask_b32 v107, v23, v107, vcc
    v_cmp_le_i32 vcc, 24, v22
    v_cndmask_b32 v108, v23, v108, vcc
    v_cmp_le_i32 vcc, 25, v22
    v_cndmask_b32 v109, v23, v109, vcc
    v_cmp_le_i32 vcc, 26, v22
    v_cndmask_b32 v110, v23, v110, vcc
    v_cmp_le_i32 vcc, 27, v22
    v_cndmask_b32 v111, v23, v111, vcc
    v_max3_f32 v24, v96, v97, v98
    v_max3_f32 v25, v99, v100, v101
    v_max3_f32 v26, v102, v103, v104
    v_max3_f32 v27, v105, v106, v107
    v_max3_f32 v24, v24, v108, v109
    v_max3_f32 v25, v25, v110, v111
    v_max3_f32 v24, v24, v25, v26
    v_max_f32 v24, v24, v27
    v_mov_b32 v25, v24
    s_nop 1
    v_permlane32_swap_b32 v24, v25
    v_max_f32 v24, v24, v25
    v_mul_f32 v24, s56, v24
    v_add_f32 v25, 0x41000000, v20
    v_cmp_gt_f32 vcc, v24, v25
    s_cbranch_vccz nors_14
    v_max_f32 v24, v24, v20
    v_sub_f32 v25, v20, v24
    v_exp_f32 v25, v25
    v_mov_b32 v20, v24
    v_mul_f32 v21, v21, v25
    v_mul_f32 v128, v25, v128
    v_mul_f32 v129, v25, v129
    v_mul_f32 v130, v25, v130
    v_mul_f32 v131, v25, v131
    v_mul_f32 v132, v25, v132
    v_mul_f32 v133, v25, v133
    v_mul_f32 v134, v25, v134
    v_mul_f32 v135, v25, v135
    v_mul_f32 v136, v25, v136
    v_mul_f32 v137, v25, v137
    v_mul_f32 v138, v25, v138
    v_mul_f32 v139, v25, v139
    v_mul_f32 v140, v25, v140
    v_mul_f32 v141, v25, v141
    v_mul_f32 v142, v25, v142
    v_mul_f32 v143, v25, v143
    v_mul_f32 v144, v25, v144
    v_mul_f32 v145, v25, v145
    v_mul_f32 v146, v25, v146
    v_mul_f32 v147, v25, v147
    v_mul_f32 v148, v25, v148
    v_mul_f32 v149, v25, v149
    v_mul_f32 v150, v25, v150
    v_mul_f32 v151, v25, v151
    v_mul_f32 v152, v25, v152
    v_mul_f32 v153, v25, v153
    v_mul_f32 v154, v25, v154
    v_mul_f32 v155, v25, v155
    v_mul_f32 v156, v25, v156
    v_mul_f32 v157, v25, v157
    v_mul_f32 v158, v25, v158
    v_mul_f32 v159, v25, v159
    v_mul_f32 v160, v25, v160
    v_mul_f32 v161, v25, v161
    v_mul_f32 v162, v25, v162
    v_mul_f32 v163, v25, v163
    v_mul_f32 v164, v25, v164
    v_mul_f32 v165, v25, v165
    v_mul_f32 v166, v25, v166
    v_mul_f32 v167, v25, v167
    v_mul_f32 v168, v25, v168
    v_mul_f32 v169, v25, v169
    v_mul_f32 v170, v25, v170
    v_mul_f32 v171, v25, v171
    v_mul_f32 v172, v25, v172
    v_mul_f32 v173, v25, v173
    v_mul_f32 v174, v25, v174
    v_mul_f32 v175, v25, v175
    v_mul_f32 v176, v25, v176
    v_mul_f32 v177, v25, v177
    v_mul_f32 v178, v25, v178
    v_mul_f32 v179, v25, v179
    v_mul_f32 v180, v25, v180
    v_mul_f32 v181, v25, v181
    v_mul_f32 v182, v25, v182
    v_mul_f32 v183, v25, v183
    v_mul_f32 v184, v25, v184
    v_mul_f32 v185, v25, v185
    v_mul_f32 v186, v25, v186
    v_mul_f32 v187, v25, v187
    v_mul_f32 v188, v25, v188
    v_mul_f32 v189, v25, v189
    v_mul_f32 v190, v25, v190
    v_mul_f32 v191, v25, v191
    v_mul_f32 v192, v25, v192
    v_mul_f32 v193, v25, v193
    v_mul_f32 v194, v25, v194
    v_mul_f32 v195, v25, v195
    v_mul_f32 v196, v25, v196
    v_mul_f32 v197, v25, v197
    v_mul_f32 v198, v25, v198
    v_mul_f32 v199, v25, v199
    v_mul_f32 v200, v25, v200
    v_mul_f32 v201, v25, v201
    v_mul_f32 v202, v25, v202
    v_mul_f32 v203, v25, v203
    v_mul_f32 v204, v25, v204
    v_mul_f32 v205, v25, v205
    v_mul_f32 v206, v25, v206
    v_mul_f32 v207, v25, v207
    v_mul_f32 v208, v25, v208
    v_mul_f32 v209, v25, v209
    v_mul_f32 v210, v25, v210
    v_mul_f32 v211, v25, v211
    v_mul_f32 v212, v25, v212
    v_mul_f32 v213, v25, v213
    v_mul_f32 v214, v25, v214
    v_mul_f32 v215, v25, v215
    v_mul_f32 v216, v25, v216
    v_mul_f32 v217, v25, v217
    v_mul_f32 v218, v25, v218
    v_mul_f32 v219, v25, v219
    v_mul_f32 v220, v25, v220
    v_mul_f32 v221, v25, v221
    v_mul_f32 v222, v25, v222
    v_mul_f32 v223, v25, v223
    v_mul_f32 v224, v25, v224
    v_mul_f32 v225, v25, v225
    v_mul_f32 v226, v25, v226
    v_mul_f32 v227, v25, v227
    v_mul_f32 v228, v25, v228
    v_mul_f32 v229, v25, v229
    v_mul_f32 v230, v25, v230
    v_mul_f32 v231, v25, v231
    v_mul_f32 v232, v25, v232
    v_mul_f32 v233, v25, v233
    v_mul_f32 v234, v25, v234
    v_mul_f32 v235, v25, v235
    v_mul_f32 v236, v25, v236
    v_mul_f32 v237, v25, v237
    v_mul_f32 v238, v25, v238
    v_mul_f32 v239, v25, v239
    v_mul_f32 v240, v25, v240
    v_mul_f32 v241, v25, v241
    v_mul_f32 v242, v25, v242
    v_mul_f32 v243, v25, v243
    v_mul_f32 v244, v25, v244
    v_mul_f32 v245, v25, v245
    v_mul_f32 v246, v25, v246
    v_mul_f32 v247, v25, v247
    v_mul_f32 v248, v25, v248
    v_mul_f32 v249, v25, v249
    v_mul_f32 v250, v25, v250
    v_mul_f32 v251, v25, v251
    v_mul_f32 v252, v25, v252
    v_mul_f32 v253, v25, v253
    v_mul_f32 v254, v25, v254
    v_mul_f32 v255, v25, v255
nors_14:
    v_fma_f32 v96, v96, s56, -v20
    v_exp_f32 v96, v96
    v_fma_f32 v97, v97, s56, -v20
    v_exp_f32 v97, v97
    v_fma_f32 v98, v98, s56, -v20
    v_exp_f32 v98, v98
    v_fma_f32 v99, v99, s56, -v20
    v_exp_f32 v99, v99
    v_fma_f32 v100, v100, s56, -v20
    v_exp_f32 v100, v100
    v_fma_f32 v101, v101, s56, -v20
    v_exp_f32 v101, v101
    v_fma_f32 v102, v102, s56, -v20
    v_exp_f32 v102, v102
    v_fma_f32 v103, v103, s56, -v20
    v_exp_f32 v103, v103
    v_fma_f32 v104, v104, s56, -v20
    v_exp_f32 v104, v104
    v_fma_f32 v105, v105, s56, -v20
    v_exp_f32 v105, v105
    v_fma_f32 v106, v106, s56, -v20
    v_exp_f32 v106, v106
    v_fma_f32 v107, v107, s56, -v20
    v_exp_f32 v107, v107
    v_fma_f32 v108, v108, s56, -v20
    v_exp_f32 v108, v108
    v_fma_f32 v109, v109, s56, -v20
    v_exp_f32 v109, v109
    v_fma_f32 v110, v110, s56, -v20
    v_exp_f32 v110, v110
    v_fma_f32 v111, v111, s56, -v20
    v_exp_f32 v111, v111
    v_add_f32 v21, v21, v96
    v_add_f32 v21, v21, v97
    v_add_f32 v21, v21, v98
    v_add_f32 v21, v21, v99
    v_add_f32 v21, v21, v100
    v_add_f32 v21, v21, v101
    v_add_f32 v21, v21, v102
    v_add_f32 v21, v21, v103
    v_add_f32 v21, v21, v104
    v_add_f32 v21, v21, v105
    v_add_f32 v21, v21, v106
    v_add_f32 v21, v21, v107
    v_add_f32 v21, v21, v108
    v_add_f32 v21, v21, v109
    v_add_f32 v21, v21, v110
    v_add_f32 v21, v21, v111
    v_cvt_pk_bf16_f32 v96, v96, v97
    v_cvt_pk_bf16_f32 v97, v98, v99
    v_cvt_pk_bf16_f32 v98, v100, v101
    v_cvt_pk_bf16_f32 v99, v102, v103
    v_cvt_pk_bf16_f32 v100, v104, v105
    v_cvt_pk_bf16_f32 v101, v106, v107
    v_cvt_pk_bf16_f32 v102, v108, v109
    v_cvt_pk_bf16_f32 v103, v110, v111
    s_add_u32 m0, s52, 0
    s_add_u32 s23, s54, 0
    buffer_load_dwordx4 v32, s[8:11], s23 offen lds
    s_add_u32 m0, s52, 1024
    s_add_u32 s23, s54, 16384
    buffer_load_dwordx4 v33, s[8:11], s23 offen lds
    s_add_u32 m0, s52, 2048
    s_add_u32 s23, s54, 32768
    buffer_load_dwordx4 v34, s[8:11], s23 offen lds
    s_add_u32 m0, s52, 3072
    s_add_u32 s23, s54, 49152
    buffer_load_dwordx4 v35, s[8:11], s23 offen lds
    s_add_u32 m0, s52, 4096
    s_add_u32 s23, s54, 65536
    buffer_load_dwordx4 v36, s[8:11], s23 offen lds
    s_add_u32 m0, s52, 5120
    s_add_u32 s23, s54, 81920
    buffer_load_dwordx4 v37, s[8:11], s23 offen lds
    s_add_u32 m0, s52, 6144
    s_add_u32 s23, s54, 98304
    buffer_load_dwordx4 v38, s[8:11], s23 offen lds
    s_add_u32 m0, s52, 7168
    s_add_u32 s23, s54, 114688
    buffer_load_dwordx4 v39, s[8:11], s23 offen lds
    s_add_u32 m0, s53, 0
    s_add_u32 s23, s55, 0
    buffer_load_dwordx4 v40, s[12:15], s23 offen lds
    s_add_u32 m0, s53, 1024
    s_add_u32 s23, s55, 32768
    buffer_load_dwordx4 v41, s[12:15], s23 offen lds
    s_add_u32 m0, s53, 2048
    s_add_u32 s23, s55, 65536
    buffer_load_dwordx4 v40, s[12:15], s23 offen lds
    s_add_u32 m0, s53, 3072
    s_add_u32 s23, s55, 98304
    buffer_load_dwordx4 v41, s[12:15], s23 offen lds
    s_add_u32 m0, s53, 4096
    s_add_u32 s23, s55, 131072
    buffer_load_dwordx4 v40, s[12:15], s23 offen lds
    s_add_u32 m0, s53, 5120
    s_add_u32 s23, s55, 163840
    buffer_load_dwordx4 v41, s[12:15], s23 offen lds
    s_add_u32 m0, s53, 6144
    s_add_u32 s23, s55, 196608
    buffer_load_dwordx4 v40, s[12:15], s23 offen lds
    s_add_u32 m0, s53, 7168
    s_add_u32 s23, s55, 229376
    buffer_load_dwordx4 v41, s[12:15], s23 offen lds
    ds_read_b128 v[64:67], v58 offset:0
    ds_read_b128 v[68:71], v59 offset:0
    ds_read_b128 v[72:75], v58 offset:4096
    ds_read_b128 v[76:79], v59 offset:4096
    ds_read_b128 v[80:83], v58 offset:8192
    ds_read_b128 v[84:87], v59 offset:8192
    ds_read_b128 v[88:91], v58 offset:12288
    ds_read_b128 v[92:95], v59 offset:12288
    s_waitcnt lgkmcnt(7)
    v_mfma_f32_32x32x16_bf16 v[128:143], v[64:67], v[96:99], v[128:143]
    ds_read_b128 v[64:67], v58 offset:16384
    s_waitcnt lgkmcnt(7)
    v_mfma_f32_32x32x16_bf16 v[128:143], v[68:71], v[100:103], v[128:143]
    ds_read_b128 v[68:71], v59 offset:16384
    s_waitcnt lgkmcnt(7)
    v_mfma_f32_32x32x16_bf16 v[144:159], v[72:75], v[96:99], v[144:159]
    ds_read_b128 v[72:75], v58 offset:20480
    s_waitcnt lgkmcnt(7)
    v_mfma_f32_32x32x16_bf16 v[144:159], v[76:79], v[100:103], v[144:159]
    ds_read_b128 v[76:79], v59 offset:20480
    s_waitcnt lgkmcnt(7)
    v_mfma_f32_32x32x16_bf16 v[160:175], v[80:83], v[96:99], v[160:175]
    ds_read_b128 v[80:83], v58 offset:24576
    s_waitcnt lgkmcnt(7)
    v_mfma_f32_32x32x16_bf16 v[160:175], v[84:87], v[100:103], v[160:175]
    ds_read_b128 v[84:87], v59 offset:24576
    s_waitcnt lgkmcnt(7)
    v_mfma_f32_32x32x16_bf16 v[176:191], v[88:91], v[96:99], v[176:191]
    ds_read_b128 v[88:91], v58 offset:28672
    s_waitcnt lgkmcnt(7)
    v_mfma_f32_32x32x16_bf16 v[176:191], v[92:95], v[100:103], v[176:191]
    ds_read_b128 v[92:95], v59 offset:28672
    s_waitcnt lgkmcnt(7)
    v_mfma_f32_32x32x16_bf16 v[192:207], v[64:67], v[96:99], v[192:207]
    s_waitcnt lgkmcnt(6)
    v_mfma_f32_32x32x16_bf16 v[192:207], v[68:71], v[100:103], v[192:207]
    s_waitcnt lgkmcnt(5)
    v_mfma_f32_32x32x16_bf16 v[208:223], v[72:75], v[96:99], v[208:223]
    s_waitcnt lgkmcnt(4)
    v_mfma_f32_32x32x16_bf16 v[208:223], v[76:79], v[100:103], v[208:223]
    s_waitcnt lgkmcnt(3)
    v_mfma_f32_32x32x16_bf16 v[224:239], v[80:83], v[96:99], v[224:239]
    s_waitcnt lgkmcnt(2)
    v_mfma_f32_32x32x16_bf16 v[224:239], v[84:87], v[100:103], v[224:239]
    s_waitcnt lgkmcnt(1)
    v_mfma_f32_32x32x16_bf16 v[240:255], v[88:91], v[96:99], v[240:255]
    s_waitcnt lgkmcnt(0)
    v_mfma_f32_32x32x16_bf16 v[240:255], v[92:95], v[100:103], v[240:255]
    v_xor_b32 v42, 0x8000, v42
    v_xor_b32 v43, 0x8000, v43
    v_xor_b32 v44, 0x8000, v44
    v_xor_b32 v45, 0x8000, v45
    v_xor_b32 v46, 0x8000, v46
    v_xor_b32 v47, 0x8000, v47
    v_xor_b32 v48, 0x8000, v48
    v_xor_b32 v49, 0x8000, v49
    v_xor_b32 v50, 0x8000, v50
    v_xor_b32 v51, 0x8000, v51
    v_xor_b32 v52, 0x8000, v52
    v_xor_b32 v53, 0x8000, v53
    v_xor_b32 v54, 0x8000, v54
    v_xor_b32 v55, 0x8000, v55
    v_xor_b32 v56, 0x8000, v56
    v_xor_b32 v57, 0x8000, v57
    v_xor_b32 v58, 0x8000, v58
    v_xor_b32 v59, 0x8000, v59
    s_xor_b32 s52, s52, 0x8000
    s_xor_b32 s53, s53, 0x8000
    s_nop 15
    v_mov_b32 v24, v21
    v_mov_b32 v25, v21
    s_nop 1
    v_permlane32_swap_b32 v24, v25
    v_add_f32 v21, v24, v25
    v_lshlrev_b32 v26, 4, v2
    s_lshl_b32 s30, s28, 13
    v_add_u32 v26, s30, v26
    v_add_u32 v26, 131072, v26
    v_lshlrev_b32 v27, 3, v2
    s_lshl_b32 s30, s28, 9
    v_add_u32 v27, s30, v27
    v_add_u32 v27, 147456, v27
    s_cmp_eq_u32 s29, 0
    s_cbranch_scc1 fw_15_0
    ds_write_b64 v27, v[20:21]
    ds_write_b128 v26, v[128:131] offset:0
    ds_write_b128 v26, v[132:135] offset:1024
    ds_write_b128 v26, v[136:139] offset:2048
    ds_write_b128 v26, v[140:143] offset:3072
    ds_write_b128 v26, v[144:147] offset:4096
    ds_write_b128 v26, v[148:151] offset:5120
    ds_write_b128 v26, v[152:155] offset:6144
    ds_write_b128 v26, v[156:159] offset:7168
    s_waitcnt lgkmcnt(0)
    s_barrier
    s_barrier
    s_branch fe_16_0
fw_15_0:
    s_barrier
    ds_read_b64 v[28:29], v27
    ds_read_b128 v[64:67], v26 offset:0
    ds_read_b128 v[68:71], v26 offset:1024
    ds_read_b128 v[72:75], v26 offset:2048
    ds_read_b128 v[76:79], v26 offset:3072
    ds_read_b128 v[80:83], v26 offset:4096
    ds_read_b128 v[84:87], v26 offset:5120
    ds_read_b128 v[88:91], v26 offset:6144
    ds_read_b128 v[92:95], v26 offset:7168
    s_waitcnt lgkmcnt(0)
    s_barrier
    v_max_f32 v30, v20, v28
    v_sub_f32 v24, v20, v30
    v_sub_f32 v25, v28, v30
    v_exp_f32 v24, v24
    v_exp_f32 v25, v25
    s_nop 0
    v_mul_f32 v30, v21, v24
    v_fmac_f32 v30, v29, v25
    v_rcp_f32 v30, v30
    s_nop 0
    v_mul_f32 v24, v24, v30
    v_mul_f32 v25, v25, v30
    v_mul_f32 v128, v24, v128
    v_fmac_f32 v128, v25, v64
    v_mul_f32 v129, v24, v129
    v_fmac_f32 v129, v25, v65
    v_mul_f32 v130, v24, v130
    v_fmac_f32 v130, v25, v66
    v_mul_f32 v131, v24, v131
    v_fmac_f32 v131, v25, v67
    v_mul_f32 v132, v24, v132
    v_fmac_f32 v132, v25, v68
    v_mul_f32 v133, v24, v133
    v_fmac_f32 v133, v25, v69
    v_mul_f32 v134, v24, v134
    v_fmac_f32 v134, v25, v70
    v_mul_f32 v135, v24, v135
    v_fmac_f32 v135, v25, v71
    v_mul_f32 v136, v24, v136
    v_fmac_f32 v136, v25, v72
    v_mul_f32 v137, v24, v137
    v_fmac_f32 v137, v25, v73
    v_mul_f32 v138, v24, v138
    v_fmac_f32 v138, v25, v74
    v_mul_f32 v139, v24, v139
    v_fmac_f32 v139, v25, v75
    v_mul_f32 v140, v24, v140
    v_fmac_f32 v140, v25, v76
    v_mul_f32 v141, v24, v141
    v_fmac_f32 v141, v25, v77
    v_mul_f32 v142, v24, v142
    v_fmac_f32 v142, v25, v78
    v_mul_f32 v143, v24, v143
    v_fmac_f32 v143, v25, v79
    v_mul_f32 v144, v24, v144
    v_fmac_f32 v144, v25, v80
    v_mul_f32 v145, v24, v145
    v_fmac_f32 v145, v25, v81
    v_mul_f32 v146, v24, v146
    v_fmac_f32 v146, v25, v82
    v_mul_f32 v147, v24, v147
    v_fmac_f32 v147, v25, v83
    v_mul_f32 v148, v24, v148
    v_fmac_f32 v148, v25, v84
    v_mul_f32 v149, v24, v149
    v_fmac_f32 v149, v25, v85
    v_mul_f32 v150, v24, v150
    v_fmac_f32 v150, v25, v86
    v_mul_f32 v151, v24, v151
    v_fmac_f32 v151, v25, v87
    v_mul_f32 v152, v24, v152
    v_fmac_f32 v152, v25, v88
    v_mul_f32 v153, v24, v153
    v_fmac_f32 v153, v25, v89
    v_mul_f32 v154, v24, v154
    v_fmac_f32 v154, v25, v90
    v_mul_f32 v155, v24, v155
    v_fmac_f32 v155, v25, v91
    v_mul_f32 v156, v24, v156
    v_fmac_f32 v156, v25, v92
    v_mul_f32 v157, v24, v157
    v_fmac_f32 v157, v25, v93
    v_mul_f32 v158, v24, v158
    v_fmac_f32 v158, v25, v94
    v_mul_f32 v159, v24, v159
    v_fmac_f32 v159, v25, v95
    v_cvt_pk_bf16_f32 v128, v128, v129
    v_cvt_pk_bf16_f32 v129, v130, v131
    ds_write_b64 v60, v[128:129] offset:0
    v_cvt_pk_bf16_f32 v132, v132, v133
    v_cvt_pk_bf16_f32 v133, v134, v135
    ds_write_b64 v60, v[132:133] offset:16
    v_cvt_pk_bf16_f32 v136, v136, v137
    v_cvt_pk_bf16_f32 v137, v138, v139
    ds_write_b64 v60, v[136:137] offset:32
    v_cvt_pk_bf16_f32 v140, v140, v141
    v_cvt_pk_bf16_f32 v141, v142, v143
    ds_write_b64 v60, v[140:141] offset:48
    v_cvt_pk_bf16_f32 v144, v144, v145
    v_cvt_pk_bf16_f32 v145, v146, v147
    ds_write_b64 v60, v[144:145] offset:64
    v_cvt_pk_bf16_f32 v148, v148, v149
    v_cvt_pk_bf16_f32 v149, v150, v151
    ds_write_b64 v60, v[148:149] offset:80
    v_cvt_pk_bf16_f32 v152, v152, v153
    v_cvt_pk_bf16_f32 v153, v154, v155
    ds_write_b64 v60, v[152:153] offset:96
    v_cvt_pk_bf16_f32 v156, v156, v157
    v_cvt_pk_bf16_f32 v157, v158, v159
    ds_write_b64 v60, v[156:157] offset:112
    s_waitcnt lgkmcnt(0)
    ds_read_b128 v[64:67], v61 offset:0
    ds_read_b128 v[68:71], v61 offset:1152
    ds_read_b128 v[72:75], v61 offset:2304
    ds_read_b128 v[76:79], v61 offset:3456
    s_waitcnt lgkmcnt(3)
    s_add_u32 s30, s58, 0
    buffer_store_dwordx4 v[64:67], v62, s[16:19], s30 offen offset:0
    s_waitcnt lgkmcnt(2)
    s_add_u32 s30, s58, 65536
    buffer_store_dwordx4 v[68:71], v62, s[16:19], s30 offen offset:0
    s_waitcnt lgkmcnt(1)
    s_add_u32 s30, s58, 131072
    buffer_store_dwordx4 v[72:75], v62, s[16:19], s30 offen offset:0
    s_waitcnt lgkmcnt(0)
    s_add_u32 s30, s58, 196608
    buffer_store_dwordx4 v[76:79], v62, s[16:19], s30 offen offset:0
fe_16_0:
    s_cmp_eq_u32 s29, 0
    s_cbranch_scc1 fw_15_1
    ds_write_b128 v26, v[160:163] offset:0
    ds_write_b128 v26, v[164:167] offset:1024
    ds_write_b128 v26, v[168:171] offset:2048
    ds_write_b128 v26, v[172:175] offset:3072
    ds_write_b128 v26, v[176:179] offset:4096
    ds_write_b128 v26, v[180:183] offset:5120
    ds_write_b128 v26, v[184:187] offset:6144
    ds_write_b128 v26, v[188:191] offset:7168
    s_waitcnt lgkmcnt(0)
    s_barrier
    s_barrier
    s_branch fe_16_1
fw_15_1:
    s_barrier
    ds_read_b128 v[64:67], v26 offset:0
    ds_read_b128 v[68:71], v26 offset:1024
    ds_read_b128 v[72:75], v26 offset:2048
    ds_read_b128 v[76:79], v26 offset:3072
    ds_read_b128 v[80:83], v26 offset:4096
    ds_read_b128 v[84:87], v26 offset:5120
    ds_read_b128 v[88:91], v26 offset:6144
    ds_read_b128 v[92:95], v26 offset:7168
    s_waitcnt lgkmcnt(0)
    s_barrier
    v_mul_f32 v160, v24, v160
    v_fmac_f32 v160, v25, v64
    v_mul_f32 v161, v24, v161
    v_fmac_f32 v161, v25, v65
    v_mul_f32 v162, v24, v162
    v_fmac_f32 v162, v25, v66
    v_mul_f32 v163, v24, v163
    v_fmac_f32 v163, v25, v67
    v_mul_f32 v164, v24, v164
    v_fmac_f32 v164, v25, v68
    v_mul_f32 v165, v24, v165
    v_fmac_f32 v165, v25, v69
    v_mul_f32 v166, v24, v166
    v_fmac_f32 v166, v25, v70
    v_mul_f32 v167, v24, v167
    v_fmac_f32 v167, v25, v71
    v_mul_f32 v168, v24, v168
    v_fmac_f32 v168, v25, v72
    v_mul_f32 v169, v24, v169
    v_fmac_f32 v169, v25, v73
    v_mul_f32 v170, v24, v170
    v_fmac_f32 v170, v25, v74
    v_mul_f32 v171, v24, v171
    v_fmac_f32 v171, v25, v75
    v_mul_f32 v172, v24, v172
    v_fmac_f32 v172, v25, v76
    v_mul_f32 v173, v24, v173
    v_fmac_f32 v173, v25, v77
    v_mul_f32 v174, v24, v174
    v_fmac_f32 v174, v25, v78
    v_mul_f32 v175, v24, v175
    v_fmac_f32 v175, v25, v79
    v_mul_f32 v176, v24, v176
    v_fmac_f32 v176, v25, v80
    v_mul_f32 v177, v24, v177
    v_fmac_f32 v177, v25, v81
    v_mul_f32 v178, v24, v178
    v_fmac_f32 v178, v25, v82
    v_mul_f32 v179, v24, v179
    v_fmac_f32 v179, v25, v83
    v_mul_f32 v180, v24, v180
    v_fmac_f32 v180, v25, v84
    v_mul_f32 v181, v24, v181
    v_fmac_f32 v181, v25, v85
    v_mul_f32 v182, v24, v182
    v_fmac_f32 v182, v25, v86
    v_mul_f32 v183, v24, v183
    v_fmac_f32 v183, v25, v87
    v_mul_f32 v184, v24, v184
    v_fmac_f32 v184, v25, v88
    v_mul_f32 v185, v24, v185
    v_fmac_f32 v185, v25, v89
    v_mul_f32 v186, v24, v186
    v_fmac_f32 v186, v25, v90
    v_mul_f32 v187, v24, v187
    v_fmac_f32 v187, v25, v91
    v_mul_f32 v188, v24, v188
    v_fmac_f32 v188, v25, v92
    v_mul_f32 v189, v24, v189
    v_fmac_f32 v189, v25, v93
    v_mul_f32 v190, v24, v190
    v_fmac_f32 v190, v25, v94
    v_mul_f32 v191, v24, v191
    v_fmac_f32 v191, v25, v95
    v_cvt_pk_bf16_f32 v160, v160, v161
    v_cvt_pk_bf16_f32 v161, v162, v163
    ds_write_b64 v60, v[160:161] offset:0
    v_cvt_pk_bf16_f32 v164, v164, v165
    v_cvt_pk_bf16_f32 v165, v166, v167
    ds_write_b64 v60, v[164:165] offset:16
    v_cvt_pk_bf16_f32 v168, v168, v169
    v_cvt_pk_bf16_f32 v169, v170, v171
    ds_write_b64 v60, v[168:169] offset:32
    v_cvt_pk_bf16_f32 v172, v172, v173
    v_cvt_pk_bf16_f32 v173, v174, v175
    ds_write_b64 v60, v[172:173] offset:48
    v_cvt_pk_bf16_f32 v176, v176, v177
    v_cvt_pk_bf16_f32 v177, v178, v179
    ds_write_b64 v60, v[176:177] offset:64
    v_cvt_pk_bf16_f32 v180, v180, v181
    v_cvt_pk_bf16_f32 v181, v182, v183
    ds_write_b64 v60, v[180:181] offset:80
    v_cvt_pk_bf16_f32 v184, v184, v185
    v_cvt_pk_bf16_f32 v185, v186, v187
    ds_write_b64 v60, v[184:185] offset:96
    v_cvt_pk_bf16_f32 v188, v188, v189
    v_cvt_pk_bf16_f32 v189, v190, v191
    ds_write_b64 v60, v[188:189] offset:112
    s_waitcnt lgkmcnt(0)
    ds_read_b128 v[64:67], v61 offset:0
    ds_read_b128 v[68:71], v61 offset:1152
    ds_read_b128 v[72:75], v61 offset:2304
    ds_read_b128 v[76:79], v61 offset:3456
    s_waitcnt lgkmcnt(3)
    s_add_u32 s30, s58, 0
    buffer_store_dwordx4 v[64:67], v62, s[16:19], s30 offen offset:128
    s_waitcnt lgkmcnt(2)
    s_add_u32 s30, s58, 65536
    buffer_store_dwordx4 v[68:71], v62, s[16:19], s30 offen offset:128
    s_waitcnt lgkmcnt(1)
    s_add_u32 s30, s58, 131072
    buffer_store_dwordx4 v[72:75], v62, s[16:19], s30 offen offset:128
    s_waitcnt lgkmcnt(0)
    s_add_u32 s30, s58, 196608
    buffer_store_dwordx4 v[76:79], v62, s[16:19], s30 offen offset:128
fe_16_1:
    s_cmp_eq_u32 s29, 0
    s_cbranch_scc1 fw_15_2
    ds_write_b128 v26, v[192:195] offset:0
    ds_write_b128 v26, v[196:199] offset:1024
    ds_write_b128 v26, v[200:203] offset:2048
    ds_write_b128 v26, v[204:207] offset:3072
    ds_write_b128 v26, v[208:211] offset:4096
    ds_write_b128 v26, v[212:215] offset:5120
    ds_write_b128 v26, v[216:219] offset:6144
    ds_write_b128 v26, v[220:223] offset:7168
    s_waitcnt lgkmcnt(0)
    s_barrier
    s_barrier
    s_branch fe_16_2
fw_15_2:
    s_barrier
    ds_read_b128 v[64:67], v26 offset:0
    ds_read_b128 v[68:71], v26 offset:1024
    ds_read_b128 v[72:75], v26 offset:2048
    ds_read_b128 v[76:79], v26 offset:3072
    ds_read_b128 v[80:83], v26 offset:4096
    ds_read_b128 v[84:87], v26 offset:5120
    ds_read_b128 v[88:91], v26 offset:6144
    ds_read_b128 v[92:95], v26 offset:7168
    s_waitcnt lgkmcnt(0)
    s_barrier
    v_mul_f32 v192, v24, v192
    v_fmac_f32 v192, v25, v64
    v_mul_f32 v193, v24, v193
    v_fmac_f32 v193, v25, v65
    v_mul_f32 v194, v24, v194
    v_fmac_f32 v194, v25, v66
    v_mul_f32 v195, v24, v195
    v_fmac_f32 v195, v25, v67
    v_mul_f32 v196, v24, v196
    v_fmac_f32 v196, v25, v68
    v_mul_f32 v197, v24, v197
    v_fmac_f32 v197, v25, v69
    v_mul_f32 v198, v24, v198
    v_fmac_f32 v198, v25, v70
    v_mul_f32 v199, v24, v199
    v_fmac_f32 v199, v25, v71
    v_mul_f32 v200, v24, v200
    v_fmac_f32 v200, v25, v72
    v_mul_f32 v201, v24, v201
    v_fmac_f32 v201, v25, v73
    v_mul_f32 v202, v24, v202
    v_fmac_f32 v202, v25, v74
    v_mul_f32 v203, v24, v203
    v_fmac_f32 v203, v25, v75
    v_mul_f32 v204, v24, v204
    v_fmac_f32 v204, v25, v76
    v_mul_f32 v205, v24, v205
    v_fmac_f32 v205, v25, v77
    v_mul_f32 v206, v24, v206
    v_fmac_f32 v206, v25, v78
    v_mul_f32 v207, v24, v207
    v_fmac_f32 v207, v25, v79
    v_mul_f32 v208, v24, v208
    v_fmac_f32 v208, v25, v80
    v_mul_f32 v209, v24, v209
    v_fmac_f32 v209, v25, v81
    v_mul_f32 v210, v24, v210
    v_fmac_f32 v210, v25, v82
    v_mul_f32 v211, v24, v211
    v_fmac_f32 v211, v25, v83
    v_mul_f32 v212, v24, v212
    v_fmac_f32 v212, v25, v84
    v_mul_f32 v213, v24, v213
    v_fmac_f32 v213, v25, v85
    v_mul_f32 v214, v24, v214
    v_fmac_f32 v214, v25, v86
    v_mul_f32 v215, v24, v215
    v_fmac_f32 v215, v25, v87
    v_mul_f32 v216, v24, v216
    v_fmac_f32 v216, v25, v88
    v_mul_f32 v217, v24, v217
    v_fmac_f32 v217, v25, v89
    v_mul_f32 v218, v24, v218
    v_fmac_f32 v218, v25, v90
    v_mul_f32 v219, v24, v219
    v_fmac_f32 v219, v25, v91
    v_mul_f32 v220, v24, v220
    v_fmac_f32 v220, v25, v92
    v_mul_f32 v221, v24, v221
    v_fmac_f32 v221, v25, v93
    v_mul_f32 v222, v24, v222
    v_fmac_f32 v222, v25, v94
    v_mul_f32 v223, v24, v223
    v_fmac_f32 v223, v25, v95
    v_cvt_pk_bf16_f32 v192, v192, v193
    v_cvt_pk_bf16_f32 v193, v194, v195
    ds_write_b64 v60, v[192:193] offset:0
    v_cvt_pk_bf16_f32 v196, v196, v197
    v_cvt_pk_bf16_f32 v197, v198, v199
    ds_write_b64 v60, v[196:197] offset:16
    v_cvt_pk_bf16_f32 v200, v200, v201
    v_cvt_pk_bf16_f32 v201, v202, v203
    ds_write_b64 v60, v[200:201] offset:32
    v_cvt_pk_bf16_f32 v204, v204, v205
    v_cvt_pk_bf16_f32 v205, v206, v207
    ds_write_b64 v60, v[204:205] offset:48
    v_cvt_pk_bf16_f32 v208, v208, v209
    v_cvt_pk_bf16_f32 v209, v210, v211
    ds_write_b64 v60, v[208:209] offset:64
    v_cvt_pk_bf16_f32 v212, v212, v213
    v_cvt_pk_bf16_f32 v213, v214, v215
    ds_write_b64 v60, v[212:213] offset:80
    v_cvt_pk_bf16_f32 v216, v216, v217
    v_cvt_pk_bf16_f32 v217, v218, v219
    ds_write_b64 v60, v[216:217] offset:96
    v_cvt_pk_bf16_f32 v220, v220, v221
    v_cvt_pk_bf16_f32 v221, v222, v223
    ds_write_b64 v60, v[220:221] offset:112
    s_waitcnt lgkmcnt(0)
    ds_read_b128 v[64:67], v61 offset:0
    ds_read_b128 v[68:71], v61 offset:1152
    ds_read_b128 v[72:75], v61 offset:2304
    ds_read_b128 v[76:79], v61 offset:3456
    s_waitcnt lgkmcnt(3)
    s_add_u32 s30, s58, 0
    buffer_store_dwordx4 v[64:67], v62, s[16:19], s30 offen offset:256
    s_waitcnt lgkmcnt(2)
    s_add_u32 s30, s58, 65536
    buffer_store_dwordx4 v[68:71], v62, s[16:19], s30 offen offset:256
    s_waitcnt lgkmcnt(1)
    s_add_u32 s30, s58, 131072
    buffer_store_dwordx4 v[72:75], v62, s[16:19], s30 offen offset:256
    s_waitcnt lgkmcnt(0)
    s_add_u32 s30, s58, 196608
    buffer_store_dwordx4 v[76:79], v62, s[16:19], s30 offen offset:256
fe_16_2:
    s_cmp_eq_u32 s29, 0
    s_cbranch_scc1 fw_15_3
    ds_write_b128 v26, v[224:227] offset:0
    ds_write_b128 v26, v[228:231] offset:1024
    ds_write_b128 v26, v[232:235] offset:2048
    ds_write_b128 v26, v[236:239] offset:3072
    ds_write_b128 v26, v[240:243] offset:4096
    ds_write_b128 v26, v[244:247] offset:5120
    ds_write_b128 v26, v[248:251] offset:6144
    ds_write_b128 v26, v[252:255] offset:7168
    s_waitcnt lgkmcnt(0)
    s_barrier
    s_barrier
    s_branch fe_16_3
fw_15_3:
    s_barrier
    ds_read_b128 v[64:67], v26 offset:0
    ds_read_b128 v[68:71], v26 offset:1024
    ds_read_b128 v[72:75], v26 offset:2048
    ds_read_b128 v[76:79], v26 offset:3072
    ds_read_b128 v[80:83], v26 offset:4096
    ds_read_b128 v[84:87], v26 offset:5120
    ds_read_b128 v[88:91], v26 offset:6144
    ds_read_b128 v[92:95], v26 offset:7168
    s_waitcnt lgkmcnt(0)
    s_barrier
    v_mul_f32 v224, v24, v224
    v_fmac_f32 v224, v25, v64
    v_mul_f32 v225, v24, v225
    v_fmac_f32 v225, v25, v65
    v_mul_f32 v226, v24, v226
    v_fmac_f32 v226, v25, v66
    v_mul_f32 v227, v24, v227
    v_fmac_f32 v227, v25, v67
    v_mul_f32 v228, v24, v228
    v_fmac_f32 v228, v25, v68
    v_mul_f32 v229, v24, v229
    v_fmac_f32 v229, v25, v69
    v_mul_f32 v230, v24, v230
    v_fmac_f32 v230, v25, v70
    v_mul_f32 v231, v24, v231
    v_fmac_f32 v231, v25, v71
    v_mul_f32 v232, v24, v232
    v_fmac_f32 v232, v25, v72
    v_mul_f32 v233, v24, v233
    v_fmac_f32 v233, v25, v73
    v_mul_f32 v234, v24, v234
    v_fmac_f32 v234, v25, v74
    v_mul_f32 v235, v24, v235
    v_fmac_f32 v235, v25, v75
    v_mul_f32 v236, v24, v236
    v_fmac_f32 v236, v25, v76
    v_mul_f32 v237, v24, v237
    v_fmac_f32 v237, v25, v77
    v_mul_f32 v238, v24, v238
    v_fmac_f32 v238, v25, v78
    v_mul_f32 v239, v24, v239
    v_fmac_f32 v239, v25, v79
    v_mul_f32 v240, v24, v240
    v_fmac_f32 v240, v25, v80
    v_mul_f32 v241, v24, v241
    v_fmac_f32 v241, v25, v81
    v_mul_f32 v242, v24, v242
    v_fmac_f32 v242, v25, v82
    v_mul_f32 v243, v24, v243
    v_fmac_f32 v243, v25, v83
    v_mul_f32 v244, v24, v244
    v_fmac_f32 v244, v25, v84
    v_mul_f32 v245, v24, v245
    v_fmac_f32 v245, v25, v85
    v_mul_f32 v246, v24, v246
    v_fmac_f32 v246, v25, v86
    v_mul_f32 v247, v24, v247
    v_fmac_f32 v247, v25, v87
    v_mul_f32 v248, v24, v248
    v_fmac_f32 v248, v25, v88
    v_mul_f32 v249, v24, v249
    v_fmac_f32 v249, v25, v89
    v_mul_f32 v250, v24, v250
    v_fmac_f32 v250, v25, v90
    v_mul_f32 v251, v24, v251
    v_fmac_f32 v251, v25, v91
    v_mul_f32 v252, v24, v252
    v_fmac_f32 v252, v25, v92
    v_mul_f32 v253, v24, v253
    v_fmac_f32 v253, v25, v93
    v_mul_f32 v254, v24, v254
    v_fmac_f32 v254, v25, v94
    v_mul_f32 v255, v24, v255
    v_fmac_f32 v255, v25, v95
    v_cvt_pk_bf16_f32 v224, v224, v225
    v_cvt_pk_bf16_f32 v225, v226, v227
    ds_write_b64 v60, v[224:225] offset:0
    v_cvt_pk_bf16_f32 v228, v228, v229
    v_cvt_pk_bf16_f32 v229, v230, v231
    ds_write_b64 v60, v[228:229] offset:16
    v_cvt_pk_bf16_f32 v232, v232, v233
    v_cvt_pk_bf16_f32 v233, v234, v235
    ds_write_b64 v60, v[232:233] offset:32
    v_cvt_pk_bf16_f32 v236, v236, v237
    v_cvt_pk_bf16_f32 v237, v238, v239
    ds_write_b64 v60, v[236:237] offset:48
    v_cvt_pk_bf16_f32 v240, v240, v241
    v_cvt_pk_bf16_f32 v241, v242, v243
    ds_write_b64 v60, v[240:241] offset:64
    v_cvt_pk_bf16_f32 v244, v244, v245
    v_cvt_pk_bf16_f32 v245, v246, v247
    ds_write_b64 v60, v[244:245] offset:80
    v_cvt_pk_bf16_f32 v248, v248, v249
    v_cvt_pk_bf16_f32 v249, v250, v251
    ds_write_b64 v60, v[248:249] offset:96
    v_cvt_pk_bf16_f32 v252, v252, v253
    v_cvt_pk_bf16_f32 v253, v254, v255
    ds_write_b64 v60, v[252:253] offset:112
    s_waitcnt lgkmcnt(0)
    ds_read_b128 v[64:67], v61 offset:0
    ds_read_b128 v[68:71], v61 offset:1152
    ds_read_b128 v[72:75], v61 offset:2304
    ds_read_b128 v[76:79], v61 offset:3456
    s_waitcnt lgkmcnt(3)
    s_add_u32 s30, s58, 0
    buffer_store_dwordx4 v[64:67], v62, s[16:19], s30 offen offset:384
    s_waitcnt lgkmcnt(2)
    s_add_u32 s30, s58, 65536
    buffer_store_dwordx4 v[68:71], v62, s[16:19], s30 offen offset:384
    s_waitcnt lgkmcnt(1)
    s_add_u32 s30, s58, 131072
    buffer_store_dwordx4 v[72:75], v62, s[16:19], s30 offen offset:384
    s_waitcnt lgkmcnt(0)
    s_add_u32 s30, s58, 196608
    buffer_store_dwordx4 v[76:79], v62, s[16:19], s30 offen offset:384
fe_16_3:
k3_end:
    s_endpgm
.p2align 8
k4_kernel:
    s_load_dwordx2 s[4:5], s[0:1], 96
    v_lshrrev_b32 v1, 6, v0
    v_and_b32 v2, 63, v0
    s_nop 0
    v_readfirstlane_b32 s25, v1
    s_cmp_ge_u32 s2, 224
    s_cbranch_scc1 k4_end
    s_load_dwordx2 s[6:7], s[0:1], 0
    s_load_dwordx2 s[32:33], s[0:1], 40
    s_load_dwordx2 s[34:35], s[0:1], 72
    s_load_dwordx2 s[36:37], s[0:1], 80
    s_and_b32 s26, s2, 31
    s_lshl_b32 s26, s26, 6
    s_lshr_b32 s27, s2, 5
    s_lshl_b32 s27, s27, 6
    s_waitcnt lgkmcnt(0)
    v_mov_b32 v64, 0
    v_mov_b32 v65, 0
    v_mov_b32 v66, 0
    v_mov_b32 v67, 0
    v_mov_b32 v68, 0
    v_mov_b32 v69, 0
    v_mov_b32 v70, 0
    v_mov_b32 v71, 0
    v_mov_b32 v72, 0
    v_mov_b32 v73, 0
    v_mov_b32 v74, 0
    v_mov_b32 v75, 0
    v_mov_b32 v76, 0
    v_mov_b32 v77, 0
    v_mov_b32 v78, 0
    v_mov_b32 v79, 0
    v_mov_b32 v80, 0
    v_mov_b32 v81, 0
    v_mov_b32 v82, 0
    v_mov_b32 v83, 0
    v_mov_b32 v84, 0
    v_mov_b32 v85, 0
    v_mov_b32 v86, 0
    v_mov_b32 v87, 0
    v_mov_b32 v88, 0
    v_mov_b32 v89, 0
    v_mov_b32 v90, 0
    v_mov_b32 v91, 0
    v_mov_b32 v92, 0
    v_mov_b32 v93, 0
    v_mov_b32 v94, 0
    v_mov_b32 v95, 0
    v_mov_b32 v96, 0
    v_mov_b32 v97, 0
    v_mov_b32 v98, 0
    v_mov_b32 v99, 0
    v_mov_b32 v100, 0
    v_mov_b32 v101, 0
    v_mov_b32 v102, 0
    v_mov_b32 v103, 0
    v_mov_b32 v104, 0
    v_mov_b32 v105, 0
    v_mov_b32 v106, 0
    v_mov_b32 v107, 0
    v_mov_b32 v108, 0
    v_mov_b32 v109, 0
    v_mov_b32 v110, 0
    v_mov_b32 v111, 0
    v_mov_b32 v112, 0
    v_mov_b32 v113, 0
    v_mov_b32 v114, 0
    v_mov_b32 v115, 0
    v_mov_b32 v116, 0
    v_mov_b32 v117, 0
    v_mov_b32 v118, 0
    v_mov_b32 v119, 0
    v_mov_b32 v120, 0
    v_mov_b32 v121, 0
    v_mov_b32 v122, 0
    v_mov_b32 v123, 0
    v_mov_b32 v124, 0
    v_mov_b32 v125, 0
    v_mov_b32 v126, 0
    v_mov_b32 v127, 0
    v_mov_b32 v128, 0
    v_mov_b32 v129, 0
    v_mov_b32 v130, 0
    v_mov_b32 v131, 0
    v_mov_b32 v132, 0
    v_mov_b32 v133, 0
    v_mov_b32 v134, 0
    v_mov_b32 v135, 0
    v_mov_b32 v136, 0
    v_mov_b32 v137, 0
    v_mov_b32 v138, 0
    v_mov_b32 v139, 0
    v_mov_b32 v140, 0
    v_mov_b32 v141, 0
    v_mov_b32 v142, 0
    v_mov_b32 v143, 0
    v_mov_b32 v144, 0
    v_mov_b32 v145, 0
    v_mov_b32 v146, 0
    v_mov_b32 v147, 0
    v_mov_b32 v148, 0
    v_mov_b32 v149, 0
    v_mov_b32 v150, 0
    v_mov_b32 v151, 0
    v_mov_b32 v152, 0
    v_mov_b32 v153, 0
    v_mov_b32 v154, 0
    v_mov_b32 v155, 0
    v_mov_b32 v156, 0
    v_mov_b32 v157, 0
    v_mov_b32 v158, 0
    v_mov_b32 v159, 0
    v_mov_b32 v160, 0
    v_mov_b32 v161, 0
    v_mov_b32 v162, 0
    v_mov_b32 v163, 0
    v_mov_b32 v164, 0
    v_mov_b32 v165, 0
    v_mov_b32 v166, 0
    v_mov_b32 v167, 0
    v_mov_b32 v168, 0
    v_mov_b32 v169, 0
    v_mov_b32 v170, 0
    v_mov_b32 v171, 0
    v_mov_b32 v172, 0
    v_mov_b32 v173, 0
    v_mov_b32 v174, 0
    v_mov_b32 v175, 0
    v_mov_b32 v176, 0
    v_mov_b32 v177, 0
    v_mov_b32 v178, 0
    v_mov_b32 v179, 0
    v_mov_b32 v180, 0
    v_mov_b32 v181, 0
    v_mov_b32 v182, 0
    v_mov_b32 v183, 0
    v_mov_b32 v184, 0
    v_mov_b32 v185, 0
    v_mov_b32 v186, 0
    v_mov_b32 v187, 0
    v_mov_b32 v188, 0
    v_mov_b32 v189, 0
    v_mov_b32 v190, 0
    v_mov_b32 v191, 0
    s_lshl_b32 s24, s25, 15
    v_and_b32 v3, 31, v2
    v_lshrrev_b32 v14, 5, v2
    v_bfe_u32 v15, v2, 1, 3
    v_xor_b32 v14, v14, v15
    v_lshlrev_b32 v3, 7, v3
    v_lshl_add_u32 v3, v14, 4, v3
    v_add_u32 v3, s24, v3
    v_xor_b32 v8, 0, v3
    v_xor_b32 v9, 32, v3
    v_xor_b32 v10, 64, v3
    v_xor_b32 v11, 96, v3
    v_lshrrev_b32 v3, 5, v2
    v_bfe_u32 v14, v2, 2, 2
    v_lshl_add_u32 v3, v3, 3, v14
    v_lshlrev_b32 v3, 7, v3
    v_bfe_u32 v15, v2, 4, 1
    v_lshl_add_u32 v3, v15, 5, v3
    v_and_b32 v15, 3, v2
    v_lshl_add_u32 v3, v15, 3, v3
    v_add_u32 v3, s24, v3
    v_add_u32 v3, 0x2000, v3
    v_bfe_u32 v15, v2, 3, 1
    v_xor_b32 v16, 0, v15
    v_lshl_add_u32 v12, v16, 6, v3
    v_xor_b32 v16, 1, v15
    v_lshl_add_u32 v13, v16, 6, v3
    v_lshrrev_b32 v3, 3, v2
    v_mul_u32_u24 v3, 896, v3
    v_bfe_u32 v14, v2, 2, 1
    v_bfe_u32 v15, v2, 4, 1
    v_xor_b32 v14, v14, v15
    v_lshl_add_u32 v3, v14, 6, v3
    v_and_b32 v14, 3, v2
    v_lshl_add_u32 v3, v14, 4, v3
    s_lshl_b32 s30, s27, 1
    v_add_u32 v6, s30, v3
    s_add_u32 s8, s4, 62914560
    s_addc_u32 s9, s5, 0
    s_mov_b32 s10, 16777216
    s_mov_b32 s11, 0x00020000
    s_mov_b32 s12, s32
    s_mov_b32 s13, s33
    s_mov_b32 s14, 3670016
    s_mov_b32 s15, 0x00020000
    v_lshrrev_b32 v3, 3, v2
    v_add_u32 v3, s26, v3
    s_mov_b32 s31, 8192
    v_mul_lo_u32 v3, v3, s31
    v_and_b32 v14, 7, v2
    v_lshrrev_b32 v15, 4, v2
    v_xor_b32 v16, v14, v15
    v_lshl_add_u32 v4, v16, 4, v3
    v_add_u32 v15, 4, v15
    v_xor_b32 v16, v14, v15
    v_lshl_add_u32 v5, v16, 4, v3
    s_mul_i32 s21, s25, 2048
    s_mul_i32 s22, s25, 917504
    s_add_u32 m0, s24, 0
    s_add_u32 s23, s21, 0
    buffer_load_dwordx4 v4, s[8:11], s23 offen lds
    s_add_u32 m0, s24, 1024
    s_add_u32 s23, s21, 65536
    buffer_load_dwordx4 v5, s[8:11], s23 offen lds
    s_add_u32 m0, s24, 2048
    s_add_u32 s23, s21, 131072
    buffer_load_dwordx4 v4, s[8:11], s23 offen lds
    s_add_u32 m0, s24, 3072
    s_add_u32 s23, s21, 196608
    buffer_load_dwordx4 v5, s[8:11], s23 offen lds
    s_add_u32 m0, s24, 4096
    s_add_u32 s23, s21, 262144
    buffer_load_dwordx4 v4, s[8:11], s23 offen lds
    s_add_u32 m0, s24, 5120
    s_add_u32 s23, s21, 327680
    buffer_load_dwordx4 v5, s[8:11], s23 offen lds
    s_add_u32 m0, s24, 6144
    s_add_u32 s23, s21, 393216
    buffer_load_dwordx4 v4, s[8:11], s23 offen lds
    s_add_u32 m0, s24, 7168
    s_add_u32 s23, s21, 458752
    buffer_load_dwordx4 v5, s[8:11], s23 offen lds
    s_add_u32 m0, s24, 8192
    s_add_u32 s23, s22, 0
    buffer_load_dwordx4 v6, s[12:15], s23 offen lds
    s_add_u32 m0, s24, 9216
    s_add_u32 s23, s22, 7168
    buffer_load_dwordx4 v6, s[12:15], s23 offen lds
    s_add_u32 m0, s24, 10240
    s_add_u32 s23, s22, 14336
    buffer_load_dwordx4 v6, s[12:15], s23 offen lds
    s_add_u32 m0, s24, 11264
    s_add_u32 s23, s22, 21504
    buffer_load_dwordx4 v6, s[12:15], s23 offen lds
    s_add_u32 m0, s24, 12288
    s_add_u32 s23, s22, 28672
    buffer_load_dwordx4 v6, s[12:15], s23 offen lds
    s_add_u32 m0, s24, 13312
    s_add_u32 s23, s22, 35840
    buffer_load_dwordx4 v6, s[12:15], s23 offen lds
    s_add_u32 m0, s24, 14336
    s_add_u32 s23, s22, 43008
    buffer_load_dwordx4 v6, s[12:15], s23 offen lds
    s_add_u32 m0, s24, 15360
    s_add_u32 s23, s22, 50176
    buffer_load_dwordx4 v6, s[12:15], s23 offen lds
    s_mov_b32 s20, 0
k4l_17:
    s_add_u32 s20, s20, 1
    s_cmp_ge_u32 s20, 16
    s_cbranch_scc1 k4s_18
    s_add_u32 s21, s21, 128
    s_add_u32 s22, s22, 57344
    s_xor_b32 s24, s24, 0x4000
    s_add_u32 m0, s24, 0
    s_add_u32 s23, s21, 0
    buffer_load_dwordx4 v4, s[8:11], s23 offen lds
    s_add_u32 m0, s24, 1024
    s_add_u32 s23, s21, 65536
    buffer_load_dwordx4 v5, s[8:11], s23 offen lds
    s_add_u32 m0, s24, 2048
    s_add_u32 s23, s21, 131072
    buffer_load_dwordx4 v4, s[8:11], s23 offen lds
    s_add_u32 m0, s24, 3072
    s_add_u32 s23, s21, 196608
    buffer_load_dwordx4 v5, s[8:11], s23 offen lds
    s_add_u32 m0, s24, 4096
    s_add_u32 s23, s21, 262144
    buffer_load_dwordx4 v4, s[8:11], s23 offen lds
    s_add_u32 m0, s24, 5120
    s_add_u32 s23, s21, 327680
    buffer_load_dwordx4 v5, s[8:11], s23 offen lds
    s_add_u32 m0, s24, 6144
    s_add_u32 s23, s21, 393216
    buffer_load_dwordx4 v4, s[8:11], s23 offen lds
    s_add_u32 m0, s24, 7168
    s_add_u32 s23, s21, 458752
    buffer_load_dwordx4 v5, s[8:11], s23 offen lds
    s_add_u32 m0, s24, 8192
    s_add_u32 s23, s22, 0
    buffer_load_dwordx4 v6, s[12:15], s23 offen lds
    s_add_u32 m0, s24, 9216
    s_add_u32 s23, s22, 7168
    buffer_load_dwordx4 v6, s[12:15], s23 offen lds
    s_add_u32 m0, s24, 10240
    s_add_u32 s23, s22, 14336
    buffer_load_dwordx4 v6, s[12:15], s23 offen lds
    s_add_u32 m0, s24, 11264
    s_add_u32 s23, s22, 21504
    buffer_load_dwordx4 v6, s[12:15], s23 offen lds
    s_add_u32 m0, s24, 12288
    s_add_u32 s23, s22, 28672
    buffer_load_dwordx4 v6, s[12:15], s23 offen lds
    s_add_u32 m0, s24, 13312
    s_add_u32 s23, s22, 35840
    buffer_load_dwordx4 v6, s[12:15], s23 offen lds
    s_add_u32 m0, s24, 14336
    s_add_u32 s23, s22, 43008
    buffer_load_dwordx4 v6, s[12:15], s23 offen lds
    s_add_u32 m0, s24, 15360
    s_add_u32 s23, s22, 50176
    buffer_load_dwordx4 v6, s[12:15], s23 offen lds
    s_waitcnt vmcnt(16)
    s_branch k4s_18_b
k4s_18:
    s_waitcnt vmcnt(0)
k4s_18_b:
    ds_read_b128 v[192:195], v8 offset:0
    ds_read_b128 v[196:199], v8 offset:4096
    ds_read_b64_tr_b16 v[208:209], v12 offset:0
    ds_read_b64_tr_b16 v[210:211], v12 offset:512
    ds_read_b64_tr_b16 v[212:213], v13 offset:0
    ds_read_b64_tr_b16 v[214:215], v13 offset:512
    s_waitcnt lgkmcnt(0)
    v_mfma_f32_32x32x16_bf16 v[64:79], v[208:211], v[192:195], v[64:79]
    v_mfma_f32_32x32x16_bf16 v[80:95], v[212:215], v[192:195], v[80:95]
    v_mfma_f32_32x32x16_bf16 v[96:111], v[208:211], v[196:199], v[96:111]
    v_mfma_f32_32x32x16_bf16 v[112:127], v[212:215], v[196:199], v[112:127]
    ds_read_b128 v[200:203], v9 offset:0
    ds_read_b128 v[204:207], v9 offset:4096
    ds_read_b64_tr_b16 v[216:217], v12 offset:2048
    ds_read_b64_tr_b16 v[218:219], v12 offset:2560
    ds_read_b64_tr_b16 v[220:221], v13 offset:2048
    ds_read_b64_tr_b16 v[222:223], v13 offset:2560
    s_waitcnt lgkmcnt(0)
    v_mfma_f32_32x32x16_bf16 v[64:79], v[216:219], v[200:203], v[64:79]
    v_mfma_f32_32x32x16_bf16 v[80:95], v[220:223], v[200:203], v[80:95]
    v_mfma_f32_32x32x16_bf16 v[96:111], v[216:219], v[204:207], v[96:111]
    v_mfma_f32_32x32x16_bf16 v[112:127], v[220:223], v[204:207], v[112:127]
    ds_read_b128 v[192:195], v10 offset:0
    ds_read_b128 v[196:199], v10 offset:4096
    ds_read_b64_tr_b16 v[208:209], v12 offset:4096
    ds_read_b64_tr_b16 v[210:211], v12 offset:4608
    ds_read_b64_tr_b16 v[212:213], v13 offset:4096
    ds_read_b64_tr_b16 v[214:215], v13 offset:4608
    s_waitcnt lgkmcnt(0)
    v_mfma_f32_32x32x16_bf16 v[64:79], v[208:211], v[192:195], v[64:79]
    v_mfma_f32_32x32x16_bf16 v[80:95], v[212:215], v[192:195], v[80:95]
    v_mfma_f32_32x32x16_bf16 v[96:111], v[208:211], v[196:199], v[96:111]
    v_mfma_f32_32x32x16_bf16 v[112:127], v[212:215], v[196:199], v[112:127]
    ds_read_b128 v[200:203], v11 offset:0
    ds_read_b128 v[204:207], v11 offset:4096
    ds_read_b64_tr_b16 v[216:217], v12 offset:6144
    ds_read_b64_tr_b16 v[218:219], v12 offset:6656
    ds_read_b64_tr_b16 v[220:221], v13 offset:6144
    ds_read_b64_tr_b16 v[222:223], v13 offset:6656
    s_waitcnt lgkmcnt(0)
    v_mfma_f32_32x32x16_bf16 v[64:79], v[216:219], v[200:203], v[64:79]
    v_mfma_f32_32x32x16_bf16 v[80:95], v[220:223], v[200:203], v[80:95]
    v_mfma_f32_32x32x16_bf16 v[96:111], v[216:219], v[204:207], v[96:111]
    v_mfma_f32_32x32x16_bf16 v[112:127], v[220:223], v[204:207], v[112:127]
    v_xor_b32 v8, 0x4000, v8
    v_xor_b32 v9, 0x4000, v9
    v_xor_b32 v10, 0x4000, v10
    v_xor_b32 v11, 0x4000, v11
    v_xor_b32 v12, 0x4000, v12
    v_xor_b32 v13, 0x4000, v13
    s_cmp_lt_u32 s20, 16
    s_cbranch_scc1 k4l_17
    s_lshl_b32 s24, s25, 15
    s_add_u32 s8, s4, 54525952
    s_addc_u32 s9, s5, 0
    s_mov_b32 s10, 7340032
    s_mov_b32 s11, 0x00020000
    s_mov_b32 s12, s34
    s_mov_b32 s13, s35
    s_mov_b32 s14, 1605632
    s_mov_b32 s15, 0x00020000
    v_lshrrev_b32 v3, 3, v2
    v_add_u32 v3, s26, v3
    s_mov_b32 s31, 3584
    v_mul_lo_u32 v3, v3, s31
    v_and_b32 v14, 7, v2
    v_lshrrev_b32 v15, 4, v2
    v_xor_b32 v16, v14, v15
    v_lshl_add_u32 v4, v16, 4, v3
    v_add_u32 v15, 4, v15
    v_xor_b32 v16, v14, v15
    v_lshl_add_u32 v5, v16, 4, v3
    s_mul_i32 s21, s25, 896
    s_mul_i32 s22, s25, 401408
    s_add_u32 m0, s24, 0
    s_add_u32 s23, s21, 0
    buffer_load_dwordx4 v4, s[8:11], s23 offen lds
    s_add_u32 m0, s24, 1024
    s_add_u32 s23, s21, 28672
    buffer_load_dwordx4 v5, s[8:11], s23 offen lds
    s_add_u32 m0, s24, 2048
    s_add_u32 s23, s21, 57344
    buffer_load_dwordx4 v4, s[8:11], s23 offen lds
    s_add_u32 m0, s24, 3072
    s_add_u32 s23, s21, 86016
    buffer_load_dwordx4 v5, s[8:11], s23 offen lds
    s_add_u32 m0, s24, 4096
    s_add_u32 s23, s21, 114688
    buffer_load_dwordx4 v4, s[8:11], s23 offen lds
    s_add_u32 m0, s24, 5120
    s_add_u32 s23, s21, 143360
    buffer_load_dwordx4 v5, s[8:11], s23 offen lds
    s_add_u32 m0, s24, 6144
    s_add_u32 s23, s21, 172032
    buffer_load_dwordx4 v4, s[8:11], s23 offen lds
    s_add_u32 m0, s24, 7168
    s_add_u32 s23, s21, 200704
    buffer_load_dwordx4 v5, s[8:11], s23 offen lds
    s_add_u32 m0, s24, 8192
    s_add_u32 s23, s22, 0
    buffer_load_dwordx4 v6, s[12:15], s23 offen lds
    s_add_u32 m0, s24, 9216
    s_add_u32 s23, s22, 7168
    buffer_load_dwordx4 v6, s[12:15], s23 offen lds
    s_add_u32 m0, s24, 10240
    s_add_u32 s23, s22, 14336
    buffer_load_dwordx4 v6, s[12:15], s23 offen lds
    s_add_u32 m0, s24, 11264
    s_add_u32 s23, s22, 21504
    buffer_load_dwordx4 v6, s[12:15], s23 offen lds
    s_add_u32 m0, s24, 12288
    s_add_u32 s23, s22, 28672
    buffer_load_dwordx4 v6, s[12:15], s23 offen lds
    s_add_u32 m0, s24, 13312
    s_add_u32 s23, s22, 35840
    buffer_load_dwordx4 v6, s[12:15], s23 offen lds
    s_add_u32 m0, s24, 14336
    s_add_u32 s23, s22, 43008
    buffer_load_dwordx4 v6, s[12:15], s23 offen lds
    s_add_u32 m0, s24, 15360
    s_add_u32 s23, s22, 50176
    buffer_load_dwordx4 v6, s[12:15], s23 offen lds
    s_mov_b32 s20, 0
k4l_19:
    s_add_u32 s20, s20, 1
    s_cmp_ge_u32 s20, 7
    s_cbranch_scc1 k4s_20
    s_add_u32 s21, s21, 128
    s_add_u32 s22, s22, 57344
    s_xor_b32 s24, s24, 0x4000
    s_add_u32 m0, s24, 0
    s_add_u32 s23, s21, 0
    buffer_load_dwordx4 v4, s[8:11], s23 offen lds
    s_add_u32 m0, s24, 1024
    s_add_u32 s23, s21, 28672
    buffer_load_dwordx4 v5, s[8:11], s23 offen lds
    s_add_u32 m0, s24, 2048
    s_add_u32 s23, s21, 57344
    buffer_load_dwordx4 v4, s[8:11], s23 offen lds
    s_add_u32 m0, s24, 3072
    s_add_u32 s23, s21, 86016
    buffer_load_dwordx4 v5, s[8:11], s23 offen lds
    s_add_u32 m0, s24, 4096
    s_add_u32 s23, s21, 114688
    buffer_load_dwordx4 v4, s[8:11], s23 offen lds
    s_add_u32 m0, s24, 5120
    s_add_u32 s23, s21, 143360
    buffer_load_dwordx4 v5, s[8:11], s23 offen lds
    s_add_u32 m0, s24, 6144
    s_add_u32 s23, s21, 172032
    buffer_load_dwordx4 v4, s[8:11], s23 offen lds
    s_add_u32 m0, s24, 7168
    s_add_u32 s23, s21, 200704
    buffer_load_dwordx4 v5, s[8:11], s23 offen lds
    s_add_u32 m0, s24, 8192
    s_add_u32 s23, s22, 0
    buffer_load_dwordx4 v6, s[12:15], s23 offen lds
    s_add_u32 m0, s24, 9216
    s_add_u32 s23, s22, 7168
    buffer_load_dwordx4 v6, s[12:15], s23 offen lds
    s_add_u32 m0, s24, 10240
    s_add_u32 s23, s22, 14336
    buffer_load_dwordx4 v6, s[12:15], s23 offen lds
    s_add_u32 m0, s24, 11264
    s_add_u32 s23, s22, 21504
    buffer_load_dwordx4 v6, s[12:15], s23 offen lds
    s_add_u32 m0, s24, 12288
    s_add_u32 s23, s22, 28672
    buffer_load_dwordx4 v6, s[12:15], s23 offen lds
    s_add_u32 m0, s24, 13312
    s_add_u32 s23, s22, 35840
    buffer_load_dwordx4 v6, s[12:15], s23 offen lds
    s_add_u32 m0, s24, 14336
    s_add_u32 s23, s22, 43008
    buffer_load_dwordx4 v6, s[12:15], s23 offen lds
    s_add_u32 m0, s24, 15360
    s_add_u32 s23, s22, 50176
    buffer_load_dwordx4 v6, s[12:15], s23 offen lds
    s_waitcnt vmcnt(16)
    s_branch k4s_20_b
k4s_20:
    s_waitcnt vmcnt(0)
k4s_20_b:
    ds_read_b128 v[192:195], v8 offset:0
    ds_read_b128 v[196:199], v8 offset:4096
    ds_read_b64_tr_b16 v[208:209], v12 offset:0
    ds_read_b64_tr_b16 v[210:211], v12 offset:512
    ds_read_b64_tr_b16 v[212:213], v13 offset:0
    ds_read_b64_tr_b16 v[214:215], v13 offset:512
    s_waitcnt lgkmcnt(0)
    v_mfma_f32_32x32x16_bf16 v[128:143], v[208:211], v[192:195], v[128:143]
    v_mfma_f32_32x32x16_bf16 v[144:159], v[212:215], v[192:195], v[144:159]
    v_mfma_f32_32x32x16_bf16 v[160:175], v[208:211], v[196:199], v[160:175]
    v_mfma_f32_32x32x16_bf16 v[176:191], v[212:215], v[196:199], v[176:191]
    ds_read_b128 v[200:203], v9 offset:0
    ds_read_b128 v[204:207], v9 offset:4096
    ds_read_b64_tr_b16 v[216:217], v12 offset:2048
    ds_read_b64_tr_b16 v[218:219], v12 offset:2560
    ds_read_b64_tr_b16 v[220:221], v13 offset:2048
    ds_read_b64_tr_b16 v[222:223], v13 offset:2560
    s_waitcnt lgkmcnt(0)
    v_mfma_f32_32x32x16_bf16 v[128:143], v[216:219], v[200:203], v[128:143]
    v_mfma_f32_32x32x16_bf16 v[144:159], v[220:223], v[200:203], v[144:159]
    v_mfma_f32_32x32x16_bf16 v[160:175], v[216:219], v[204:207], v[160:175]
    v_mfma_f32_32x32x16_bf16 v[176:191], v[220:223], v[204:207], v[176:191]
    ds_read_b128 v[192:195], v10 offset:0
    ds_read_b128 v[196:199], v10 offset:4096
    ds_read_b64_tr_b16 v[208:209], v12 offset:4096
    ds_read_b64_tr_b16 v[210:211], v12 offset:4608
    ds_read_b64_tr_b16 v[212:213], v13 offset:4096
    ds_read_b64_tr_b16 v[214:215], v13 offset:4608
    s_waitcnt lgkmcnt(0)
    v_mfma_f32_32x32x16_bf16 v[128:143], v[208:211], v[192:195], v[128:143]
    v_mfma_f32_32x32x16_bf16 v[144:159], v[212:215], v[192:195], v[144:159]
    v_mfma_f32_32x32x16_bf16 v[160:175], v[208:211], v[196:199], v[160:175]
    v_mfma_f32_32x32x16_bf16 v[176:191], v[212:215], v[196:199], v[176:191]
    ds_read_b128 v[200:203], v11 offset:0
    ds_read_b128 v[204:207], v11 offset:4096
    ds_read_b64_tr_b16 v[216:217], v12 offset:6144
    ds_read_b64_tr_b16 v[218:219], v12 offset:6656
    ds_read_b64_tr_b16 v[220:221], v13 offset:6144
    ds_read_b64_tr_b16 v[222:223], v13 offset:6656
    s_waitcnt lgkmcnt(0)
    v_mfma_f32_32x32x16_bf16 v[128:143], v[216:219], v[200:203], v[128:143]
    v_mfma_f32_32x32x16_bf16 v[144:159], v[220:223], v[200:203], v[144:159]
    v_mfma_f32_32x32x16_bf16 v[160:175], v[216:219], v[204:207], v[160:175]
    v_mfma_f32_32x32x16_bf16 v[176:191], v[220:223], v[204:207], v[176:191]
    v_xor_b32 v8, 0x4000, v8
    v_xor_b32 v9, 0x4000, v9
    v_xor_b32 v10, 0x4000, v10
    v_xor_b32 v11, 0x4000, v11
    v_xor_b32 v12, 0x4000, v12
    v_xor_b32 v13, 0x4000, v13
    s_cmp_lt_u32 s20, 7
    s_cbranch_scc1 k4l_19
    s_nop 15
    s_lshl_b32 s24, s25, 15
    v_lshlrev_b32 v3, 4, v2
    v_add_u32 v3, s24, v3
    ds_write_b128 v3, v[64:67] offset:0
    ds_write_b128 v3, v[68:71] offset:1024
    ds_write_b128 v3, v[72:75] offset:2048
    ds_write_b128 v3, v[76:79] offset:3072
    ds_write_b128 v3, v[80:83] offset:4096
    ds_write_b128 v3, v[84:87] offset:5120
    ds_write_b128 v3, v[88:91] offset:6144
    ds_write_b128 v3, v[92:95] offset:7168
    ds_write_b128 v3, v[96:99] offset:8192
    ds_write_b128 v3, v[100:103] offset:9216
    ds_write_b128 v3, v[104:107] offset:10240
    ds_write_b128 v3, v[108:111] offset:11264
    ds_write_b128 v3, v[112:115] offset:12288
    ds_write_b128 v3, v[116:119] offset:13312
    ds_write_b128 v3, v[120:123] offset:14336
    ds_write_b128 v3, v[124:127] offset:15360
    ds_write_b128 v3, v[128:131] offset:16384
    ds_write_b128 v3, v[132:135] offset:17408
    ds_write_b128 v3, v[136:139] offset:18432
    ds_write_b128 v3, v[140:143] offset:19456
    ds_write_b128 v3, v[144:147] offset:20480
    ds_write_b128 v3, v[148:151] offset:21504
    ds_write_b128 v3, v[152:155] offset:22528
    ds_write_b128 v3, v[156:159] offset:23552
    ds_write_b128 v3, v[160:163] offset:24576
    ds_write_b128 v3, v[164:167] offset:25600
    ds_write_b128 v3, v[168:171] offset:26624
    ds_write_b128 v3, v[172:175] offset:27648
    ds_write_b128 v3, v[176:179] offset:28672
    ds_write_b128 v3, v[180:183] offset:29696
    ds_write_b128 v3, v[184:187] offset:30720
    ds_write_b128 v3, v[188:191] offset:31744
    s_waitcnt lgkmcnt(0)
    s_barrier
    v_lshlrev_b32 v3, 4, v2
    s_lshl_b32 s30, s25, 12
    v_add_u32 v3, s30, v3
    v_add_u32 v27, 0x10000, v3
    ds_read_b128 v[64:67], v3 offset:0
    ds_read_b128 v[68:71], v3 offset:1024
    ds_read_b128 v[72:75], v3 offset:2048
    ds_read_b128 v[76:79], v3 offset:3072
    ds_read_b128 v[80:83], v3 offset:16384
    ds_read_b128 v[84:87], v3 offset:17408
    ds_read_b128 v[88:91], v3 offset:18432
    ds_read_b128 v[92:95], v3 offset:19456
    ds_read_b128 v[96:99], v3 offset:32768
    ds_read_b128 v[100:103], v3 offset:33792
    ds_read_b128 v[104:107], v3 offset:34816
    ds_read_b128 v[108:111], v3 offset:35840
    ds_read_b128 v[112:115], v3 offset:49152
    ds_read_b128 v[116:119], v3 offset:50176
    ds_read_b128 v[120:123], v3 offset:51200
    ds_read_b128 v[124:127], v3 offset:52224
    ds_read_b128 v[128:131], v27 offset:0
    ds_read_b128 v[132:135], v27 offset:1024
    ds_read_b128 v[136:139], v27 offset:2048
    ds_read_b128 v[140:143], v27 offset:3072
    ds_read_b128 v[144:147], v27 offset:16384
    ds_read_b128 v[148:151], v27 offset:17408
    ds_read_b128 v[152:155], v27 offset:18432
    ds_read_b128 v[156:159], v27 offset:19456
    ds_read_b128 v[160:163], v27 offset:32768
    ds_read_b128 v[164:167], v27 offset:33792
    ds_read_b128 v[168:171], v27 offset:34816
    ds_read_b128 v[172:175], v27 offset:35840
    ds_read_b128 v[176:179], v27 offset:49152
    ds_read_b128 v[180:183], v27 offset:50176
    ds_read_b128 v[184:187], v27 offset:51200
    ds_read_b128 v[188:191], v27 offset:52224
    s_mov_b32 s8, s6
    s_mov_b32 s9, s7
    s_mov_b32 s10, 1835008
    s_mov_b32 s11, 0x00020000
    s_mov_b32 s16, s36
    s_mov_b32 s17, s37
    s_mov_b32 s18, 1835008
    s_mov_b32 s19, 0x00020000
    v_and_b32 v14, 31, v2
    s_lshr_b32 s30, s25, 1
    s_lshl_b32 s30, s30, 5
    s_add_u32 s30, s30, s26
    v_add_u32 v14, s30, v14
    v_mul_u32_u24 v14, 896, v14
    v_lshrrev_b32 v15, 5, v2
    v_lshl_add_u32 v14, v15, 3, v14
    s_and_b32 s30, s25, 1
    s_lshl_b32 s30, s30, 5
    s_add_u32 s30, s30, s27
    s_lshl_b32 s30, s30, 1
    v_add_u32 v14, s30, v14
    buffer_load_dwordx2 v[16:17], v14, s[8:11], 0 offen offset:0
    buffer_load_dwordx2 v[18:19], v14, s[8:11], 0 offen offset:16
    buffer_load_dwordx2 v[20:21], v14, s[8:11], 0 offen offset:32
    buffer_load_dwordx2 v[22:23], v14, s[8:11], 0 offen offset:48
    s_waitcnt lgkmcnt(0)
    v_add_f32 v64, v64, v96
    v_add_f32 v128, v128, v160
    v_add_f32 v64, v64, v128
    v_add_f32 v80, v80, v112
    v_add_f32 v144, v144, v176
    v_add_f32 v80, v80, v144
    v_add_f32 v65, v65, v97
    v_add_f32 v129, v129, v161
    v_add_f32 v65, v65, v129
    v_add_f32 v81, v81, v113
    v_add_f32 v145, v145, v177
    v_add_f32 v81, v81, v145
    v_add_f32 v66, v66, v98
    v_add_f32 v130, v130, v162
    v_add_f32 v66, v66, v130
    v_add_f32 v82, v82, v114
    v_add_f32 v146, v146, v178
    v_add_f32 v82, v82, v146
    v_add_f32 v67, v67, v99
    v_add_f32 v131, v131, v163
    v_add_f32 v67, v67, v131
    v_add_f32 v83, v83, v115
    v_add_f32 v147, v147, v179
    v_add_f32 v83, v83, v147
    v_add_f32 v68, v68, v100
    v_add_f32 v132, v132, v164
    v_add_f32 v68, v68, v132
    v_add_f32 v84, v84, v116
    v_add_f32 v148, v148, v180
    v_add_f32 v84, v84, v148
    v_add_f32 v69, v69, v101
    v_add_f32 v133, v133, v165
    v_add_f32 v69, v69, v133
    v_add_f32 v85, v85, v117
    v_add_f32 v149, v149, v181
    v_add_f32 v85, v85, v149
    v_add_f32 v70, v70, v102
    v_add_f32 v134, v134, v166
    v_add_f32 v70, v70, v134
    v_add_f32 v86, v86, v118
    v_add_f32 v150, v150, v182
    v_add_f32 v86, v86, v150
    v_add_f32 v71, v71, v103
    v_add_f32 v135, v135, v167
    v_add_f32 v71, v71, v135
    v_add_f32 v87, v87, v119
    v_add_f32 v151, v151, v183
    v_add_f32 v87, v87, v151
    v_add_f32 v72, v72, v104
    v_add_f32 v136, v136, v168
    v_add_f32 v72, v72, v136
    v_add_f32 v88, v88, v120
    v_add_f32 v152, v152, v184
    v_add_f32 v88, v88, v152
    v_add_f32 v73, v73, v105
    v_add_f32 v137, v137, v169
    v_add_f32 v73, v73, v137
    v_add_f32 v89, v89, v121
    v_add_f32 v153, v153, v185
    v_add_f32 v89, v89, v153
    v_add_f32 v74, v74, v106
    v_add_f32 v138, v138, v170
    v_add_f32 v74, v74, v138
    v_add_f32 v90, v90, v122
    v_add_f32 v154, v154, v186
    v_add_f32 v90, v90, v154
    v_add_f32 v75, v75, v107
    v_add_f32 v139, v139, v171
    v_add_f32 v75, v75, v139
    v_add_f32 v91, v91, v123
    v_add_f32 v155, v155, v187
    v_add_f32 v91, v91, v155
    v_add_f32 v76, v76, v108
    v_add_f32 v140, v140, v172
    v_add_f32 v76, v76, v140
    v_add_f32 v92, v92, v124
    v_add_f32 v156, v156, v188
    v_add_f32 v92, v92, v156
    v_add_f32 v77, v77, v109
    v_add_f32 v141, v141, v173
    v_add_f32 v77, v77, v141
    v_add_f32 v93, v93, v125
    v_add_f32 v157, v157, v189
    v_add_f32 v93, v93, v157
    v_add_f32 v78, v78, v110
    v_add_f32 v142, v142, v174
    v_add_f32 v78, v78, v142
    v_add_f32 v94, v94, v126
    v_add_f32 v158, v158, v190
    v_add_f32 v94, v94, v158
    v_add_f32 v79, v79, v111
    v_add_f32 v143, v143, v175
    v_add_f32 v79, v79, v143
    v_add_f32 v95, v95, v127
    v_add_f32 v159, v159, v191
    v_add_f32 v95, v95, v159
    s_mov_b32 s31, 0xffff0000
    s_mov_b32 s44, 0xbfb8aa3b
    s_waitcnt vmcnt(0)
    v_cvt_pk_bf16_f32 v24, v64, v65
    v_lshlrev_b32 v64, 16, v24
    v_and_b32 v65, s31, v24
    v_cvt_pk_bf16_f32 v24, v80, v81
    v_lshlrev_b32 v80, 16, v24
    v_and_b32 v81, s31, v24
    v_cvt_pk_bf16_f32 v24, v66, v67
    v_lshlrev_b32 v66, 16, v24
    v_and_b32 v67, s31, v24
    v_cvt_pk_bf16_f32 v24, v82, v83
    v_lshlrev_b32 v82, 16, v24
    v_and_b32 v83, s31, v24
    v_cvt_pk_bf16_f32 v24, v68, v69
    v_lshlrev_b32 v68, 16, v24
    v_and_b32 v69, s31, v24
    v_cvt_pk_bf16_f32 v24, v84, v85
    v_lshlrev_b32 v84, 16, v24
    v_and_b32 v85, s31, v24
    v_cvt_pk_bf16_f32 v24, v70, v71
    v_lshlrev_b32 v70, 16, v24
    v_and_b32 v71, s31, v24
    v_cvt_pk_bf16_f32 v24, v86, v87
    v_lshlrev_b32 v86, 16, v24
    v_and_b32 v87, s31, v24
    v_cvt_pk_bf16_f32 v24, v72, v73
    v_lshlrev_b32 v72, 16, v24
    v_and_b32 v73, s31, v24
    v_cvt_pk_bf16_f32 v24, v88, v89
    v_lshlrev_b32 v88, 16, v24
    v_and_b32 v89, s31, v24
    v_cvt_pk_bf16_f32 v24, v74, v75
    v_lshlrev_b32 v74, 16, v24
    v_and_b32 v75, s31, v24
    v_cvt_pk_bf16_f32 v24, v90, v91
    v_lshlrev_b32 v90, 16, v24
    v_and_b32 v91, s31, v24
    v_cvt_pk_bf16_f32 v24, v76, v77
    v_lshlrev_b32 v76, 16, v24
    v_and_b32 v77, s31, v24
    v_cvt_pk_bf16_f32 v24, v92, v93
    v_lshlrev_b32 v92, 16, v24
    v_and_b32 v93, s31, v24
    v_cvt_pk_bf16_f32 v24, v78, v79
    v_lshlrev_b32 v78, 16, v24
    v_and_b32 v79, s31, v24
    v_cvt_pk_bf16_f32 v24, v94, v95
    v_lshlrev_b32 v94, 16, v24
    v_and_b32 v95, s31, v24
    v_mul_f32 v25, s44, v80
    v_exp_f32 v25, v25
    s_nop 0
    v_add_f32 v25, 1.0, v25
    v_rcp_f32 v25, v25
    s_nop 0
    v_mul_f32 v80, v80, v25
    v_mul_f32 v25, s44, v81
    v_exp_f32 v25, v25
    s_nop 0
    v_add_f32 v25, 1.0, v25
    v_rcp_f32 v25, v25
    s_nop 0
    v_mul_f32 v81, v81, v25
    v_mul_f32 v25, s44, v82
    v_exp_f32 v25, v25
    s_nop 0
    v_add_f32 v25, 1.0, v25
    v_rcp_f32 v25, v25
    s_nop 0
    v_mul_f32 v82, v82, v25
    v_mul_f32 v25, s44, v83
    v_exp_f32 v25, v25
    s_nop 0
    v_add_f32 v25, 1.0, v25
    v_rcp_f32 v25, v25
    s_nop 0
    v_mul_f32 v83, v83, v25
    v_mul_f32 v25, s44, v84
    v_exp_f32 v25, v25
    s_nop 0
    v_add_f32 v25, 1.0, v25
    v_rcp_f32 v25, v25
    s_nop 0
    v_mul_f32 v84, v84, v25
    v_mul_f32 v25, s44, v85
    v_exp_f32 v25, v25
    s_nop 0
    v_add_f32 v25, 1.0, v25
    v_rcp_f32 v25, v25
    s_nop 0
    v_mul_f32 v85, v85, v25
    v_mul_f32 v25, s44, v86
    v_exp_f32 v25, v25
    s_nop 0
    v_add_f32 v25, 1.0, v25
    v_rcp_f32 v25, v25
    s_nop 0
    v_mul_f32 v86, v86, v25
    v_mul_f32 v25, s44, v87
    v_exp_f32 v25, v25
    s_nop 0
    v_add_f32 v25, 1.0, v25
    v_rcp_f32 v25, v25
    s_nop 0
    v_mul_f32 v87, v87, v25
    v_mul_f32 v25, s44, v88
    v_exp_f32 v25, v25
    s_nop 0
    v_add_f32 v25, 1.0, v25
    v_rcp_f32 v25, v25
    s_nop 0
    v_mul_f32 v88, v88, v25
    v_mul_f32 v25, s44, v89
    v_exp_f32 v25, v25
    s_nop 0
    v_add_f32 v25, 1.0, v25
    v_rcp_f32 v25, v25
    s_nop 0
    v_mul_f32 v89, v89, v25
    v_mul_f32 v25, s44, v90
    v_exp_f32 v25, v25
    s_nop 0
    v_add_f32 v25, 1.0, v25
    v_rcp_f32 v25, v25
    s_nop 0
    v_mul_f32 v90, v90, v25
    v_mul_f32 v25, s44, v91
    v_exp_f32 v25, v25
    s_nop 0
    v_add_f32 v25, 1.0, v25
    v_rcp_f32 v25, v25
    s_nop 0
    v_mul_f32 v91, v91, v25
    v_mul_f32 v25, s44, v92
    v_exp_f32 v25, v25
    s_nop 0
    v_add_f32 v25, 1.0, v25
    v_rcp_f32 v25, v25
    s_nop 0
    v_mul_f32 v92, v92, v25
    v_mul_f32 v25, s44, v93
    v_exp_f32 v25, v25
    s_nop 0
    v_add_f32 v25, 1.0, v25
    v_rcp_f32 v25, v25
    s_nop 0
    v_mul_f32 v93, v93, v25
    v_mul_f32 v25, s44, v94
    v_exp_f32 v25, v25
    s_nop 0
    v_add_f32 v25, 1.0, v25
    v_rcp_f32 v25, v25
    s_nop 0
    v_mul_f32 v94, v94, v25
    v_mul_f32 v25, s44, v95
    v_exp_f32 v25, v25
    s_nop 0
    v_add_f32 v25, 1.0, v25
    v_rcp_f32 v25, v25
    s_nop 0
    v_mul_f32 v95, v95, v25
    v_cvt_pk_bf16_f32 v24, v80, v81
    v_lshlrev_b32 v80, 16, v24
    v_and_b32 v81, s31, v24
    v_cvt_pk_bf16_f32 v24, v82, v83
    v_lshlrev_b32 v82, 16, v24
    v_and_b32 v83, s31, v24
    v_cvt_pk_bf16_f32 v24, v84, v85
    v_lshlrev_b32 v84, 16, v24
    v_and_b32 v85, s31, v24
    v_cvt_pk_bf16_f32 v24, v86, v87
    v_lshlrev_b32 v86, 16, v24
    v_and_b32 v87, s31, v24
    v_cvt_pk_bf16_f32 v24, v88, v89
    v_lshlrev_b32 v88, 16, v24
    v_and_b32 v89, s31, v24
    v_cvt_pk_bf16_f32 v24, v90, v91
    v_lshlrev_b32 v90, 16, v24
    v_and_b32 v91, s31, v24
    v_cvt_pk_bf16_f32 v24, v92, v93
    v_lshlrev_b32 v92, 16, v24
    v_and_b32 v93, s31, v24
    v_cvt_pk_bf16_f32 v24, v94, v95
    v_lshlrev_b32 v94, 16, v24
    v_and_b32 v95, s31, v24
    v_mul_f32 v64, v64, v80
    v_mul_f32 v65, v65, v81
    v_mul_f32 v66, v66, v82
    v_mul_f32 v67, v67, v83
    v_mul_f32 v68, v68, v84
    v_mul_f32 v69, v69, v85
    v_mul_f32 v70, v70, v86
    v_mul_f32 v71, v71, v87
    v_mul_f32 v72, v72, v88
    v_mul_f32 v73, v73, v89
    v_mul_f32 v74, v74, v90
    v_mul_f32 v75, v75, v91
    v_mul_f32 v76, v76, v92
    v_mul_f32 v77, v77, v93
    v_mul_f32 v78, v78, v94
    v_mul_f32 v79, v79, v95
    v_cvt_pk_bf16_f32 v24, v64, v65
    v_lshlrev_b32 v64, 16, v24
    v_and_b32 v65, s31, v24
    v_cvt_pk_bf16_f32 v24, v66, v67
    v_lshlrev_b32 v66, 16, v24
    v_and_b32 v67, s31, v24
    v_cvt_pk_bf16_f32 v24, v68, v69
    v_lshlrev_b32 v68, 16, v24
    v_and_b32 v69, s31, v24
    v_cvt_pk_bf16_f32 v24, v70, v71
    v_lshlrev_b32 v70, 16, v24
    v_and_b32 v71, s31, v24
    v_cvt_pk_bf16_f32 v24, v72, v73
    v_lshlrev_b32 v72, 16, v24
    v_and_b32 v73, s31, v24
    v_cvt_pk_bf16_f32 v24, v74, v75
    v_lshlrev_b32 v74, 16, v24
    v_and_b32 v75, s31, v24
    v_cvt_pk_bf16_f32 v24, v76, v77
    v_lshlrev_b32 v76, 16, v24
    v_and_b32 v77, s31, v24
    v_cvt_pk_bf16_f32 v24, v78, v79
    v_lshlrev_b32 v78, 16, v24
    v_and_b32 v79, s31, v24
    v_lshlrev_b32 v25, 16, v16
    v_and_b32 v26, s31, v16
    v_add_f32 v25, v25, v64
    v_add_f32 v26, v26, v65
    v_cvt_pk_bf16_f32 v16, v25, v26
    v_lshlrev_b32 v25, 16, v17
    v_and_b32 v26, s31, v17
    v_add_f32 v25, v25, v66
    v_add_f32 v26, v26, v67
    v_cvt_pk_bf16_f32 v17, v25, v26
    buffer_store_dwordx2 v[16:17], v14, s[16:19], 0 offen offset:0
    v_lshlrev_b32 v25, 16, v18
    v_and_b32 v26, s31, v18
    v_add_f32 v25, v25, v68
    v_add_f32 v26, v26, v69
    v_cvt_pk_bf16_f32 v18, v25, v26
    v_lshlrev_b32 v25, 16, v19
    v_and_b32 v26, s31, v19
    v_add_f32 v25, v25, v70
    v_add_f32 v26, v26, v71
    v_cvt_pk_bf16_f32 v19, v25, v26
    buffer_store_dwordx2 v[18:19], v14, s[16:19], 0 offen offset:16
    v_lshlrev_b32 v25, 16, v20
    v_and_b32 v26, s31, v20
    v_add_f32 v25, v25, v72
    v_add_f32 v26, v26, v73
    v_cvt_pk_bf16_f32 v20, v25, v26
    v_lshlrev_b32 v25, 16, v21
    v_and_b32 v26, s31, v21
    v_add_f32 v25, v25, v74
    v_add_f32 v26, v26, v75
    v_cvt_pk_bf16_f32 v21, v25, v26
    buffer_store_dwordx2 v[20:21], v14, s[16:19], 0 offen offset:32
    v_lshlrev_b32 v25, 16, v22
    v_and_b32 v26, s31, v22
    v_add_f32 v25, v25, v76
    v_add_f32 v26, v26, v77
    v_cvt_pk_bf16_f32 v22, v25, v26
    v_lshlrev_b32 v25, 16, v23
    v_and_b32 v26, s31, v23
    v_add_f32 v25, v25, v78
    v_add_f32 v26, v26, v79
    v_cvt_pk_bf16_f32 v23, v25, v26
    buffer_store_dwordx2 v[22:23], v14, s[16:19], 0 offen offset:48
k4_end:
    s_endpgm
.section .rodata,"a"
.p2align 6
.amdhsa_kernel k1_kernel
  .amdhsa_next_free_vgpr 256
  .amdhsa_next_free_sgpr 102
  .amdhsa_accum_offset 256
  .amdhsa_group_segment_fixed_size 0
  .amdhsa_kernarg_size 104
  .amdhsa_user_sgpr_count 2
  .amdhsa_user_sgpr_kernarg_segment_ptr 1
  .amdhsa_system_sgpr_workgroup_id_x 1
.end_amdhsa_kernel
.p2align 6
.amdhsa_kernel k2_kernel
  .amdhsa_next_free_vgpr 256
  .amdhsa_next_free_sgpr 102
  .amdhsa_accum_offset 256
  .amdhsa_group_segment_fixed_size 0
  .amdhsa_kernarg_size 104
  .amdhsa_user_sgpr_count 2
  .amdhsa_user_sgpr_kernarg_segment_ptr 1
  .amdhsa_system_sgpr_workgroup_id_x 1
.end_amdhsa_kernel
.p2align 6
.amdhsa_kernel k3_kernel
  .amdhsa_next_free_vgpr 512
  .amdhsa_next_free_sgpr 102
  .amdhsa_accum_offset 256
  .amdhsa_group_segment_fixed_size 0
  .amdhsa_kernarg_size 104
  .amdhsa_user_sgpr_count 2
  .amdhsa_user_sgpr_kernarg_segment_ptr 1
  .amdhsa_system_sgpr_workgroup_id_x 1
.end_amdhsa_kernel
.p2align 6
.amdhsa_kernel k4_kernel
  .amdhsa_next_free_vgpr 256
  .amdhsa_next_free_sgpr 102
  .amdhsa_accum_offset 256
  .amdhsa_group_segment_fixed_size 0
  .amdhsa_kernarg_size 104
  .amdhsa_user_sgpr_count 2
  .amdhsa_user_sgpr_kernarg_segment_ptr 1
  .amdhsa_system_sgpr_workgroup_id_x 1
.end_amdhsa_kernel
```
